```python
import torch

def _softmax(x, axis=-1):
    return torch.softmax(x, dim=axis)

def _gelu(x):
    return torch.nn.functional.gelu(x, approximate='tanh')

def _silu(x):
    return torch.nn.functional.silu(x)

def _sigmoid(x):
    return torch.sigmoid(x)

def _layernorm(x, axis=-1, eps=1e-05):
    m = x.mean(dim=axis, keepdim=True)
    v = x.var(dim=axis, keepdim=True, unbiased=False)
    return (x - m) / torch.sqrt(v + eps)

def _scatter_add(tgt, idx, src, axis=0):
    return tgt.clone().index_add_(axis, idx, src)

def _segment_sum(src, seg, n):
    out = torch.zeros((n,) + src.shape[1:], dtype=src.dtype)
    return out.index_add_(0, seg, src)

def _pad(x, pw):
    flat = tuple((v for pair in reversed(pw) for v in pair))
    return torch.nn.functional.pad(x, flat)
kernel_name = 'adaLN_cond__gqa_block_cached__geglu_ffn__decode'

def setup_inputs():

    _w = lambda a: (lambda t: t.to(torch.bfloat16) if t.is_floating_point() else t)(torch.as_tensor(a))

    def _A_setup():
        B, Sq, D = (8, 1, 576)
        Hq, Hkv, Sk, Dh = (32, 16, 8192, 128)
        assert Hq % Hkv == 0, (Hq, Hkv)
        return {'x': _w((lambda *s: torch.randn(*s, dtype=torch.bfloat16) * 0.1)(B, Sq, D)), 'k_cache': _w((lambda *s: torch.randn(*s, dtype=torch.bfloat16) * 0.8)(B, Hkv, Sk, Dh)), 'v_cache': _w((lambda *s: torch.randn(*s, dtype=torch.bfloat16) * 0.8)(B, Hkv, Sk, Dh)), 'wq': _w((lambda *s: torch.randn(*s, dtype=torch.bfloat16) * 0.8)(D, Hq * Dh) * D ** (-0.5)), 'wo': _w((lambda *s: torch.randn(*s, dtype=torch.bfloat16) * 0.8)(Hq * Dh, D) * (Hq * Dh) ** (-0.5))}
    _A_in = _A_setup()

    def _B_setup():
        B, S, D, F = (8, 1, 576, 4608)
        return {'x': _w((lambda *s: torch.randn(*s, dtype=torch.bfloat16) * 0.1)(B, S, D)), 'w_gate': _w((lambda *s: torch.randn(*s, dtype=torch.bfloat16) * 0.1)(D, F)), 'w_up': _w((lambda *s: torch.randn(*s, dtype=torch.bfloat16) * 0.1)(D, F)), 'w_down': _w((lambda *s: torch.randn(*s, dtype=torch.bfloat16) * 0.1)(F, D))}
    _B_in = _B_setup()
    return {'A_x': _A_in['x'], 'A_k_cache': _A_in['k_cache'], 'A_v_cache': _A_in['v_cache'], 'A_wq': _A_in['wq'], 'A_wo': _A_in['wo'], 'B_x': _B_in['x'], 'B_w_gate': _B_in['w_gate'], 'B_w_up': _B_in['w_up'], 'B_w_down': _B_in['w_down'], 'c': _w((lambda *s: torch.randn(*s, dtype=torch.bfloat16) * 0.4)(8, 576) * 8.0), 'w_mod': _w((lambda *s: torch.randn(*s, dtype=torch.bfloat16) * 0.4)(576, 6 * 576) * 576 ** (-0.5) * 8.0)}

def reference(A_x, A_k_cache, A_v_cache, A_wq, A_wo, B_x, B_w_gate, B_w_up, B_w_down, c, w_mod):

    def _A_ref(x, k_cache, v_cache, wq, wo):
        B, Sq, D = x.shape
        Hq, Dh = (32, 128)
        Hkv = k_cache.shape[1]
        rep = Hq // Hkv
        q = (lambda x, *d: x.permute(*d))((x @ wq).reshape(B, Sq, Hq, Dh), 0, 2, 1, 3)
        k = (lambda x, n, axis: torch.repeat_interleave(x, n, dim=axis))(k_cache, rep, axis=1)
        v = (lambda x, n, axis: torch.repeat_interleave(x, n, dim=axis))(v_cache, rep, axis=1)
        scores = torch.einsum('bhqd,bhkd->bhqk', q, k) * Dh ** (-0.5)
        p = _softmax(scores, axis=-1)
        o = torch.einsum('bhqk,bhkd->bhqd', p, v)
        return (lambda x, *d: x.permute(*d))(o, 0, 2, 1, 3).reshape(B, Sq, Hq * Dh) @ wo

    def _B_ref(x, w_gate, w_up, w_down):
        return _gelu(x @ w_gate) * (x @ w_up) @ w_down
    x = A_x
    mod = (_silu(c) @ w_mod).reshape(c.shape[0], 6, 1, -1)
    sa, ca, ga, sb, cb, gb = (mod[:, 0].clone(), mod[:, 1].clone(), mod[:, 2].clone(), mod[:, 3].clone(), mod[:, 4].clone(), mod[:, 5].clone())
    h = _layernorm(x, axis=-1) * (1 + ca) + sa
    x = x + ga * _A_ref(h, A_k_cache, A_v_cache, A_wq, A_wo)
    h = _layernorm(x, axis=-1) * (1 + cb) + sb
    x = x + gb * _B_ref(h, B_w_gate, B_w_up, B_w_down)
    return x
```

```asm
; @launch kernel=k1_kernel grid=(54,1,1) block=(256,1,1) lds=81920
; @launch kernel=k2_kernel grid=(64,1,1) block=(256,1,1) lds=81920
; @launch kernel=k3_kernel grid=(512,1,1) block=(256,1,1) lds=20480
; @launch kernel=k4_kernel grid=(72,1,1) block=(256,1,1) lds=81920
; @launch kernel=k5_kernel grid=(72,1,1) block=(256,1,1) lds=81920
; @launch kernel=k6_kernel grid=(81,1,1) block=(256,1,1) lds=81920
.amdgcn_target "amdgcn-amd-amdhsa--gfx950"
.text
.globl k1_kernel
.p2align 8
.type k1_kernel,@function
k1_kernel:
s_cmp_ge_u32 s2, 54
s_cbranch_scc1 k1_kernel_end
s_load_dwordx2 s[8:9], s[0:1], 80
s_mov_b32 s10, 3981312
s_mov_b32 s11, 0x00020000
s_load_dwordx2 s[16:17], s[0:1], 72
s_mov_b32 s18, 9216
s_mov_b32 s19, 0x00020000
s_load_dwordx2 s[24:25], s[0:1], 104
s_mov_b32 s26, 2097152
s_mov_b32 s27, 0x00020000
s_waitcnt lgkmcnt(0)
v_lshrrev_b32 v200, 5, v0
v_and_b32 v201, 31, v0
v_mul_u32_u24 v204, 1152, v200
v_lshl_add_u32 v204, v201, 2, v204
buffer_load_dword v44, v204, s[16:19], 0 offen offset:0
buffer_load_dword v45, v204, s[16:19], 0 offen offset:128
buffer_load_dword v46, v204, s[16:19], 0 offen offset:256
buffer_load_dword v47, v204, s[16:19], 0 offen offset:384
buffer_load_dword v48, v204, s[16:19], 0 offen offset:512
buffer_load_dword v49, v204, s[16:19], 0 offen offset:640
buffer_load_dword v50, v204, s[16:19], 0 offen offset:768
buffer_load_dword v51, v204, s[16:19], 0 offen offset:896
buffer_load_dword v52, v204, s[16:19], 0 offen offset:1024
v_and_b32 v220, 7, v0
v_lshrrev_b32 v221, 3, v0
v_mul_u32_u24 v222, 124416, v221
v_lshl_add_u32 v222, v220, 4, v222
s_mov_b32 s29, 0
s_lshl_b32 s28, s2, 7
s_add_u32 s29, s29, s28
v_add_u32 v224, 0, v222
buffer_load_dwordx4 v[100:103], v224, s[8:11], s29 offen
v_add_u32 v224, 6912, v222
buffer_load_dwordx4 v[104:107], v224, s[8:11], s29 offen
v_add_u32 v224, 13824, v222
buffer_load_dwordx4 v[108:111], v224, s[8:11], s29 offen
v_add_u32 v224, 20736, v222
buffer_load_dwordx4 v[112:115], v224, s[8:11], s29 offen
v_add_u32 v224, 27648, v222
buffer_load_dwordx4 v[116:119], v224, s[8:11], s29 offen
v_add_u32 v224, 34560, v222
buffer_load_dwordx4 v[120:123], v224, s[8:11], s29 offen
v_add_u32 v224, 41472, v222
buffer_load_dwordx4 v[124:127], v224, s[8:11], s29 offen
v_add_u32 v224, 48384, v222
buffer_load_dwordx4 v[128:131], v224, s[8:11], s29 offen
v_add_u32 v224, 55296, v222
buffer_load_dwordx4 v[132:135], v224, s[8:11], s29 offen
v_add_u32 v224, 62208, v222
buffer_load_dwordx4 v[136:139], v224, s[8:11], s29 offen
v_add_u32 v224, 69120, v222
buffer_load_dwordx4 v[140:143], v224, s[8:11], s29 offen
v_add_u32 v224, 76032, v222
buffer_load_dwordx4 v[144:147], v224, s[8:11], s29 offen
v_add_u32 v224, 82944, v222
buffer_load_dwordx4 v[148:151], v224, s[8:11], s29 offen
v_add_u32 v224, 89856, v222
buffer_load_dwordx4 v[152:155], v224, s[8:11], s29 offen
v_add_u32 v224, 96768, v222
buffer_load_dwordx4 v[156:159], v224, s[8:11], s29 offen
v_add_u32 v224, 103680, v222
buffer_load_dwordx4 v[160:163], v224, s[8:11], s29 offen
v_add_u32 v224, 110592, v222
buffer_load_dwordx4 v[164:167], v224, s[8:11], s29 offen
v_add_u32 v224, 117504, v222
buffer_load_dwordx4 v[168:171], v224, s[8:11], s29 offen
v_lshlrev_b32 v207, 5, v201
v_lshl_add_u32 v207, v200, 2, v207
s_waitcnt vmcnt(18)
v_lshlrev_b32 v90, 16, v44
v_and_b32 v91, 0xffff0000, v44
v_mul_f32 v92, 0xbfb8aa3b, v90
v_exp_f32 v92, v92
s_nop 0
v_add_f32 v92, 1.0, v92
v_rcp_f32 v92, v92
s_nop 0
v_mul_f32 v90, v90, v92
v_mul_f32 v92, 0xbfb8aa3b, v91
v_exp_f32 v92, v92
s_nop 0
v_add_f32 v92, 1.0, v92
v_rcp_f32 v92, v92
s_nop 0
v_mul_f32 v91, v91, v92
v_cvt_pk_bf16_f32 v208, v90, v91
ds_write_b32 v207, v208 offset:0
v_lshlrev_b32 v90, 16, v45
v_and_b32 v91, 0xffff0000, v45
v_mul_f32 v92, 0xbfb8aa3b, v90
v_exp_f32 v92, v92
s_nop 0
v_add_f32 v92, 1.0, v92
v_rcp_f32 v92, v92
s_nop 0
v_mul_f32 v90, v90, v92
v_mul_f32 v92, 0xbfb8aa3b, v91
v_exp_f32 v92, v92
s_nop 0
v_add_f32 v92, 1.0, v92
v_rcp_f32 v92, v92
s_nop 0
v_mul_f32 v91, v91, v92
v_cvt_pk_bf16_f32 v208, v90, v91
ds_write_b32 v207, v208 offset:1024
v_lshlrev_b32 v90, 16, v46
v_and_b32 v91, 0xffff0000, v46
v_mul_f32 v92, 0xbfb8aa3b, v90
v_exp_f32 v92, v92
s_nop 0
v_add_f32 v92, 1.0, v92
v_rcp_f32 v92, v92
s_nop 0
v_mul_f32 v90, v90, v92
v_mul_f32 v92, 0xbfb8aa3b, v91
v_exp_f32 v92, v92
s_nop 0
v_add_f32 v92, 1.0, v92
v_rcp_f32 v92, v92
s_nop 0
v_mul_f32 v91, v91, v92
v_cvt_pk_bf16_f32 v208, v90, v91
ds_write_b32 v207, v208 offset:2048
v_lshlrev_b32 v90, 16, v47
v_and_b32 v91, 0xffff0000, v47
v_mul_f32 v92, 0xbfb8aa3b, v90
v_exp_f32 v92, v92
s_nop 0
v_add_f32 v92, 1.0, v92
v_rcp_f32 v92, v92
s_nop 0
v_mul_f32 v90, v90, v92
v_mul_f32 v92, 0xbfb8aa3b, v91
v_exp_f32 v92, v92
s_nop 0
v_add_f32 v92, 1.0, v92
v_rcp_f32 v92, v92
s_nop 0
v_mul_f32 v91, v91, v92
v_cvt_pk_bf16_f32 v208, v90, v91
ds_write_b32 v207, v208 offset:3072
v_lshlrev_b32 v90, 16, v48
v_and_b32 v91, 0xffff0000, v48
v_mul_f32 v92, 0xbfb8aa3b, v90
v_exp_f32 v92, v92
s_nop 0
v_add_f32 v92, 1.0, v92
v_rcp_f32 v92, v92
s_nop 0
v_mul_f32 v90, v90, v92
v_mul_f32 v92, 0xbfb8aa3b, v91
v_exp_f32 v92, v92
s_nop 0
v_add_f32 v92, 1.0, v92
v_rcp_f32 v92, v92
s_nop 0
v_mul_f32 v91, v91, v92
v_cvt_pk_bf16_f32 v208, v90, v91
ds_write_b32 v207, v208 offset:4096
v_lshlrev_b32 v90, 16, v49
v_and_b32 v91, 0xffff0000, v49
v_mul_f32 v92, 0xbfb8aa3b, v90
v_exp_f32 v92, v92
s_nop 0
v_add_f32 v92, 1.0, v92
v_rcp_f32 v92, v92
s_nop 0
v_mul_f32 v90, v90, v92
v_mul_f32 v92, 0xbfb8aa3b, v91
v_exp_f32 v92, v92
s_nop 0
v_add_f32 v92, 1.0, v92
v_rcp_f32 v92, v92
s_nop 0
v_mul_f32 v91, v91, v92
v_cvt_pk_bf16_f32 v208, v90, v91
ds_write_b32 v207, v208 offset:5120
v_lshlrev_b32 v90, 16, v50
v_and_b32 v91, 0xffff0000, v50
v_mul_f32 v92, 0xbfb8aa3b, v90
v_exp_f32 v92, v92
s_nop 0
v_add_f32 v92, 1.0, v92
v_rcp_f32 v92, v92
s_nop 0
v_mul_f32 v90, v90, v92
v_mul_f32 v92, 0xbfb8aa3b, v91
v_exp_f32 v92, v92
s_nop 0
v_add_f32 v92, 1.0, v92
v_rcp_f32 v92, v92
s_nop 0
v_mul_f32 v91, v91, v92
v_cvt_pk_bf16_f32 v208, v90, v91
ds_write_b32 v207, v208 offset:6144
v_lshlrev_b32 v90, 16, v51
v_and_b32 v91, 0xffff0000, v51
v_mul_f32 v92, 0xbfb8aa3b, v90
v_exp_f32 v92, v92
s_nop 0
v_add_f32 v92, 1.0, v92
v_rcp_f32 v92, v92
s_nop 0
v_mul_f32 v90, v90, v92
v_mul_f32 v92, 0xbfb8aa3b, v91
v_exp_f32 v92, v92
s_nop 0
v_add_f32 v92, 1.0, v92
v_rcp_f32 v92, v92
s_nop 0
v_mul_f32 v91, v91, v92
v_cvt_pk_bf16_f32 v208, v90, v91
ds_write_b32 v207, v208 offset:7168
v_lshlrev_b32 v90, 16, v52
v_and_b32 v91, 0xffff0000, v52
v_mul_f32 v92, 0xbfb8aa3b, v90
v_exp_f32 v92, v92
s_nop 0
v_add_f32 v92, 1.0, v92
v_rcp_f32 v92, v92
s_nop 0
v_mul_f32 v90, v90, v92
v_mul_f32 v92, 0xbfb8aa3b, v91
v_exp_f32 v92, v92
s_nop 0
v_add_f32 v92, 1.0, v92
v_rcp_f32 v92, v92
s_nop 0
v_mul_f32 v91, v91, v92
v_cvt_pk_bf16_f32 v208, v90, v91
ds_write_b32 v207, v208 offset:8192
s_waitcnt lgkmcnt(0)
s_barrier
s_mov_b32 s30, 0x05040100
s_mov_b32 s31, 0x07060302
v_mul_u32_u24 v223, 288, v221
v_mov_b32 v4, 0
v_mov_b32 v5, 0
v_mov_b32 v6, 0
v_mov_b32 v7, 0
v_mov_b32 v8, 0
v_mov_b32 v9, 0
v_mov_b32 v10, 0
v_mov_b32 v11, 0
v_mov_b32 v12, 0
v_mov_b32 v13, 0
v_mov_b32 v14, 0
v_mov_b32 v15, 0
v_mov_b32 v16, 0
v_mov_b32 v17, 0
v_mov_b32 v18, 0
v_mov_b32 v19, 0
v_mov_b32 v20, 0
v_mov_b32 v21, 0
v_mov_b32 v22, 0
v_mov_b32 v23, 0
v_mov_b32 v24, 0
v_mov_b32 v25, 0
v_mov_b32 v26, 0
v_mov_b32 v27, 0
v_mov_b32 v28, 0
v_mov_b32 v29, 0
v_mov_b32 v30, 0
v_mov_b32 v31, 0
v_mov_b32 v32, 0
v_mov_b32 v33, 0
v_mov_b32 v34, 0
v_mov_b32 v35, 0
v_mov_b32 v36, 0
v_mov_b32 v37, 0
v_mov_b32 v38, 0
v_mov_b32 v39, 0
v_mov_b32 v40, 0
v_mov_b32 v41, 0
v_mov_b32 v42, 0
v_mov_b32 v43, 0
v_mov_b32 v44, 0
v_mov_b32 v45, 0
v_mov_b32 v46, 0
v_mov_b32 v47, 0
v_mov_b32 v48, 0
v_mov_b32 v49, 0
v_mov_b32 v50, 0
v_mov_b32 v51, 0
v_mov_b32 v52, 0
v_mov_b32 v53, 0
v_mov_b32 v54, 0
v_mov_b32 v55, 0
v_mov_b32 v56, 0
v_mov_b32 v57, 0
v_mov_b32 v58, 0
v_mov_b32 v59, 0
v_mov_b32 v60, 0
v_mov_b32 v61, 0
v_mov_b32 v62, 0
v_mov_b32 v63, 0
v_mov_b32 v64, 0
v_mov_b32 v65, 0
v_mov_b32 v66, 0
v_mov_b32 v67, 0
ds_read_b128 v[80:83], v223 offset:0
ds_read_b128 v[84:87], v223 offset:16
s_waitcnt vmcnt(16) lgkmcnt(0)
v_perm_b32 v90, v104, v100, s30
v_perm_b32 v91, v104, v100, s31
v_perm_b32 v92, v105, v101, s30
v_perm_b32 v93, v105, v101, s31
v_perm_b32 v94, v106, v102, s30
v_perm_b32 v95, v106, v102, s31
v_perm_b32 v96, v107, v103, s30
v_perm_b32 v97, v107, v103, s31
v_dot2_f32_bf16 v4, v90, v80, v4
v_dot2_f32_bf16 v5, v91, v80, v5
v_dot2_f32_bf16 v6, v92, v80, v6
v_dot2_f32_bf16 v7, v93, v80, v7
v_dot2_f32_bf16 v8, v94, v80, v8
v_dot2_f32_bf16 v9, v95, v80, v9
v_dot2_f32_bf16 v10, v96, v80, v10
v_dot2_f32_bf16 v11, v97, v80, v11
v_dot2_f32_bf16 v12, v90, v81, v12
v_dot2_f32_bf16 v13, v91, v81, v13
v_dot2_f32_bf16 v14, v92, v81, v14
v_dot2_f32_bf16 v15, v93, v81, v15
v_dot2_f32_bf16 v16, v94, v81, v16
v_dot2_f32_bf16 v17, v95, v81, v17
v_dot2_f32_bf16 v18, v96, v81, v18
v_dot2_f32_bf16 v19, v97, v81, v19
v_dot2_f32_bf16 v20, v90, v82, v20
v_dot2_f32_bf16 v21, v91, v82, v21
v_dot2_f32_bf16 v22, v92, v82, v22
v_dot2_f32_bf16 v23, v93, v82, v23
v_dot2_f32_bf16 v24, v94, v82, v24
v_dot2_f32_bf16 v25, v95, v82, v25
v_dot2_f32_bf16 v26, v96, v82, v26
v_dot2_f32_bf16 v27, v97, v82, v27
v_dot2_f32_bf16 v28, v90, v83, v28
v_dot2_f32_bf16 v29, v91, v83, v29
v_dot2_f32_bf16 v30, v92, v83, v30
v_dot2_f32_bf16 v31, v93, v83, v31
v_dot2_f32_bf16 v32, v94, v83, v32
v_dot2_f32_bf16 v33, v95, v83, v33
v_dot2_f32_bf16 v34, v96, v83, v34
v_dot2_f32_bf16 v35, v97, v83, v35
v_dot2_f32_bf16 v36, v90, v84, v36
v_dot2_f32_bf16 v37, v91, v84, v37
v_dot2_f32_bf16 v38, v92, v84, v38
v_dot2_f32_bf16 v39, v93, v84, v39
v_dot2_f32_bf16 v40, v94, v84, v40
v_dot2_f32_bf16 v41, v95, v84, v41
v_dot2_f32_bf16 v42, v96, v84, v42
v_dot2_f32_bf16 v43, v97, v84, v43
v_dot2_f32_bf16 v44, v90, v85, v44
v_dot2_f32_bf16 v45, v91, v85, v45
v_dot2_f32_bf16 v46, v92, v85, v46
v_dot2_f32_bf16 v47, v93, v85, v47
v_dot2_f32_bf16 v48, v94, v85, v48
v_dot2_f32_bf16 v49, v95, v85, v49
v_dot2_f32_bf16 v50, v96, v85, v50
v_dot2_f32_bf16 v51, v97, v85, v51
v_dot2_f32_bf16 v52, v90, v86, v52
v_dot2_f32_bf16 v53, v91, v86, v53
v_dot2_f32_bf16 v54, v92, v86, v54
v_dot2_f32_bf16 v55, v93, v86, v55
v_dot2_f32_bf16 v56, v94, v86, v56
v_dot2_f32_bf16 v57, v95, v86, v57
v_dot2_f32_bf16 v58, v96, v86, v58
v_dot2_f32_bf16 v59, v97, v86, v59
v_dot2_f32_bf16 v60, v90, v87, v60
v_dot2_f32_bf16 v61, v91, v87, v61
v_dot2_f32_bf16 v62, v92, v87, v62
v_dot2_f32_bf16 v63, v93, v87, v63
v_dot2_f32_bf16 v64, v94, v87, v64
v_dot2_f32_bf16 v65, v95, v87, v65
v_dot2_f32_bf16 v66, v96, v87, v66
v_dot2_f32_bf16 v67, v97, v87, v67
ds_read_b128 v[80:83], v223 offset:32
ds_read_b128 v[84:87], v223 offset:48
s_waitcnt vmcnt(14) lgkmcnt(0)
v_perm_b32 v90, v112, v108, s30
v_perm_b32 v91, v112, v108, s31
v_perm_b32 v92, v113, v109, s30
v_perm_b32 v93, v113, v109, s31
v_perm_b32 v94, v114, v110, s30
v_perm_b32 v95, v114, v110, s31
v_perm_b32 v96, v115, v111, s30
v_perm_b32 v97, v115, v111, s31
v_dot2_f32_bf16 v4, v90, v80, v4
v_dot2_f32_bf16 v5, v91, v80, v5
v_dot2_f32_bf16 v6, v92, v80, v6
v_dot2_f32_bf16 v7, v93, v80, v7
v_dot2_f32_bf16 v8, v94, v80, v8
v_dot2_f32_bf16 v9, v95, v80, v9
v_dot2_f32_bf16 v10, v96, v80, v10
v_dot2_f32_bf16 v11, v97, v80, v11
v_dot2_f32_bf16 v12, v90, v81, v12
v_dot2_f32_bf16 v13, v91, v81, v13
v_dot2_f32_bf16 v14, v92, v81, v14
v_dot2_f32_bf16 v15, v93, v81, v15
v_dot2_f32_bf16 v16, v94, v81, v16
v_dot2_f32_bf16 v17, v95, v81, v17
v_dot2_f32_bf16 v18, v96, v81, v18
v_dot2_f32_bf16 v19, v97, v81, v19
v_dot2_f32_bf16 v20, v90, v82, v20
v_dot2_f32_bf16 v21, v91, v82, v21
v_dot2_f32_bf16 v22, v92, v82, v22
v_dot2_f32_bf16 v23, v93, v82, v23
v_dot2_f32_bf16 v24, v94, v82, v24
v_dot2_f32_bf16 v25, v95, v82, v25
v_dot2_f32_bf16 v26, v96, v82, v26
v_dot2_f32_bf16 v27, v97, v82, v27
v_dot2_f32_bf16 v28, v90, v83, v28
v_dot2_f32_bf16 v29, v91, v83, v29
v_dot2_f32_bf16 v30, v92, v83, v30
v_dot2_f32_bf16 v31, v93, v83, v31
v_dot2_f32_bf16 v32, v94, v83, v32
v_dot2_f32_bf16 v33, v95, v83, v33
v_dot2_f32_bf16 v34, v96, v83, v34
v_dot2_f32_bf16 v35, v97, v83, v35
v_dot2_f32_bf16 v36, v90, v84, v36
v_dot2_f32_bf16 v37, v91, v84, v37
v_dot2_f32_bf16 v38, v92, v84, v38
v_dot2_f32_bf16 v39, v93, v84, v39
v_dot2_f32_bf16 v40, v94, v84, v40
v_dot2_f32_bf16 v41, v95, v84, v41
v_dot2_f32_bf16 v42, v96, v84, v42
v_dot2_f32_bf16 v43, v97, v84, v43
v_dot2_f32_bf16 v44, v90, v85, v44
v_dot2_f32_bf16 v45, v91, v85, v45
v_dot2_f32_bf16 v46, v92, v85, v46
v_dot2_f32_bf16 v47, v93, v85, v47
v_dot2_f32_bf16 v48, v94, v85, v48
v_dot2_f32_bf16 v49, v95, v85, v49
v_dot2_f32_bf16 v50, v96, v85, v50
v_dot2_f32_bf16 v51, v97, v85, v51
v_dot2_f32_bf16 v52, v90, v86, v52
v_dot2_f32_bf16 v53, v91, v86, v53
v_dot2_f32_bf16 v54, v92, v86, v54
v_dot2_f32_bf16 v55, v93, v86, v55
v_dot2_f32_bf16 v56, v94, v86, v56
v_dot2_f32_bf16 v57, v95, v86, v57
v_dot2_f32_bf16 v58, v96, v86, v58
v_dot2_f32_bf16 v59, v97, v86, v59
v_dot2_f32_bf16 v60, v90, v87, v60
v_dot2_f32_bf16 v61, v91, v87, v61
v_dot2_f32_bf16 v62, v92, v87, v62
v_dot2_f32_bf16 v63, v93, v87, v63
v_dot2_f32_bf16 v64, v94, v87, v64
v_dot2_f32_bf16 v65, v95, v87, v65
v_dot2_f32_bf16 v66, v96, v87, v66
v_dot2_f32_bf16 v67, v97, v87, v67
ds_read_b128 v[80:83], v223 offset:64
ds_read_b128 v[84:87], v223 offset:80
s_waitcnt vmcnt(12) lgkmcnt(0)
v_perm_b32 v90, v120, v116, s30
v_perm_b32 v91, v120, v116, s31
v_perm_b32 v92, v121, v117, s30
v_perm_b32 v93, v121, v117, s31
v_perm_b32 v94, v122, v118, s30
v_perm_b32 v95, v122, v118, s31
v_perm_b32 v96, v123, v119, s30
v_perm_b32 v97, v123, v119, s31
v_dot2_f32_bf16 v4, v90, v80, v4
v_dot2_f32_bf16 v5, v91, v80, v5
v_dot2_f32_bf16 v6, v92, v80, v6
v_dot2_f32_bf16 v7, v93, v80, v7
v_dot2_f32_bf16 v8, v94, v80, v8
v_dot2_f32_bf16 v9, v95, v80, v9
v_dot2_f32_bf16 v10, v96, v80, v10
v_dot2_f32_bf16 v11, v97, v80, v11
v_dot2_f32_bf16 v12, v90, v81, v12
v_dot2_f32_bf16 v13, v91, v81, v13
v_dot2_f32_bf16 v14, v92, v81, v14
v_dot2_f32_bf16 v15, v93, v81, v15
v_dot2_f32_bf16 v16, v94, v81, v16
v_dot2_f32_bf16 v17, v95, v81, v17
v_dot2_f32_bf16 v18, v96, v81, v18
v_dot2_f32_bf16 v19, v97, v81, v19
v_dot2_f32_bf16 v20, v90, v82, v20
v_dot2_f32_bf16 v21, v91, v82, v21
v_dot2_f32_bf16 v22, v92, v82, v22
v_dot2_f32_bf16 v23, v93, v82, v23
v_dot2_f32_bf16 v24, v94, v82, v24
v_dot2_f32_bf16 v25, v95, v82, v25
v_dot2_f32_bf16 v26, v96, v82, v26
v_dot2_f32_bf16 v27, v97, v82, v27
v_dot2_f32_bf16 v28, v90, v83, v28
v_dot2_f32_bf16 v29, v91, v83, v29
v_dot2_f32_bf16 v30, v92, v83, v30
v_dot2_f32_bf16 v31, v93, v83, v31
v_dot2_f32_bf16 v32, v94, v83, v32
v_dot2_f32_bf16 v33, v95, v83, v33
v_dot2_f32_bf16 v34, v96, v83, v34
v_dot2_f32_bf16 v35, v97, v83, v35
v_dot2_f32_bf16 v36, v90, v84, v36
v_dot2_f32_bf16 v37, v91, v84, v37
v_dot2_f32_bf16 v38, v92, v84, v38
v_dot2_f32_bf16 v39, v93, v84, v39
v_dot2_f32_bf16 v40, v94, v84, v40
v_dot2_f32_bf16 v41, v95, v84, v41
v_dot2_f32_bf16 v42, v96, v84, v42
v_dot2_f32_bf16 v43, v97, v84, v43
v_dot2_f32_bf16 v44, v90, v85, v44
v_dot2_f32_bf16 v45, v91, v85, v45
v_dot2_f32_bf16 v46, v92, v85, v46
v_dot2_f32_bf16 v47, v93, v85, v47
v_dot2_f32_bf16 v48, v94, v85, v48
v_dot2_f32_bf16 v49, v95, v85, v49
v_dot2_f32_bf16 v50, v96, v85, v50
v_dot2_f32_bf16 v51, v97, v85, v51
v_dot2_f32_bf16 v52, v90, v86, v52
v_dot2_f32_bf16 v53, v91, v86, v53
v_dot2_f32_bf16 v54, v92, v86, v54
v_dot2_f32_bf16 v55, v93, v86, v55
v_dot2_f32_bf16 v56, v94, v86, v56
v_dot2_f32_bf16 v57, v95, v86, v57
v_dot2_f32_bf16 v58, v96, v86, v58
v_dot2_f32_bf16 v59, v97, v86, v59
v_dot2_f32_bf16 v60, v90, v87, v60
v_dot2_f32_bf16 v61, v91, v87, v61
v_dot2_f32_bf16 v62, v92, v87, v62
v_dot2_f32_bf16 v63, v93, v87, v63
v_dot2_f32_bf16 v64, v94, v87, v64
v_dot2_f32_bf16 v65, v95, v87, v65
v_dot2_f32_bf16 v66, v96, v87, v66
v_dot2_f32_bf16 v67, v97, v87, v67
ds_read_b128 v[80:83], v223 offset:96
ds_read_b128 v[84:87], v223 offset:112
s_waitcnt vmcnt(10) lgkmcnt(0)
v_perm_b32 v90, v128, v124, s30
v_perm_b32 v91, v128, v124, s31
v_perm_b32 v92, v129, v125, s30
v_perm_b32 v93, v129, v125, s31
v_perm_b32 v94, v130, v126, s30
v_perm_b32 v95, v130, v126, s31
v_perm_b32 v96, v131, v127, s30
v_perm_b32 v97, v131, v127, s31
v_dot2_f32_bf16 v4, v90, v80, v4
v_dot2_f32_bf16 v5, v91, v80, v5
v_dot2_f32_bf16 v6, v92, v80, v6
v_dot2_f32_bf16 v7, v93, v80, v7
v_dot2_f32_bf16 v8, v94, v80, v8
v_dot2_f32_bf16 v9, v95, v80, v9
v_dot2_f32_bf16 v10, v96, v80, v10
v_dot2_f32_bf16 v11, v97, v80, v11
v_dot2_f32_bf16 v12, v90, v81, v12
v_dot2_f32_bf16 v13, v91, v81, v13
v_dot2_f32_bf16 v14, v92, v81, v14
v_dot2_f32_bf16 v15, v93, v81, v15
v_dot2_f32_bf16 v16, v94, v81, v16
v_dot2_f32_bf16 v17, v95, v81, v17
v_dot2_f32_bf16 v18, v96, v81, v18
v_dot2_f32_bf16 v19, v97, v81, v19
v_dot2_f32_bf16 v20, v90, v82, v20
v_dot2_f32_bf16 v21, v91, v82, v21
v_dot2_f32_bf16 v22, v92, v82, v22
v_dot2_f32_bf16 v23, v93, v82, v23
v_dot2_f32_bf16 v24, v94, v82, v24
v_dot2_f32_bf16 v25, v95, v82, v25
v_dot2_f32_bf16 v26, v96, v82, v26
v_dot2_f32_bf16 v27, v97, v82, v27
v_dot2_f32_bf16 v28, v90, v83, v28
v_dot2_f32_bf16 v29, v91, v83, v29
v_dot2_f32_bf16 v30, v92, v83, v30
v_dot2_f32_bf16 v31, v93, v83, v31
v_dot2_f32_bf16 v32, v94, v83, v32
v_dot2_f32_bf16 v33, v95, v83, v33
v_dot2_f32_bf16 v34, v96, v83, v34
v_dot2_f32_bf16 v35, v97, v83, v35
v_dot2_f32_bf16 v36, v90, v84, v36
v_dot2_f32_bf16 v37, v91, v84, v37
v_dot2_f32_bf16 v38, v92, v84, v38
v_dot2_f32_bf16 v39, v93, v84, v39
v_dot2_f32_bf16 v40, v94, v84, v40
v_dot2_f32_bf16 v41, v95, v84, v41
v_dot2_f32_bf16 v42, v96, v84, v42
v_dot2_f32_bf16 v43, v97, v84, v43
v_dot2_f32_bf16 v44, v90, v85, v44
v_dot2_f32_bf16 v45, v91, v85, v45
v_dot2_f32_bf16 v46, v92, v85, v46
v_dot2_f32_bf16 v47, v93, v85, v47
v_dot2_f32_bf16 v48, v94, v85, v48
v_dot2_f32_bf16 v49, v95, v85, v49
v_dot2_f32_bf16 v50, v96, v85, v50
v_dot2_f32_bf16 v51, v97, v85, v51
v_dot2_f32_bf16 v52, v90, v86, v52
v_dot2_f32_bf16 v53, v91, v86, v53
v_dot2_f32_bf16 v54, v92, v86, v54
v_dot2_f32_bf16 v55, v93, v86, v55
v_dot2_f32_bf16 v56, v94, v86, v56
v_dot2_f32_bf16 v57, v95, v86, v57
v_dot2_f32_bf16 v58, v96, v86, v58
v_dot2_f32_bf16 v59, v97, v86, v59
v_dot2_f32_bf16 v60, v90, v87, v60
v_dot2_f32_bf16 v61, v91, v87, v61
v_dot2_f32_bf16 v62, v92, v87, v62
v_dot2_f32_bf16 v63, v93, v87, v63
v_dot2_f32_bf16 v64, v94, v87, v64
v_dot2_f32_bf16 v65, v95, v87, v65
v_dot2_f32_bf16 v66, v96, v87, v66
v_dot2_f32_bf16 v67, v97, v87, v67
ds_read_b128 v[80:83], v223 offset:128
ds_read_b128 v[84:87], v223 offset:144
s_waitcnt vmcnt(8) lgkmcnt(0)
v_perm_b32 v90, v136, v132, s30
v_perm_b32 v91, v136, v132, s31
v_perm_b32 v92, v137, v133, s30
v_perm_b32 v93, v137, v133, s31
v_perm_b32 v94, v138, v134, s30
v_perm_b32 v95, v138, v134, s31
v_perm_b32 v96, v139, v135, s30
v_perm_b32 v97, v139, v135, s31
v_dot2_f32_bf16 v4, v90, v80, v4
v_dot2_f32_bf16 v5, v91, v80, v5
v_dot2_f32_bf16 v6, v92, v80, v6
v_dot2_f32_bf16 v7, v93, v80, v7
v_dot2_f32_bf16 v8, v94, v80, v8
v_dot2_f32_bf16 v9, v95, v80, v9
v_dot2_f32_bf16 v10, v96, v80, v10
v_dot2_f32_bf16 v11, v97, v80, v11
v_dot2_f32_bf16 v12, v90, v81, v12
v_dot2_f32_bf16 v13, v91, v81, v13
v_dot2_f32_bf16 v14, v92, v81, v14
v_dot2_f32_bf16 v15, v93, v81, v15
v_dot2_f32_bf16 v16, v94, v81, v16
v_dot2_f32_bf16 v17, v95, v81, v17
v_dot2_f32_bf16 v18, v96, v81, v18
v_dot2_f32_bf16 v19, v97, v81, v19
v_dot2_f32_bf16 v20, v90, v82, v20
v_dot2_f32_bf16 v21, v91, v82, v21
v_dot2_f32_bf16 v22, v92, v82, v22
v_dot2_f32_bf16 v23, v93, v82, v23
v_dot2_f32_bf16 v24, v94, v82, v24
v_dot2_f32_bf16 v25, v95, v82, v25
v_dot2_f32_bf16 v26, v96, v82, v26
v_dot2_f32_bf16 v27, v97, v82, v27
v_dot2_f32_bf16 v28, v90, v83, v28
v_dot2_f32_bf16 v29, v91, v83, v29
v_dot2_f32_bf16 v30, v92, v83, v30
v_dot2_f32_bf16 v31, v93, v83, v31
v_dot2_f32_bf16 v32, v94, v83, v32
v_dot2_f32_bf16 v33, v95, v83, v33
v_dot2_f32_bf16 v34, v96, v83, v34
v_dot2_f32_bf16 v35, v97, v83, v35
v_dot2_f32_bf16 v36, v90, v84, v36
v_dot2_f32_bf16 v37, v91, v84, v37
v_dot2_f32_bf16 v38, v92, v84, v38
v_dot2_f32_bf16 v39, v93, v84, v39
v_dot2_f32_bf16 v40, v94, v84, v40
v_dot2_f32_bf16 v41, v95, v84, v41
v_dot2_f32_bf16 v42, v96, v84, v42
v_dot2_f32_bf16 v43, v97, v84, v43
v_dot2_f32_bf16 v44, v90, v85, v44
v_dot2_f32_bf16 v45, v91, v85, v45
v_dot2_f32_bf16 v46, v92, v85, v46
v_dot2_f32_bf16 v47, v93, v85, v47
v_dot2_f32_bf16 v48, v94, v85, v48
v_dot2_f32_bf16 v49, v95, v85, v49
v_dot2_f32_bf16 v50, v96, v85, v50
v_dot2_f32_bf16 v51, v97, v85, v51
v_dot2_f32_bf16 v52, v90, v86, v52
v_dot2_f32_bf16 v53, v91, v86, v53
v_dot2_f32_bf16 v54, v92, v86, v54
v_dot2_f32_bf16 v55, v93, v86, v55
v_dot2_f32_bf16 v56, v94, v86, v56
v_dot2_f32_bf16 v57, v95, v86, v57
v_dot2_f32_bf16 v58, v96, v86, v58
v_dot2_f32_bf16 v59, v97, v86, v59
v_dot2_f32_bf16 v60, v90, v87, v60
v_dot2_f32_bf16 v61, v91, v87, v61
v_dot2_f32_bf16 v62, v92, v87, v62
v_dot2_f32_bf16 v63, v93, v87, v63
v_dot2_f32_bf16 v64, v94, v87, v64
v_dot2_f32_bf16 v65, v95, v87, v65
v_dot2_f32_bf16 v66, v96, v87, v66
v_dot2_f32_bf16 v67, v97, v87, v67
ds_read_b128 v[80:83], v223 offset:160
ds_read_b128 v[84:87], v223 offset:176
s_waitcnt vmcnt(6) lgkmcnt(0)
v_perm_b32 v90, v144, v140, s30
v_perm_b32 v91, v144, v140, s31
v_perm_b32 v92, v145, v141, s30
v_perm_b32 v93, v145, v141, s31
v_perm_b32 v94, v146, v142, s30
v_perm_b32 v95, v146, v142, s31
v_perm_b32 v96, v147, v143, s30
v_perm_b32 v97, v147, v143, s31
v_dot2_f32_bf16 v4, v90, v80, v4
v_dot2_f32_bf16 v5, v91, v80, v5
v_dot2_f32_bf16 v6, v92, v80, v6
v_dot2_f32_bf16 v7, v93, v80, v7
v_dot2_f32_bf16 v8, v94, v80, v8
v_dot2_f32_bf16 v9, v95, v80, v9
v_dot2_f32_bf16 v10, v96, v80, v10
v_dot2_f32_bf16 v11, v97, v80, v11
v_dot2_f32_bf16 v12, v90, v81, v12
v_dot2_f32_bf16 v13, v91, v81, v13
v_dot2_f32_bf16 v14, v92, v81, v14
v_dot2_f32_bf16 v15, v93, v81, v15
v_dot2_f32_bf16 v16, v94, v81, v16
v_dot2_f32_bf16 v17, v95, v81, v17
v_dot2_f32_bf16 v18, v96, v81, v18
v_dot2_f32_bf16 v19, v97, v81, v19
v_dot2_f32_bf16 v20, v90, v82, v20
v_dot2_f32_bf16 v21, v91, v82, v21
v_dot2_f32_bf16 v22, v92, v82, v22
v_dot2_f32_bf16 v23, v93, v82, v23
v_dot2_f32_bf16 v24, v94, v82, v24
v_dot2_f32_bf16 v25, v95, v82, v25
v_dot2_f32_bf16 v26, v96, v82, v26
v_dot2_f32_bf16 v27, v97, v82, v27
v_dot2_f32_bf16 v28, v90, v83, v28
v_dot2_f32_bf16 v29, v91, v83, v29
v_dot2_f32_bf16 v30, v92, v83, v30
v_dot2_f32_bf16 v31, v93, v83, v31
v_dot2_f32_bf16 v32, v94, v83, v32
v_dot2_f32_bf16 v33, v95, v83, v33
v_dot2_f32_bf16 v34, v96, v83, v34
v_dot2_f32_bf16 v35, v97, v83, v35
v_dot2_f32_bf16 v36, v90, v84, v36
v_dot2_f32_bf16 v37, v91, v84, v37
v_dot2_f32_bf16 v38, v92, v84, v38
v_dot2_f32_bf16 v39, v93, v84, v39
v_dot2_f32_bf16 v40, v94, v84, v40
v_dot2_f32_bf16 v41, v95, v84, v41
v_dot2_f32_bf16 v42, v96, v84, v42
v_dot2_f32_bf16 v43, v97, v84, v43
v_dot2_f32_bf16 v44, v90, v85, v44
v_dot2_f32_bf16 v45, v91, v85, v45
v_dot2_f32_bf16 v46, v92, v85, v46
v_dot2_f32_bf16 v47, v93, v85, v47
v_dot2_f32_bf16 v48, v94, v85, v48
v_dot2_f32_bf16 v49, v95, v85, v49
v_dot2_f32_bf16 v50, v96, v85, v50
v_dot2_f32_bf16 v51, v97, v85, v51
v_dot2_f32_bf16 v52, v90, v86, v52
v_dot2_f32_bf16 v53, v91, v86, v53
v_dot2_f32_bf16 v54, v92, v86, v54
v_dot2_f32_bf16 v55, v93, v86, v55
v_dot2_f32_bf16 v56, v94, v86, v56
v_dot2_f32_bf16 v57, v95, v86, v57
v_dot2_f32_bf16 v58, v96, v86, v58
v_dot2_f32_bf16 v59, v97, v86, v59
v_dot2_f32_bf16 v60, v90, v87, v60
v_dot2_f32_bf16 v61, v91, v87, v61
v_dot2_f32_bf16 v62, v92, v87, v62
v_dot2_f32_bf16 v63, v93, v87, v63
v_dot2_f32_bf16 v64, v94, v87, v64
v_dot2_f32_bf16 v65, v95, v87, v65
v_dot2_f32_bf16 v66, v96, v87, v66
v_dot2_f32_bf16 v67, v97, v87, v67
ds_read_b128 v[80:83], v223 offset:192
ds_read_b128 v[84:87], v223 offset:208
s_waitcnt vmcnt(4) lgkmcnt(0)
v_perm_b32 v90, v152, v148, s30
v_perm_b32 v91, v152, v148, s31
v_perm_b32 v92, v153, v149, s30
v_perm_b32 v93, v153, v149, s31
v_perm_b32 v94, v154, v150, s30
v_perm_b32 v95, v154, v150, s31
v_perm_b32 v96, v155, v151, s30
v_perm_b32 v97, v155, v151, s31
v_dot2_f32_bf16 v4, v90, v80, v4
v_dot2_f32_bf16 v5, v91, v80, v5
v_dot2_f32_bf16 v6, v92, v80, v6
v_dot2_f32_bf16 v7, v93, v80, v7
v_dot2_f32_bf16 v8, v94, v80, v8
v_dot2_f32_bf16 v9, v95, v80, v9
v_dot2_f32_bf16 v10, v96, v80, v10
v_dot2_f32_bf16 v11, v97, v80, v11
v_dot2_f32_bf16 v12, v90, v81, v12
v_dot2_f32_bf16 v13, v91, v81, v13
v_dot2_f32_bf16 v14, v92, v81, v14
v_dot2_f32_bf16 v15, v93, v81, v15
v_dot2_f32_bf16 v16, v94, v81, v16
v_dot2_f32_bf16 v17, v95, v81, v17
v_dot2_f32_bf16 v18, v96, v81, v18
v_dot2_f32_bf16 v19, v97, v81, v19
v_dot2_f32_bf16 v20, v90, v82, v20
v_dot2_f32_bf16 v21, v91, v82, v21
v_dot2_f32_bf16 v22, v92, v82, v22
v_dot2_f32_bf16 v23, v93, v82, v23
v_dot2_f32_bf16 v24, v94, v82, v24
v_dot2_f32_bf16 v25, v95, v82, v25
v_dot2_f32_bf16 v26, v96, v82, v26
v_dot2_f32_bf16 v27, v97, v82, v27
v_dot2_f32_bf16 v28, v90, v83, v28
v_dot2_f32_bf16 v29, v91, v83, v29
v_dot2_f32_bf16 v30, v92, v83, v30
v_dot2_f32_bf16 v31, v93, v83, v31
v_dot2_f32_bf16 v32, v94, v83, v32
v_dot2_f32_bf16 v33, v95, v83, v33
v_dot2_f32_bf16 v34, v96, v83, v34
v_dot2_f32_bf16 v35, v97, v83, v35
v_dot2_f32_bf16 v36, v90, v84, v36
v_dot2_f32_bf16 v37, v91, v84, v37
v_dot2_f32_bf16 v38, v92, v84, v38
v_dot2_f32_bf16 v39, v93, v84, v39
v_dot2_f32_bf16 v40, v94, v84, v40
v_dot2_f32_bf16 v41, v95, v84, v41
v_dot2_f32_bf16 v42, v96, v84, v42
v_dot2_f32_bf16 v43, v97, v84, v43
v_dot2_f32_bf16 v44, v90, v85, v44
v_dot2_f32_bf16 v45, v91, v85, v45
v_dot2_f32_bf16 v46, v92, v85, v46
v_dot2_f32_bf16 v47, v93, v85, v47
v_dot2_f32_bf16 v48, v94, v85, v48
v_dot2_f32_bf16 v49, v95, v85, v49
v_dot2_f32_bf16 v50, v96, v85, v50
v_dot2_f32_bf16 v51, v97, v85, v51
v_dot2_f32_bf16 v52, v90, v86, v52
v_dot2_f32_bf16 v53, v91, v86, v53
v_dot2_f32_bf16 v54, v92, v86, v54
v_dot2_f32_bf16 v55, v93, v86, v55
v_dot2_f32_bf16 v56, v94, v86, v56
v_dot2_f32_bf16 v57, v95, v86, v57
v_dot2_f32_bf16 v58, v96, v86, v58
v_dot2_f32_bf16 v59, v97, v86, v59
v_dot2_f32_bf16 v60, v90, v87, v60
v_dot2_f32_bf16 v61, v91, v87, v61
v_dot2_f32_bf16 v62, v92, v87, v62
v_dot2_f32_bf16 v63, v93, v87, v63
v_dot2_f32_bf16 v64, v94, v87, v64
v_dot2_f32_bf16 v65, v95, v87, v65
v_dot2_f32_bf16 v66, v96, v87, v66
v_dot2_f32_bf16 v67, v97, v87, v67
ds_read_b128 v[80:83], v223 offset:224
ds_read_b128 v[84:87], v223 offset:240
s_waitcnt vmcnt(2) lgkmcnt(0)
v_perm_b32 v90, v160, v156, s30
v_perm_b32 v91, v160, v156, s31
v_perm_b32 v92, v161, v157, s30
v_perm_b32 v93, v161, v157, s31
v_perm_b32 v94, v162, v158, s30
v_perm_b32 v95, v162, v158, s31
v_perm_b32 v96, v163, v159, s30
v_perm_b32 v97, v163, v159, s31
v_dot2_f32_bf16 v4, v90, v80, v4
v_dot2_f32_bf16 v5, v91, v80, v5
v_dot2_f32_bf16 v6, v92, v80, v6
v_dot2_f32_bf16 v7, v93, v80, v7
v_dot2_f32_bf16 v8, v94, v80, v8
v_dot2_f32_bf16 v9, v95, v80, v9
v_dot2_f32_bf16 v10, v96, v80, v10
v_dot2_f32_bf16 v11, v97, v80, v11
v_dot2_f32_bf16 v12, v90, v81, v12
v_dot2_f32_bf16 v13, v91, v81, v13
v_dot2_f32_bf16 v14, v92, v81, v14
v_dot2_f32_bf16 v15, v93, v81, v15
v_dot2_f32_bf16 v16, v94, v81, v16
v_dot2_f32_bf16 v17, v95, v81, v17
v_dot2_f32_bf16 v18, v96, v81, v18
v_dot2_f32_bf16 v19, v97, v81, v19
v_dot2_f32_bf16 v20, v90, v82, v20
v_dot2_f32_bf16 v21, v91, v82, v21
v_dot2_f32_bf16 v22, v92, v82, v22
v_dot2_f32_bf16 v23, v93, v82, v23
v_dot2_f32_bf16 v24, v94, v82, v24
v_dot2_f32_bf16 v25, v95, v82, v25
v_dot2_f32_bf16 v26, v96, v82, v26
v_dot2_f32_bf16 v27, v97, v82, v27
v_dot2_f32_bf16 v28, v90, v83, v28
v_dot2_f32_bf16 v29, v91, v83, v29
v_dot2_f32_bf16 v30, v92, v83, v30
v_dot2_f32_bf16 v31, v93, v83, v31
v_dot2_f32_bf16 v32, v94, v83, v32
v_dot2_f32_bf16 v33, v95, v83, v33
v_dot2_f32_bf16 v34, v96, v83, v34
v_dot2_f32_bf16 v35, v97, v83, v35
v_dot2_f32_bf16 v36, v90, v84, v36
v_dot2_f32_bf16 v37, v91, v84, v37
v_dot2_f32_bf16 v38, v92, v84, v38
v_dot2_f32_bf16 v39, v93, v84, v39
v_dot2_f32_bf16 v40, v94, v84, v40
v_dot2_f32_bf16 v41, v95, v84, v41
v_dot2_f32_bf16 v42, v96, v84, v42
v_dot2_f32_bf16 v43, v97, v84, v43
v_dot2_f32_bf16 v44, v90, v85, v44
v_dot2_f32_bf16 v45, v91, v85, v45
v_dot2_f32_bf16 v46, v92, v85, v46
v_dot2_f32_bf16 v47, v93, v85, v47
v_dot2_f32_bf16 v48, v94, v85, v48
v_dot2_f32_bf16 v49, v95, v85, v49
v_dot2_f32_bf16 v50, v96, v85, v50
v_dot2_f32_bf16 v51, v97, v85, v51
v_dot2_f32_bf16 v52, v90, v86, v52
v_dot2_f32_bf16 v53, v91, v86, v53
v_dot2_f32_bf16 v54, v92, v86, v54
v_dot2_f32_bf16 v55, v93, v86, v55
v_dot2_f32_bf16 v56, v94, v86, v56
v_dot2_f32_bf16 v57, v95, v86, v57
v_dot2_f32_bf16 v58, v96, v86, v58
v_dot2_f32_bf16 v59, v97, v86, v59
v_dot2_f32_bf16 v60, v90, v87, v60
v_dot2_f32_bf16 v61, v91, v87, v61
v_dot2_f32_bf16 v62, v92, v87, v62
v_dot2_f32_bf16 v63, v93, v87, v63
v_dot2_f32_bf16 v64, v94, v87, v64
v_dot2_f32_bf16 v65, v95, v87, v65
v_dot2_f32_bf16 v66, v96, v87, v66
v_dot2_f32_bf16 v67, v97, v87, v67
ds_read_b128 v[80:83], v223 offset:256
ds_read_b128 v[84:87], v223 offset:272
s_waitcnt vmcnt(0) lgkmcnt(0)
v_perm_b32 v90, v168, v164, s30
v_perm_b32 v91, v168, v164, s31
v_perm_b32 v92, v169, v165, s30
v_perm_b32 v93, v169, v165, s31
v_perm_b32 v94, v170, v166, s30
v_perm_b32 v95, v170, v166, s31
v_perm_b32 v96, v171, v167, s30
v_perm_b32 v97, v171, v167, s31
v_dot2_f32_bf16 v4, v90, v80, v4
v_dot2_f32_bf16 v5, v91, v80, v5
v_dot2_f32_bf16 v6, v92, v80, v6
v_dot2_f32_bf16 v7, v93, v80, v7
v_dot2_f32_bf16 v8, v94, v80, v8
v_dot2_f32_bf16 v9, v95, v80, v9
v_dot2_f32_bf16 v10, v96, v80, v10
v_dot2_f32_bf16 v11, v97, v80, v11
v_dot2_f32_bf16 v12, v90, v81, v12
v_dot2_f32_bf16 v13, v91, v81, v13
v_dot2_f32_bf16 v14, v92, v81, v14
v_dot2_f32_bf16 v15, v93, v81, v15
v_dot2_f32_bf16 v16, v94, v81, v16
v_dot2_f32_bf16 v17, v95, v81, v17
v_dot2_f32_bf16 v18, v96, v81, v18
v_dot2_f32_bf16 v19, v97, v81, v19
v_dot2_f32_bf16 v20, v90, v82, v20
v_dot2_f32_bf16 v21, v91, v82, v21
v_dot2_f32_bf16 v22, v92, v82, v22
v_dot2_f32_bf16 v23, v93, v82, v23
v_dot2_f32_bf16 v24, v94, v82, v24
v_dot2_f32_bf16 v25, v95, v82, v25
v_dot2_f32_bf16 v26, v96, v82, v26
v_dot2_f32_bf16 v27, v97, v82, v27
v_dot2_f32_bf16 v28, v90, v83, v28
v_dot2_f32_bf16 v29, v91, v83, v29
v_dot2_f32_bf16 v30, v92, v83, v30
v_dot2_f32_bf16 v31, v93, v83, v31
v_dot2_f32_bf16 v32, v94, v83, v32
v_dot2_f32_bf16 v33, v95, v83, v33
v_dot2_f32_bf16 v34, v96, v83, v34
v_dot2_f32_bf16 v35, v97, v83, v35
v_dot2_f32_bf16 v36, v90, v84, v36
v_dot2_f32_bf16 v37, v91, v84, v37
v_dot2_f32_bf16 v38, v92, v84, v38
v_dot2_f32_bf16 v39, v93, v84, v39
v_dot2_f32_bf16 v40, v94, v84, v40
v_dot2_f32_bf16 v41, v95, v84, v41
v_dot2_f32_bf16 v42, v96, v84, v42
v_dot2_f32_bf16 v43, v97, v84, v43
v_dot2_f32_bf16 v44, v90, v85, v44
v_dot2_f32_bf16 v45, v91, v85, v45
v_dot2_f32_bf16 v46, v92, v85, v46
v_dot2_f32_bf16 v47, v93, v85, v47
v_dot2_f32_bf16 v48, v94, v85, v48
v_dot2_f32_bf16 v49, v95, v85, v49
v_dot2_f32_bf16 v50, v96, v85, v50
v_dot2_f32_bf16 v51, v97, v85, v51
v_dot2_f32_bf16 v52, v90, v86, v52
v_dot2_f32_bf16 v53, v91, v86, v53
v_dot2_f32_bf16 v54, v92, v86, v54
v_dot2_f32_bf16 v55, v93, v86, v55
v_dot2_f32_bf16 v56, v94, v86, v56
v_dot2_f32_bf16 v57, v95, v86, v57
v_dot2_f32_bf16 v58, v96, v86, v58
v_dot2_f32_bf16 v59, v97, v86, v59
v_dot2_f32_bf16 v60, v90, v87, v60
v_dot2_f32_bf16 v61, v91, v87, v61
v_dot2_f32_bf16 v62, v92, v87, v62
v_dot2_f32_bf16 v63, v93, v87, v63
v_dot2_f32_bf16 v64, v94, v87, v64
v_dot2_f32_bf16 v65, v95, v87, v65
v_dot2_f32_bf16 v66, v96, v87, v66
v_dot2_f32_bf16 v67, v97, v87, v67
s_nop 4
v_lshlrev_b32 v225, 11, v221
v_lshl_add_u32 v225, v220, 5, v225
s_barrier
ds_write_b128 v225, v[4:7] offset:16384
ds_write_b128 v225, v[8:11] offset:16400
ds_write_b128 v225, v[12:15] offset:16640
ds_write_b128 v225, v[16:19] offset:16656
ds_write_b128 v225, v[20:23] offset:16896
ds_write_b128 v225, v[24:27] offset:16912
ds_write_b128 v225, v[28:31] offset:17152
ds_write_b128 v225, v[32:35] offset:17168
ds_write_b128 v225, v[36:39] offset:17408
ds_write_b128 v225, v[40:43] offset:17424
ds_write_b128 v225, v[44:47] offset:17664
ds_write_b128 v225, v[48:51] offset:17680
ds_write_b128 v225, v[52:55] offset:17920
ds_write_b128 v225, v[56:59] offset:17936
ds_write_b128 v225, v[60:63] offset:18176
ds_write_b128 v225, v[64:67] offset:18192
s_waitcnt lgkmcnt(0)
s_barrier
v_lshlrev_b32 v226, 3, v0
v_add_u32 v226, 16384, v226
ds_read_b64 v[4:5], v226 offset:0
ds_read_b64 v[6:7], v226 offset:2048
ds_read_b64 v[8:9], v226 offset:4096
ds_read_b64 v[10:11], v226 offset:6144
ds_read_b64 v[12:13], v226 offset:8192
ds_read_b64 v[14:15], v226 offset:10240
ds_read_b64 v[16:17], v226 offset:12288
ds_read_b64 v[18:19], v226 offset:14336
ds_read_b64 v[20:21], v226 offset:16384
ds_read_b64 v[22:23], v226 offset:18432
ds_read_b64 v[24:25], v226 offset:20480
ds_read_b64 v[26:27], v226 offset:22528
ds_read_b64 v[28:29], v226 offset:24576
ds_read_b64 v[30:31], v226 offset:26624
ds_read_b64 v[32:33], v226 offset:28672
ds_read_b64 v[34:35], v226 offset:30720
ds_read_b64 v[36:37], v226 offset:32768
ds_read_b64 v[38:39], v226 offset:34816
ds_read_b64 v[40:41], v226 offset:36864
ds_read_b64 v[42:43], v226 offset:38912
ds_read_b64 v[44:45], v226 offset:40960
ds_read_b64 v[46:47], v226 offset:43008
ds_read_b64 v[48:49], v226 offset:45056
ds_read_b64 v[50:51], v226 offset:47104
ds_read_b64 v[52:53], v226 offset:49152
ds_read_b64 v[54:55], v226 offset:51200
ds_read_b64 v[56:57], v226 offset:53248
ds_read_b64 v[58:59], v226 offset:55296
ds_read_b64 v[60:61], v226 offset:57344
ds_read_b64 v[62:63], v226 offset:59392
ds_read_b64 v[64:65], v226 offset:61440
ds_read_b64 v[66:67], v226 offset:63488
s_waitcnt lgkmcnt(0)
v_mov_b32 v210, 0
v_mov_b32 v211, 0
v_add_f32 v210, v210, v4
v_add_f32 v211, v211, v5
v_add_f32 v210, v210, v6
v_add_f32 v211, v211, v7
v_add_f32 v210, v210, v8
v_add_f32 v211, v211, v9
v_add_f32 v210, v210, v10
v_add_f32 v211, v211, v11
v_add_f32 v210, v210, v12
v_add_f32 v211, v211, v13
v_add_f32 v210, v210, v14
v_add_f32 v211, v211, v15
v_add_f32 v210, v210, v16
v_add_f32 v211, v211, v17
v_add_f32 v210, v210, v18
v_add_f32 v211, v211, v19
v_add_f32 v210, v210, v20
v_add_f32 v211, v211, v21
v_add_f32 v210, v210, v22
v_add_f32 v211, v211, v23
v_add_f32 v210, v210, v24
v_add_f32 v211, v211, v25
v_add_f32 v210, v210, v26
v_add_f32 v211, v211, v27
v_add_f32 v210, v210, v28
v_add_f32 v211, v211, v29
v_add_f32 v210, v210, v30
v_add_f32 v211, v211, v31
v_add_f32 v210, v210, v32
v_add_f32 v211, v211, v33
v_add_f32 v210, v210, v34
v_add_f32 v211, v211, v35
v_add_f32 v210, v210, v36
v_add_f32 v211, v211, v37
v_add_f32 v210, v210, v38
v_add_f32 v211, v211, v39
v_add_f32 v210, v210, v40
v_add_f32 v211, v211, v41
v_add_f32 v210, v210, v42
v_add_f32 v211, v211, v43
v_add_f32 v210, v210, v44
v_add_f32 v211, v211, v45
v_add_f32 v210, v210, v46
v_add_f32 v211, v211, v47
v_add_f32 v210, v210, v48
v_add_f32 v211, v211, v49
v_add_f32 v210, v210, v50
v_add_f32 v211, v211, v51
v_add_f32 v210, v210, v52
v_add_f32 v211, v211, v53
v_add_f32 v210, v210, v54
v_add_f32 v211, v211, v55
v_add_f32 v210, v210, v56
v_add_f32 v211, v211, v57
v_add_f32 v210, v210, v58
v_add_f32 v211, v211, v59
v_add_f32 v210, v210, v60
v_add_f32 v211, v211, v61
v_add_f32 v210, v210, v62
v_add_f32 v211, v211, v63
v_add_f32 v210, v210, v64
v_add_f32 v211, v211, v65
v_add_f32 v210, v210, v66
v_add_f32 v211, v211, v67
v_cvt_pk_bf16_f32 v209, v210, v210
v_lshlrev_b32 v210, 16, v209
v_cvt_pk_bf16_f32 v209, v211, v211
v_lshlrev_b32 v211, 16, v209
v_mul_u32_u24 v204, 0x3600, v200
v_lshl_add_u32 v204, v201, 3, v204
s_lshl_b32 s28, s2, 8
buffer_store_dwordx2 v[210:211], v204, s[24:27], s28 offen
k1_kernel_end:
s_endpgm
.globl k2_kernel
.p2align 8
.type k2_kernel,@function
k2_kernel:
s_cmp_ge_u32 s2, 64
s_cbranch_scc1 k2_kernel_end
s_load_dwordx2 s[8:9], s[0:1], 24
s_mov_b32 s10, 4718592
s_mov_b32 s11, 0x00020000
s_load_dwordx2 s[16:17], s[0:1], 0
s_mov_b32 s18, 9216
s_mov_b32 s19, 0x00020000
s_load_dwordx2 s[24:25], s[0:1], 104
s_mov_b32 s26, 2097152
s_mov_b32 s27, 0x00020000
s_waitcnt lgkmcnt(0)
v_lshrrev_b32 v200, 5, v0
v_and_b32 v201, 31, v0
v_mul_u32_u24 v204, 1152, v200
v_lshl_add_u32 v204, v201, 2, v204
buffer_load_dword v44, v204, s[16:19], 0 offen offset:0
buffer_load_dword v45, v204, s[16:19], 0 offen offset:128
buffer_load_dword v46, v204, s[16:19], 0 offen offset:256
buffer_load_dword v47, v204, s[16:19], 0 offen offset:384
buffer_load_dword v48, v204, s[16:19], 0 offen offset:512
buffer_load_dword v49, v204, s[16:19], 0 offen offset:640
buffer_load_dword v50, v204, s[16:19], 0 offen offset:768
buffer_load_dword v51, v204, s[16:19], 0 offen offset:896
buffer_load_dword v52, v204, s[16:19], 0 offen offset:1024
v_and_b32 v220, 7, v0
v_lshrrev_b32 v221, 3, v0
v_mul_u32_u24 v222, 147456, v221
v_lshl_add_u32 v222, v220, 4, v222
s_mov_b32 s29, 0
s_lshl_b32 s28, s2, 7
s_add_u32 s29, s29, s28
v_add_u32 v224, 0, v222
buffer_load_dwordx4 v[100:103], v224, s[8:11], s29 offen
v_add_u32 v224, 8192, v222
buffer_load_dwordx4 v[104:107], v224, s[8:11], s29 offen
v_add_u32 v224, 16384, v222
buffer_load_dwordx4 v[108:111], v224, s[8:11], s29 offen
v_add_u32 v224, 24576, v222
buffer_load_dwordx4 v[112:115], v224, s[8:11], s29 offen
v_add_u32 v224, 32768, v222
buffer_load_dwordx4 v[116:119], v224, s[8:11], s29 offen
v_add_u32 v224, 40960, v222
buffer_load_dwordx4 v[120:123], v224, s[8:11], s29 offen
v_add_u32 v224, 49152, v222
buffer_load_dwordx4 v[124:127], v224, s[8:11], s29 offen
v_add_u32 v224, 57344, v222
buffer_load_dwordx4 v[128:131], v224, s[8:11], s29 offen
v_add_u32 v224, 65536, v222
buffer_load_dwordx4 v[132:135], v224, s[8:11], s29 offen
v_add_u32 v224, 73728, v222
buffer_load_dwordx4 v[136:139], v224, s[8:11], s29 offen
v_add_u32 v224, 81920, v222
buffer_load_dwordx4 v[140:143], v224, s[8:11], s29 offen
v_add_u32 v224, 90112, v222
buffer_load_dwordx4 v[144:147], v224, s[8:11], s29 offen
v_add_u32 v224, 98304, v222
buffer_load_dwordx4 v[148:151], v224, s[8:11], s29 offen
v_add_u32 v224, 106496, v222
buffer_load_dwordx4 v[152:155], v224, s[8:11], s29 offen
v_add_u32 v224, 114688, v222
buffer_load_dwordx4 v[156:159], v224, s[8:11], s29 offen
v_add_u32 v224, 122880, v222
buffer_load_dwordx4 v[160:163], v224, s[8:11], s29 offen
v_add_u32 v224, 131072, v222
buffer_load_dwordx4 v[164:167], v224, s[8:11], s29 offen
v_add_u32 v224, 139264, v222
buffer_load_dwordx4 v[168:171], v224, s[8:11], s29 offen
s_waitcnt vmcnt(18)
v_lshlrev_b32 v60, 16, v44
v_and_b32 v61, 0xffff0000, v44
v_lshlrev_b32 v62, 16, v45
v_and_b32 v63, 0xffff0000, v45
v_lshlrev_b32 v64, 16, v46
v_and_b32 v65, 0xffff0000, v46
v_lshlrev_b32 v66, 16, v47
v_and_b32 v67, 0xffff0000, v47
v_lshlrev_b32 v68, 16, v48
v_and_b32 v69, 0xffff0000, v48
v_lshlrev_b32 v70, 16, v49
v_and_b32 v71, 0xffff0000, v49
v_lshlrev_b32 v72, 16, v50
v_and_b32 v73, 0xffff0000, v50
v_lshlrev_b32 v74, 16, v51
v_and_b32 v75, 0xffff0000, v51
v_lshlrev_b32 v76, 16, v52
v_and_b32 v77, 0xffff0000, v52
v_mov_b32 v202, 0
v_add_f32 v202, v202, v60
v_add_f32 v202, v202, v61
v_add_f32 v202, v202, v62
v_add_f32 v202, v202, v63
v_add_f32 v202, v202, v64
v_add_f32 v202, v202, v65
v_add_f32 v202, v202, v66
v_add_f32 v202, v202, v67
v_add_f32 v202, v202, v68
v_add_f32 v202, v202, v69
v_add_f32 v202, v202, v70
v_add_f32 v202, v202, v71
v_add_f32 v202, v202, v72
v_add_f32 v202, v202, v73
v_add_f32 v202, v202, v74
v_add_f32 v202, v202, v75
v_add_f32 v202, v202, v76
v_add_f32 v202, v202, v77
s_nop 1
v_add_f32_dpp v202, v202, v202 row_ror:8 row_mask:0xf bank_mask:0xf
s_nop 1
v_add_f32_dpp v202, v202, v202 row_ror:4 row_mask:0xf bank_mask:0xf
s_nop 1
v_add_f32_dpp v202, v202, v202 row_ror:2 row_mask:0xf bank_mask:0xf
s_nop 1
v_add_f32_dpp v202, v202, v202 row_ror:1 row_mask:0xf bank_mask:0xf
ds_swizzle_b32 v250, v202 offset:0x401F
s_waitcnt lgkmcnt(0)
v_add_f32 v202, v250, v202
v_mul_f32 v202, 0x3ae38e39, v202
v_mov_b32 v203, 0
v_sub_f32 v60, v60, v202
v_fmac_f32 v203, v60, v60
v_sub_f32 v61, v61, v202
v_fmac_f32 v203, v61, v61
v_sub_f32 v62, v62, v202
v_fmac_f32 v203, v62, v62
v_sub_f32 v63, v63, v202
v_fmac_f32 v203, v63, v63
v_sub_f32 v64, v64, v202
v_fmac_f32 v203, v64, v64
v_sub_f32 v65, v65, v202
v_fmac_f32 v203, v65, v65
v_sub_f32 v66, v66, v202
v_fmac_f32 v203, v66, v66
v_sub_f32 v67, v67, v202
v_fmac_f32 v203, v67, v67
v_sub_f32 v68, v68, v202
v_fmac_f32 v203, v68, v68
v_sub_f32 v69, v69, v202
v_fmac_f32 v203, v69, v69
v_sub_f32 v70, v70, v202
v_fmac_f32 v203, v70, v70
v_sub_f32 v71, v71, v202
v_fmac_f32 v203, v71, v71
v_sub_f32 v72, v72, v202
v_fmac_f32 v203, v72, v72
v_sub_f32 v73, v73, v202
v_fmac_f32 v203, v73, v73
v_sub_f32 v74, v74, v202
v_fmac_f32 v203, v74, v74
v_sub_f32 v75, v75, v202
v_fmac_f32 v203, v75, v75
v_sub_f32 v76, v76, v202
v_fmac_f32 v203, v76, v76
v_sub_f32 v77, v77, v202
v_fmac_f32 v203, v77, v77
s_nop 1
v_add_f32_dpp v203, v203, v203 row_ror:8 row_mask:0xf bank_mask:0xf
s_nop 1
v_add_f32_dpp v203, v203, v203 row_ror:4 row_mask:0xf bank_mask:0xf
s_nop 1
v_add_f32_dpp v203, v203, v203 row_ror:2 row_mask:0xf bank_mask:0xf
s_nop 1
v_add_f32_dpp v203, v203, v203 row_ror:1 row_mask:0xf bank_mask:0xf
ds_swizzle_b32 v250, v203 offset:0x401F
s_waitcnt lgkmcnt(0)
v_add_f32 v203, v250, v203
v_mul_f32 v203, 0x3ae38e39, v203
v_add_f32 v203, 0x3727c5ac, v203
v_rsq_f32 v203, v203
v_mul_u32_u24 v204, 0x3600, v200
v_lshl_add_u32 v204, v201, 3, v204
v_add_u32 v205, 0, v204
v_add_u32 v206, 2304, v204
buffer_load_dwordx2 v[4:5], v205, s[24:27], 0 offen offset:0
buffer_load_dwordx2 v[24:25], v206, s[24:27], 0 offen offset:0
buffer_load_dwordx2 v[6:7], v205, s[24:27], 0 offen offset:256
buffer_load_dwordx2 v[26:27], v206, s[24:27], 0 offen offset:256
buffer_load_dwordx2 v[8:9], v205, s[24:27], 0 offen offset:512
buffer_load_dwordx2 v[28:29], v206, s[24:27], 0 offen offset:512
buffer_load_dwordx2 v[10:11], v205, s[24:27], 0 offen offset:768
buffer_load_dwordx2 v[30:31], v206, s[24:27], 0 offen offset:768
buffer_load_dwordx2 v[12:13], v205, s[24:27], 0 offen offset:1024
buffer_load_dwordx2 v[32:33], v206, s[24:27], 0 offen offset:1024
buffer_load_dwordx2 v[14:15], v205, s[24:27], 0 offen offset:1280
buffer_load_dwordx2 v[34:35], v206, s[24:27], 0 offen offset:1280
buffer_load_dwordx2 v[16:17], v205, s[24:27], 0 offen offset:1536
buffer_load_dwordx2 v[36:37], v206, s[24:27], 0 offen offset:1536
buffer_load_dwordx2 v[18:19], v205, s[24:27], 0 offen offset:1792
buffer_load_dwordx2 v[38:39], v206, s[24:27], 0 offen offset:1792
buffer_load_dwordx2 v[20:21], v205, s[24:27], 0 offen offset:2048
buffer_load_dwordx2 v[40:41], v206, s[24:27], 0 offen offset:2048
s_waitcnt vmcnt(0)
v_lshlrev_b32 v207, 5, v201
v_lshl_add_u32 v207, v200, 2, v207
v_mul_f32 v60, v60, v203
v_add_f32 v24, 1.0, v24
v_fma_f32 v60, v60, v24, v4
v_mul_f32 v61, v61, v203
v_add_f32 v25, 1.0, v25
v_fma_f32 v61, v61, v25, v5
v_cvt_pk_bf16_f32 v208, v60, v61
ds_write_b32 v207, v208 offset:0
v_mul_f32 v62, v62, v203
v_add_f32 v26, 1.0, v26
v_fma_f32 v62, v62, v26, v6
v_mul_f32 v63, v63, v203
v_add_f32 v27, 1.0, v27
v_fma_f32 v63, v63, v27, v7
v_cvt_pk_bf16_f32 v208, v62, v63
ds_write_b32 v207, v208 offset:1024
v_mul_f32 v64, v64, v203
v_add_f32 v28, 1.0, v28
v_fma_f32 v64, v64, v28, v8
v_mul_f32 v65, v65, v203
v_add_f32 v29, 1.0, v29
v_fma_f32 v65, v65, v29, v9
v_cvt_pk_bf16_f32 v208, v64, v65
ds_write_b32 v207, v208 offset:2048
v_mul_f32 v66, v66, v203
v_add_f32 v30, 1.0, v30
v_fma_f32 v66, v66, v30, v10
v_mul_f32 v67, v67, v203
v_add_f32 v31, 1.0, v31
v_fma_f32 v67, v67, v31, v11
v_cvt_pk_bf16_f32 v208, v66, v67
ds_write_b32 v207, v208 offset:3072
v_mul_f32 v68, v68, v203
v_add_f32 v32, 1.0, v32
v_fma_f32 v68, v68, v32, v12
v_mul_f32 v69, v69, v203
v_add_f32 v33, 1.0, v33
v_fma_f32 v69, v69, v33, v13
v_cvt_pk_bf16_f32 v208, v68, v69
ds_write_b32 v207, v208 offset:4096
v_mul_f32 v70, v70, v203
v_add_f32 v34, 1.0, v34
v_fma_f32 v70, v70, v34, v14
v_mul_f32 v71, v71, v203
v_add_f32 v35, 1.0, v35
v_fma_f32 v71, v71, v35, v15
v_cvt_pk_bf16_f32 v208, v70, v71
ds_write_b32 v207, v208 offset:5120
v_mul_f32 v72, v72, v203
v_add_f32 v36, 1.0, v36
v_fma_f32 v72, v72, v36, v16
v_mul_f32 v73, v73, v203
v_add_f32 v37, 1.0, v37
v_fma_f32 v73, v73, v37, v17
v_cvt_pk_bf16_f32 v208, v72, v73
ds_write_b32 v207, v208 offset:6144
v_mul_f32 v74, v74, v203
v_add_f32 v38, 1.0, v38
v_fma_f32 v74, v74, v38, v18
v_mul_f32 v75, v75, v203
v_add_f32 v39, 1.0, v39
v_fma_f32 v75, v75, v39, v19
v_cvt_pk_bf16_f32 v208, v74, v75
ds_write_b32 v207, v208 offset:7168
v_mul_f32 v76, v76, v203
v_add_f32 v40, 1.0, v40
v_fma_f32 v76, v76, v40, v20
v_mul_f32 v77, v77, v203
v_add_f32 v41, 1.0, v41
v_fma_f32 v77, v77, v41, v21
v_cvt_pk_bf16_f32 v208, v76, v77
ds_write_b32 v207, v208 offset:8192
s_waitcnt lgkmcnt(0)
s_barrier
s_mov_b32 s30, 0x05040100
s_mov_b32 s31, 0x07060302
v_mul_u32_u24 v223, 288, v221
v_mov_b32 v4, 0
v_mov_b32 v5, 0
v_mov_b32 v6, 0
v_mov_b32 v7, 0
v_mov_b32 v8, 0
v_mov_b32 v9, 0
v_mov_b32 v10, 0
v_mov_b32 v11, 0
v_mov_b32 v12, 0
v_mov_b32 v13, 0
v_mov_b32 v14, 0
v_mov_b32 v15, 0
v_mov_b32 v16, 0
v_mov_b32 v17, 0
v_mov_b32 v18, 0
v_mov_b32 v19, 0
v_mov_b32 v20, 0
v_mov_b32 v21, 0
v_mov_b32 v22, 0
v_mov_b32 v23, 0
v_mov_b32 v24, 0
v_mov_b32 v25, 0
v_mov_b32 v26, 0
v_mov_b32 v27, 0
v_mov_b32 v28, 0
v_mov_b32 v29, 0
v_mov_b32 v30, 0
v_mov_b32 v31, 0
v_mov_b32 v32, 0
v_mov_b32 v33, 0
v_mov_b32 v34, 0
v_mov_b32 v35, 0
v_mov_b32 v36, 0
v_mov_b32 v37, 0
v_mov_b32 v38, 0
v_mov_b32 v39, 0
v_mov_b32 v40, 0
v_mov_b32 v41, 0
v_mov_b32 v42, 0
v_mov_b32 v43, 0
v_mov_b32 v44, 0
v_mov_b32 v45, 0
v_mov_b32 v46, 0
v_mov_b32 v47, 0
v_mov_b32 v48, 0
v_mov_b32 v49, 0
v_mov_b32 v50, 0
v_mov_b32 v51, 0
v_mov_b32 v52, 0
v_mov_b32 v53, 0
v_mov_b32 v54, 0
v_mov_b32 v55, 0
v_mov_b32 v56, 0
v_mov_b32 v57, 0
v_mov_b32 v58, 0
v_mov_b32 v59, 0
v_mov_b32 v60, 0
v_mov_b32 v61, 0
v_mov_b32 v62, 0
v_mov_b32 v63, 0
v_mov_b32 v64, 0
v_mov_b32 v65, 0
v_mov_b32 v66, 0
v_mov_b32 v67, 0
ds_read_b128 v[80:83], v223 offset:0
ds_read_b128 v[84:87], v223 offset:16
s_waitcnt vmcnt(16) lgkmcnt(0)
v_perm_b32 v90, v104, v100, s30
v_perm_b32 v91, v104, v100, s31
v_perm_b32 v92, v105, v101, s30
v_perm_b32 v93, v105, v101, s31
v_perm_b32 v94, v106, v102, s30
v_perm_b32 v95, v106, v102, s31
v_perm_b32 v96, v107, v103, s30
v_perm_b32 v97, v107, v103, s31
v_dot2_f32_bf16 v4, v90, v80, v4
v_dot2_f32_bf16 v5, v91, v80, v5
v_dot2_f32_bf16 v6, v92, v80, v6
v_dot2_f32_bf16 v7, v93, v80, v7
v_dot2_f32_bf16 v8, v94, v80, v8
v_dot2_f32_bf16 v9, v95, v80, v9
v_dot2_f32_bf16 v10, v96, v80, v10
v_dot2_f32_bf16 v11, v97, v80, v11
v_dot2_f32_bf16 v12, v90, v81, v12
v_dot2_f32_bf16 v13, v91, v81, v13
v_dot2_f32_bf16 v14, v92, v81, v14
v_dot2_f32_bf16 v15, v93, v81, v15
v_dot2_f32_bf16 v16, v94, v81, v16
v_dot2_f32_bf16 v17, v95, v81, v17
v_dot2_f32_bf16 v18, v96, v81, v18
v_dot2_f32_bf16 v19, v97, v81, v19
v_dot2_f32_bf16 v20, v90, v82, v20
v_dot2_f32_bf16 v21, v91, v82, v21
v_dot2_f32_bf16 v22, v92, v82, v22
v_dot2_f32_bf16 v23, v93, v82, v23
v_dot2_f32_bf16 v24, v94, v82, v24
v_dot2_f32_bf16 v25, v95, v82, v25
v_dot2_f32_bf16 v26, v96, v82, v26
v_dot2_f32_bf16 v27, v97, v82, v27
v_dot2_f32_bf16 v28, v90, v83, v28
v_dot2_f32_bf16 v29, v91, v83, v29
v_dot2_f32_bf16 v30, v92, v83, v30
v_dot2_f32_bf16 v31, v93, v83, v31
v_dot2_f32_bf16 v32, v94, v83, v32
v_dot2_f32_bf16 v33, v95, v83, v33
v_dot2_f32_bf16 v34, v96, v83, v34
v_dot2_f32_bf16 v35, v97, v83, v35
v_dot2_f32_bf16 v36, v90, v84, v36
v_dot2_f32_bf16 v37, v91, v84, v37
v_dot2_f32_bf16 v38, v92, v84, v38
v_dot2_f32_bf16 v39, v93, v84, v39
v_dot2_f32_bf16 v40, v94, v84, v40
v_dot2_f32_bf16 v41, v95, v84, v41
v_dot2_f32_bf16 v42, v96, v84, v42
v_dot2_f32_bf16 v43, v97, v84, v43
v_dot2_f32_bf16 v44, v90, v85, v44
v_dot2_f32_bf16 v45, v91, v85, v45
v_dot2_f32_bf16 v46, v92, v85, v46
v_dot2_f32_bf16 v47, v93, v85, v47
v_dot2_f32_bf16 v48, v94, v85, v48
v_dot2_f32_bf16 v49, v95, v85, v49
v_dot2_f32_bf16 v50, v96, v85, v50
v_dot2_f32_bf16 v51, v97, v85, v51
v_dot2_f32_bf16 v52, v90, v86, v52
v_dot2_f32_bf16 v53, v91, v86, v53
v_dot2_f32_bf16 v54, v92, v86, v54
v_dot2_f32_bf16 v55, v93, v86, v55
v_dot2_f32_bf16 v56, v94, v86, v56
v_dot2_f32_bf16 v57, v95, v86, v57
v_dot2_f32_bf16 v58, v96, v86, v58
v_dot2_f32_bf16 v59, v97, v86, v59
v_dot2_f32_bf16 v60, v90, v87, v60
v_dot2_f32_bf16 v61, v91, v87, v61
v_dot2_f32_bf16 v62, v92, v87, v62
v_dot2_f32_bf16 v63, v93, v87, v63
v_dot2_f32_bf16 v64, v94, v87, v64
v_dot2_f32_bf16 v65, v95, v87, v65
v_dot2_f32_bf16 v66, v96, v87, v66
v_dot2_f32_bf16 v67, v97, v87, v67
ds_read_b128 v[80:83], v223 offset:32
ds_read_b128 v[84:87], v223 offset:48
s_waitcnt vmcnt(14) lgkmcnt(0)
v_perm_b32 v90, v112, v108, s30
v_perm_b32 v91, v112, v108, s31
v_perm_b32 v92, v113, v109, s30
v_perm_b32 v93, v113, v109, s31
v_perm_b32 v94, v114, v110, s30
v_perm_b32 v95, v114, v110, s31
v_perm_b32 v96, v115, v111, s30
v_perm_b32 v97, v115, v111, s31
v_dot2_f32_bf16 v4, v90, v80, v4
v_dot2_f32_bf16 v5, v91, v80, v5
v_dot2_f32_bf16 v6, v92, v80, v6
v_dot2_f32_bf16 v7, v93, v80, v7
v_dot2_f32_bf16 v8, v94, v80, v8
v_dot2_f32_bf16 v9, v95, v80, v9
v_dot2_f32_bf16 v10, v96, v80, v10
v_dot2_f32_bf16 v11, v97, v80, v11
v_dot2_f32_bf16 v12, v90, v81, v12
v_dot2_f32_bf16 v13, v91, v81, v13
v_dot2_f32_bf16 v14, v92, v81, v14
v_dot2_f32_bf16 v15, v93, v81, v15
v_dot2_f32_bf16 v16, v94, v81, v16
v_dot2_f32_bf16 v17, v95, v81, v17
v_dot2_f32_bf16 v18, v96, v81, v18
v_dot2_f32_bf16 v19, v97, v81, v19
v_dot2_f32_bf16 v20, v90, v82, v20
v_dot2_f32_bf16 v21, v91, v82, v21
v_dot2_f32_bf16 v22, v92, v82, v22
v_dot2_f32_bf16 v23, v93, v82, v23
v_dot2_f32_bf16 v24, v94, v82, v24
v_dot2_f32_bf16 v25, v95, v82, v25
v_dot2_f32_bf16 v26, v96, v82, v26
v_dot2_f32_bf16 v27, v97, v82, v27
v_dot2_f32_bf16 v28, v90, v83, v28
v_dot2_f32_bf16 v29, v91, v83, v29
v_dot2_f32_bf16 v30, v92, v83, v30
v_dot2_f32_bf16 v31, v93, v83, v31
v_dot2_f32_bf16 v32, v94, v83, v32
v_dot2_f32_bf16 v33, v95, v83, v33
v_dot2_f32_bf16 v34, v96, v83, v34
v_dot2_f32_bf16 v35, v97, v83, v35
v_dot2_f32_bf16 v36, v90, v84, v36
v_dot2_f32_bf16 v37, v91, v84, v37
v_dot2_f32_bf16 v38, v92, v84, v38
v_dot2_f32_bf16 v39, v93, v84, v39
v_dot2_f32_bf16 v40, v94, v84, v40
v_dot2_f32_bf16 v41, v95, v84, v41
v_dot2_f32_bf16 v42, v96, v84, v42
v_dot2_f32_bf16 v43, v97, v84, v43
v_dot2_f32_bf16 v44, v90, v85, v44
v_dot2_f32_bf16 v45, v91, v85, v45
v_dot2_f32_bf16 v46, v92, v85, v46
v_dot2_f32_bf16 v47, v93, v85, v47
v_dot2_f32_bf16 v48, v94, v85, v48
v_dot2_f32_bf16 v49, v95, v85, v49
v_dot2_f32_bf16 v50, v96, v85, v50
v_dot2_f32_bf16 v51, v97, v85, v51
v_dot2_f32_bf16 v52, v90, v86, v52
v_dot2_f32_bf16 v53, v91, v86, v53
v_dot2_f32_bf16 v54, v92, v86, v54
v_dot2_f32_bf16 v55, v93, v86, v55
v_dot2_f32_bf16 v56, v94, v86, v56
v_dot2_f32_bf16 v57, v95, v86, v57
v_dot2_f32_bf16 v58, v96, v86, v58
v_dot2_f32_bf16 v59, v97, v86, v59
v_dot2_f32_bf16 v60, v90, v87, v60
v_dot2_f32_bf16 v61, v91, v87, v61
v_dot2_f32_bf16 v62, v92, v87, v62
v_dot2_f32_bf16 v63, v93, v87, v63
v_dot2_f32_bf16 v64, v94, v87, v64
v_dot2_f32_bf16 v65, v95, v87, v65
v_dot2_f32_bf16 v66, v96, v87, v66
v_dot2_f32_bf16 v67, v97, v87, v67
ds_read_b128 v[80:83], v223 offset:64
ds_read_b128 v[84:87], v223 offset:80
s_waitcnt vmcnt(12) lgkmcnt(0)
v_perm_b32 v90, v120, v116, s30
v_perm_b32 v91, v120, v116, s31
v_perm_b32 v92, v121, v117, s30
v_perm_b32 v93, v121, v117, s31
v_perm_b32 v94, v122, v118, s30
v_perm_b32 v95, v122, v118, s31
v_perm_b32 v96, v123, v119, s30
v_perm_b32 v97, v123, v119, s31
v_dot2_f32_bf16 v4, v90, v80, v4
v_dot2_f32_bf16 v5, v91, v80, v5
v_dot2_f32_bf16 v6, v92, v80, v6
v_dot2_f32_bf16 v7, v93, v80, v7
v_dot2_f32_bf16 v8, v94, v80, v8
v_dot2_f32_bf16 v9, v95, v80, v9
v_dot2_f32_bf16 v10, v96, v80, v10
v_dot2_f32_bf16 v11, v97, v80, v11
v_dot2_f32_bf16 v12, v90, v81, v12
v_dot2_f32_bf16 v13, v91, v81, v13
v_dot2_f32_bf16 v14, v92, v81, v14
v_dot2_f32_bf16 v15, v93, v81, v15
v_dot2_f32_bf16 v16, v94, v81, v16
v_dot2_f32_bf16 v17, v95, v81, v17
v_dot2_f32_bf16 v18, v96, v81, v18
v_dot2_f32_bf16 v19, v97, v81, v19
v_dot2_f32_bf16 v20, v90, v82, v20
v_dot2_f32_bf16 v21, v91, v82, v21
v_dot2_f32_bf16 v22, v92, v82, v22
v_dot2_f32_bf16 v23, v93, v82, v23
v_dot2_f32_bf16 v24, v94, v82, v24
v_dot2_f32_bf16 v25, v95, v82, v25
v_dot2_f32_bf16 v26, v96, v82, v26
v_dot2_f32_bf16 v27, v97, v82, v27
v_dot2_f32_bf16 v28, v90, v83, v28
v_dot2_f32_bf16 v29, v91, v83, v29
v_dot2_f32_bf16 v30, v92, v83, v30
v_dot2_f32_bf16 v31, v93, v83, v31
v_dot2_f32_bf16 v32, v94, v83, v32
v_dot2_f32_bf16 v33, v95, v83, v33
v_dot2_f32_bf16 v34, v96, v83, v34
v_dot2_f32_bf16 v35, v97, v83, v35
v_dot2_f32_bf16 v36, v90, v84, v36
v_dot2_f32_bf16 v37, v91, v84, v37
v_dot2_f32_bf16 v38, v92, v84, v38
v_dot2_f32_bf16 v39, v93, v84, v39
v_dot2_f32_bf16 v40, v94, v84, v40
v_dot2_f32_bf16 v41, v95, v84, v41
v_dot2_f32_bf16 v42, v96, v84, v42
v_dot2_f32_bf16 v43, v97, v84, v43
v_dot2_f32_bf16 v44, v90, v85, v44
v_dot2_f32_bf16 v45, v91, v85, v45
v_dot2_f32_bf16 v46, v92, v85, v46
v_dot2_f32_bf16 v47, v93, v85, v47
v_dot2_f32_bf16 v48, v94, v85, v48
v_dot2_f32_bf16 v49, v95, v85, v49
v_dot2_f32_bf16 v50, v96, v85, v50
v_dot2_f32_bf16 v51, v97, v85, v51
v_dot2_f32_bf16 v52, v90, v86, v52
v_dot2_f32_bf16 v53, v91, v86, v53
v_dot2_f32_bf16 v54, v92, v86, v54
v_dot2_f32_bf16 v55, v93, v86, v55
v_dot2_f32_bf16 v56, v94, v86, v56
v_dot2_f32_bf16 v57, v95, v86, v57
v_dot2_f32_bf16 v58, v96, v86, v58
v_dot2_f32_bf16 v59, v97, v86, v59
v_dot2_f32_bf16 v60, v90, v87, v60
v_dot2_f32_bf16 v61, v91, v87, v61
v_dot2_f32_bf16 v62, v92, v87, v62
v_dot2_f32_bf16 v63, v93, v87, v63
v_dot2_f32_bf16 v64, v94, v87, v64
v_dot2_f32_bf16 v65, v95, v87, v65
v_dot2_f32_bf16 v66, v96, v87, v66
v_dot2_f32_bf16 v67, v97, v87, v67
ds_read_b128 v[80:83], v223 offset:96
ds_read_b128 v[84:87], v223 offset:112
s_waitcnt vmcnt(10) lgkmcnt(0)
v_perm_b32 v90, v128, v124, s30
v_perm_b32 v91, v128, v124, s31
v_perm_b32 v92, v129, v125, s30
v_perm_b32 v93, v129, v125, s31
v_perm_b32 v94, v130, v126, s30
v_perm_b32 v95, v130, v126, s31
v_perm_b32 v96, v131, v127, s30
v_perm_b32 v97, v131, v127, s31
v_dot2_f32_bf16 v4, v90, v80, v4
v_dot2_f32_bf16 v5, v91, v80, v5
v_dot2_f32_bf16 v6, v92, v80, v6
v_dot2_f32_bf16 v7, v93, v80, v7
v_dot2_f32_bf16 v8, v94, v80, v8
v_dot2_f32_bf16 v9, v95, v80, v9
v_dot2_f32_bf16 v10, v96, v80, v10
v_dot2_f32_bf16 v11, v97, v80, v11
v_dot2_f32_bf16 v12, v90, v81, v12
v_dot2_f32_bf16 v13, v91, v81, v13
v_dot2_f32_bf16 v14, v92, v81, v14
v_dot2_f32_bf16 v15, v93, v81, v15
v_dot2_f32_bf16 v16, v94, v81, v16
v_dot2_f32_bf16 v17, v95, v81, v17
v_dot2_f32_bf16 v18, v96, v81, v18
v_dot2_f32_bf16 v19, v97, v81, v19
v_dot2_f32_bf16 v20, v90, v82, v20
v_dot2_f32_bf16 v21, v91, v82, v21
v_dot2_f32_bf16 v22, v92, v82, v22
v_dot2_f32_bf16 v23, v93, v82, v23
v_dot2_f32_bf16 v24, v94, v82, v24
v_dot2_f32_bf16 v25, v95, v82, v25
v_dot2_f32_bf16 v26, v96, v82, v26
v_dot2_f32_bf16 v27, v97, v82, v27
v_dot2_f32_bf16 v28, v90, v83, v28
v_dot2_f32_bf16 v29, v91, v83, v29
v_dot2_f32_bf16 v30, v92, v83, v30
v_dot2_f32_bf16 v31, v93, v83, v31
v_dot2_f32_bf16 v32, v94, v83, v32
v_dot2_f32_bf16 v33, v95, v83, v33
v_dot2_f32_bf16 v34, v96, v83, v34
v_dot2_f32_bf16 v35, v97, v83, v35
v_dot2_f32_bf16 v36, v90, v84, v36
v_dot2_f32_bf16 v37, v91, v84, v37
v_dot2_f32_bf16 v38, v92, v84, v38
v_dot2_f32_bf16 v39, v93, v84, v39
v_dot2_f32_bf16 v40, v94, v84, v40
v_dot2_f32_bf16 v41, v95, v84, v41
v_dot2_f32_bf16 v42, v96, v84, v42
v_dot2_f32_bf16 v43, v97, v84, v43
v_dot2_f32_bf16 v44, v90, v85, v44
v_dot2_f32_bf16 v45, v91, v85, v45
v_dot2_f32_bf16 v46, v92, v85, v46
v_dot2_f32_bf16 v47, v93, v85, v47
v_dot2_f32_bf16 v48, v94, v85, v48
v_dot2_f32_bf16 v49, v95, v85, v49
v_dot2_f32_bf16 v50, v96, v85, v50
v_dot2_f32_bf16 v51, v97, v85, v51
v_dot2_f32_bf16 v52, v90, v86, v52
v_dot2_f32_bf16 v53, v91, v86, v53
v_dot2_f32_bf16 v54, v92, v86, v54
v_dot2_f32_bf16 v55, v93, v86, v55
v_dot2_f32_bf16 v56, v94, v86, v56
v_dot2_f32_bf16 v57, v95, v86, v57
v_dot2_f32_bf16 v58, v96, v86, v58
v_dot2_f32_bf16 v59, v97, v86, v59
v_dot2_f32_bf16 v60, v90, v87, v60
v_dot2_f32_bf16 v61, v91, v87, v61
v_dot2_f32_bf16 v62, v92, v87, v62
v_dot2_f32_bf16 v63, v93, v87, v63
v_dot2_f32_bf16 v64, v94, v87, v64
v_dot2_f32_bf16 v65, v95, v87, v65
v_dot2_f32_bf16 v66, v96, v87, v66
v_dot2_f32_bf16 v67, v97, v87, v67
ds_read_b128 v[80:83], v223 offset:128
ds_read_b128 v[84:87], v223 offset:144
s_waitcnt vmcnt(8) lgkmcnt(0)
v_perm_b32 v90, v136, v132, s30
v_perm_b32 v91, v136, v132, s31
v_perm_b32 v92, v137, v133, s30
v_perm_b32 v93, v137, v133, s31
v_perm_b32 v94, v138, v134, s30
v_perm_b32 v95, v138, v134, s31
v_perm_b32 v96, v139, v135, s30
v_perm_b32 v97, v139, v135, s31
v_dot2_f32_bf16 v4, v90, v80, v4
v_dot2_f32_bf16 v5, v91, v80, v5
v_dot2_f32_bf16 v6, v92, v80, v6
v_dot2_f32_bf16 v7, v93, v80, v7
v_dot2_f32_bf16 v8, v94, v80, v8
v_dot2_f32_bf16 v9, v95, v80, v9
v_dot2_f32_bf16 v10, v96, v80, v10
v_dot2_f32_bf16 v11, v97, v80, v11
v_dot2_f32_bf16 v12, v90, v81, v12
v_dot2_f32_bf16 v13, v91, v81, v13
v_dot2_f32_bf16 v14, v92, v81, v14
v_dot2_f32_bf16 v15, v93, v81, v15
v_dot2_f32_bf16 v16, v94, v81, v16
v_dot2_f32_bf16 v17, v95, v81, v17
v_dot2_f32_bf16 v18, v96, v81, v18
v_dot2_f32_bf16 v19, v97, v81, v19
v_dot2_f32_bf16 v20, v90, v82, v20
v_dot2_f32_bf16 v21, v91, v82, v21
v_dot2_f32_bf16 v22, v92, v82, v22
v_dot2_f32_bf16 v23, v93, v82, v23
v_dot2_f32_bf16 v24, v94, v82, v24
v_dot2_f32_bf16 v25, v95, v82, v25
v_dot2_f32_bf16 v26, v96, v82, v26
v_dot2_f32_bf16 v27, v97, v82, v27
v_dot2_f32_bf16 v28, v90, v83, v28
v_dot2_f32_bf16 v29, v91, v83, v29
v_dot2_f32_bf16 v30, v92, v83, v30
v_dot2_f32_bf16 v31, v93, v83, v31
v_dot2_f32_bf16 v32, v94, v83, v32
v_dot2_f32_bf16 v33, v95, v83, v33
v_dot2_f32_bf16 v34, v96, v83, v34
v_dot2_f32_bf16 v35, v97, v83, v35
v_dot2_f32_bf16 v36, v90, v84, v36
v_dot2_f32_bf16 v37, v91, v84, v37
v_dot2_f32_bf16 v38, v92, v84, v38
v_dot2_f32_bf16 v39, v93, v84, v39
v_dot2_f32_bf16 v40, v94, v84, v40
v_dot2_f32_bf16 v41, v95, v84, v41
v_dot2_f32_bf16 v42, v96, v84, v42
v_dot2_f32_bf16 v43, v97, v84, v43
v_dot2_f32_bf16 v44, v90, v85, v44
v_dot2_f32_bf16 v45, v91, v85, v45
v_dot2_f32_bf16 v46, v92, v85, v46
v_dot2_f32_bf16 v47, v93, v85, v47
v_dot2_f32_bf16 v48, v94, v85, v48
v_dot2_f32_bf16 v49, v95, v85, v49
v_dot2_f32_bf16 v50, v96, v85, v50
v_dot2_f32_bf16 v51, v97, v85, v51
v_dot2_f32_bf16 v52, v90, v86, v52
v_dot2_f32_bf16 v53, v91, v86, v53
v_dot2_f32_bf16 v54, v92, v86, v54
v_dot2_f32_bf16 v55, v93, v86, v55
v_dot2_f32_bf16 v56, v94, v86, v56
v_dot2_f32_bf16 v57, v95, v86, v57
v_dot2_f32_bf16 v58, v96, v86, v58
v_dot2_f32_bf16 v59, v97, v86, v59
v_dot2_f32_bf16 v60, v90, v87, v60
v_dot2_f32_bf16 v61, v91, v87, v61
v_dot2_f32_bf16 v62, v92, v87, v62
v_dot2_f32_bf16 v63, v93, v87, v63
v_dot2_f32_bf16 v64, v94, v87, v64
v_dot2_f32_bf16 v65, v95, v87, v65
v_dot2_f32_bf16 v66, v96, v87, v66
v_dot2_f32_bf16 v67, v97, v87, v67
ds_read_b128 v[80:83], v223 offset:160
ds_read_b128 v[84:87], v223 offset:176
s_waitcnt vmcnt(6) lgkmcnt(0)
v_perm_b32 v90, v144, v140, s30
v_perm_b32 v91, v144, v140, s31
v_perm_b32 v92, v145, v141, s30
v_perm_b32 v93, v145, v141, s31
v_perm_b32 v94, v146, v142, s30
v_perm_b32 v95, v146, v142, s31
v_perm_b32 v96, v147, v143, s30
v_perm_b32 v97, v147, v143, s31
v_dot2_f32_bf16 v4, v90, v80, v4
v_dot2_f32_bf16 v5, v91, v80, v5
v_dot2_f32_bf16 v6, v92, v80, v6
v_dot2_f32_bf16 v7, v93, v80, v7
v_dot2_f32_bf16 v8, v94, v80, v8
v_dot2_f32_bf16 v9, v95, v80, v9
v_dot2_f32_bf16 v10, v96, v80, v10
v_dot2_f32_bf16 v11, v97, v80, v11
v_dot2_f32_bf16 v12, v90, v81, v12
v_dot2_f32_bf16 v13, v91, v81, v13
v_dot2_f32_bf16 v14, v92, v81, v14
v_dot2_f32_bf16 v15, v93, v81, v15
v_dot2_f32_bf16 v16, v94, v81, v16
v_dot2_f32_bf16 v17, v95, v81, v17
v_dot2_f32_bf16 v18, v96, v81, v18
v_dot2_f32_bf16 v19, v97, v81, v19
v_dot2_f32_bf16 v20, v90, v82, v20
v_dot2_f32_bf16 v21, v91, v82, v21
v_dot2_f32_bf16 v22, v92, v82, v22
v_dot2_f32_bf16 v23, v93, v82, v23
v_dot2_f32_bf16 v24, v94, v82, v24
v_dot2_f32_bf16 v25, v95, v82, v25
v_dot2_f32_bf16 v26, v96, v82, v26
v_dot2_f32_bf16 v27, v97, v82, v27
v_dot2_f32_bf16 v28, v90, v83, v28
v_dot2_f32_bf16 v29, v91, v83, v29
v_dot2_f32_bf16 v30, v92, v83, v30
v_dot2_f32_bf16 v31, v93, v83, v31
v_dot2_f32_bf16 v32, v94, v83, v32
v_dot2_f32_bf16 v33, v95, v83, v33
v_dot2_f32_bf16 v34, v96, v83, v34
v_dot2_f32_bf16 v35, v97, v83, v35
v_dot2_f32_bf16 v36, v90, v84, v36
v_dot2_f32_bf16 v37, v91, v84, v37
v_dot2_f32_bf16 v38, v92, v84, v38
v_dot2_f32_bf16 v39, v93, v84, v39
v_dot2_f32_bf16 v40, v94, v84, v40
v_dot2_f32_bf16 v41, v95, v84, v41
v_dot2_f32_bf16 v42, v96, v84, v42
v_dot2_f32_bf16 v43, v97, v84, v43
v_dot2_f32_bf16 v44, v90, v85, v44
v_dot2_f32_bf16 v45, v91, v85, v45
v_dot2_f32_bf16 v46, v92, v85, v46
v_dot2_f32_bf16 v47, v93, v85, v47
v_dot2_f32_bf16 v48, v94, v85, v48
v_dot2_f32_bf16 v49, v95, v85, v49
v_dot2_f32_bf16 v50, v96, v85, v50
v_dot2_f32_bf16 v51, v97, v85, v51
v_dot2_f32_bf16 v52, v90, v86, v52
v_dot2_f32_bf16 v53, v91, v86, v53
v_dot2_f32_bf16 v54, v92, v86, v54
v_dot2_f32_bf16 v55, v93, v86, v55
v_dot2_f32_bf16 v56, v94, v86, v56
v_dot2_f32_bf16 v57, v95, v86, v57
v_dot2_f32_bf16 v58, v96, v86, v58
v_dot2_f32_bf16 v59, v97, v86, v59
v_dot2_f32_bf16 v60, v90, v87, v60
v_dot2_f32_bf16 v61, v91, v87, v61
v_dot2_f32_bf16 v62, v92, v87, v62
v_dot2_f32_bf16 v63, v93, v87, v63
v_dot2_f32_bf16 v64, v94, v87, v64
v_dot2_f32_bf16 v65, v95, v87, v65
v_dot2_f32_bf16 v66, v96, v87, v66
v_dot2_f32_bf16 v67, v97, v87, v67
ds_read_b128 v[80:83], v223 offset:192
ds_read_b128 v[84:87], v223 offset:208
s_waitcnt vmcnt(4) lgkmcnt(0)
v_perm_b32 v90, v152, v148, s30
v_perm_b32 v91, v152, v148, s31
v_perm_b32 v92, v153, v149, s30
v_perm_b32 v93, v153, v149, s31
v_perm_b32 v94, v154, v150, s30
v_perm_b32 v95, v154, v150, s31
v_perm_b32 v96, v155, v151, s30
v_perm_b32 v97, v155, v151, s31
v_dot2_f32_bf16 v4, v90, v80, v4
v_dot2_f32_bf16 v5, v91, v80, v5
v_dot2_f32_bf16 v6, v92, v80, v6
v_dot2_f32_bf16 v7, v93, v80, v7
v_dot2_f32_bf16 v8, v94, v80, v8
v_dot2_f32_bf16 v9, v95, v80, v9
v_dot2_f32_bf16 v10, v96, v80, v10
v_dot2_f32_bf16 v11, v97, v80, v11
v_dot2_f32_bf16 v12, v90, v81, v12
v_dot2_f32_bf16 v13, v91, v81, v13
v_dot2_f32_bf16 v14, v92, v81, v14
v_dot2_f32_bf16 v15, v93, v81, v15
v_dot2_f32_bf16 v16, v94, v81, v16
v_dot2_f32_bf16 v17, v95, v81, v17
v_dot2_f32_bf16 v18, v96, v81, v18
v_dot2_f32_bf16 v19, v97, v81, v19
v_dot2_f32_bf16 v20, v90, v82, v20
v_dot2_f32_bf16 v21, v91, v82, v21
v_dot2_f32_bf16 v22, v92, v82, v22
v_dot2_f32_bf16 v23, v93, v82, v23
v_dot2_f32_bf16 v24, v94, v82, v24
v_dot2_f32_bf16 v25, v95, v82, v25
v_dot2_f32_bf16 v26, v96, v82, v26
v_dot2_f32_bf16 v27, v97, v82, v27
v_dot2_f32_bf16 v28, v90, v83, v28
v_dot2_f32_bf16 v29, v91, v83, v29
v_dot2_f32_bf16 v30, v92, v83, v30
v_dot2_f32_bf16 v31, v93, v83, v31
v_dot2_f32_bf16 v32, v94, v83, v32
v_dot2_f32_bf16 v33, v95, v83, v33
v_dot2_f32_bf16 v34, v96, v83, v34
v_dot2_f32_bf16 v35, v97, v83, v35
v_dot2_f32_bf16 v36, v90, v84, v36
v_dot2_f32_bf16 v37, v91, v84, v37
v_dot2_f32_bf16 v38, v92, v84, v38
v_dot2_f32_bf16 v39, v93, v84, v39
v_dot2_f32_bf16 v40, v94, v84, v40
v_dot2_f32_bf16 v41, v95, v84, v41
v_dot2_f32_bf16 v42, v96, v84, v42
v_dot2_f32_bf16 v43, v97, v84, v43
v_dot2_f32_bf16 v44, v90, v85, v44
v_dot2_f32_bf16 v45, v91, v85, v45
v_dot2_f32_bf16 v46, v92, v85, v46
v_dot2_f32_bf16 v47, v93, v85, v47
v_dot2_f32_bf16 v48, v94, v85, v48
v_dot2_f32_bf16 v49, v95, v85, v49
v_dot2_f32_bf16 v50, v96, v85, v50
v_dot2_f32_bf16 v51, v97, v85, v51
v_dot2_f32_bf16 v52, v90, v86, v52
v_dot2_f32_bf16 v53, v91, v86, v53
v_dot2_f32_bf16 v54, v92, v86, v54
v_dot2_f32_bf16 v55, v93, v86, v55
v_dot2_f32_bf16 v56, v94, v86, v56
v_dot2_f32_bf16 v57, v95, v86, v57
v_dot2_f32_bf16 v58, v96, v86, v58
v_dot2_f32_bf16 v59, v97, v86, v59
v_dot2_f32_bf16 v60, v90, v87, v60
v_dot2_f32_bf16 v61, v91, v87, v61
v_dot2_f32_bf16 v62, v92, v87, v62
v_dot2_f32_bf16 v63, v93, v87, v63
v_dot2_f32_bf16 v64, v94, v87, v64
v_dot2_f32_bf16 v65, v95, v87, v65
v_dot2_f32_bf16 v66, v96, v87, v66
v_dot2_f32_bf16 v67, v97, v87, v67
ds_read_b128 v[80:83], v223 offset:224
ds_read_b128 v[84:87], v223 offset:240
s_waitcnt vmcnt(2) lgkmcnt(0)
v_perm_b32 v90, v160, v156, s30
v_perm_b32 v91, v160, v156, s31
v_perm_b32 v92, v161, v157, s30
v_perm_b32 v93, v161, v157, s31
v_perm_b32 v94, v162, v158, s30
v_perm_b32 v95, v162, v158, s31
v_perm_b32 v96, v163, v159, s30
v_perm_b32 v97, v163, v159, s31
v_dot2_f32_bf16 v4, v90, v80, v4
v_dot2_f32_bf16 v5, v91, v80, v5
v_dot2_f32_bf16 v6, v92, v80, v6
v_dot2_f32_bf16 v7, v93, v80, v7
v_dot2_f32_bf16 v8, v94, v80, v8
v_dot2_f32_bf16 v9, v95, v80, v9
v_dot2_f32_bf16 v10, v96, v80, v10
v_dot2_f32_bf16 v11, v97, v80, v11
v_dot2_f32_bf16 v12, v90, v81, v12
v_dot2_f32_bf16 v13, v91, v81, v13
v_dot2_f32_bf16 v14, v92, v81, v14
v_dot2_f32_bf16 v15, v93, v81, v15
v_dot2_f32_bf16 v16, v94, v81, v16
v_dot2_f32_bf16 v17, v95, v81, v17
v_dot2_f32_bf16 v18, v96, v81, v18
v_dot2_f32_bf16 v19, v97, v81, v19
v_dot2_f32_bf16 v20, v90, v82, v20
v_dot2_f32_bf16 v21, v91, v82, v21
v_dot2_f32_bf16 v22, v92, v82, v22
v_dot2_f32_bf16 v23, v93, v82, v23
v_dot2_f32_bf16 v24, v94, v82, v24
v_dot2_f32_bf16 v25, v95, v82, v25
v_dot2_f32_bf16 v26, v96, v82, v26
v_dot2_f32_bf16 v27, v97, v82, v27
v_dot2_f32_bf16 v28, v90, v83, v28
v_dot2_f32_bf16 v29, v91, v83, v29
v_dot2_f32_bf16 v30, v92, v83, v30
v_dot2_f32_bf16 v31, v93, v83, v31
v_dot2_f32_bf16 v32, v94, v83, v32
v_dot2_f32_bf16 v33, v95, v83, v33
v_dot2_f32_bf16 v34, v96, v83, v34
v_dot2_f32_bf16 v35, v97, v83, v35
v_dot2_f32_bf16 v36, v90, v84, v36
v_dot2_f32_bf16 v37, v91, v84, v37
v_dot2_f32_bf16 v38, v92, v84, v38
v_dot2_f32_bf16 v39, v93, v84, v39
v_dot2_f32_bf16 v40, v94, v84, v40
v_dot2_f32_bf16 v41, v95, v84, v41
v_dot2_f32_bf16 v42, v96, v84, v42
v_dot2_f32_bf16 v43, v97, v84, v43
v_dot2_f32_bf16 v44, v90, v85, v44
v_dot2_f32_bf16 v45, v91, v85, v45
v_dot2_f32_bf16 v46, v92, v85, v46
v_dot2_f32_bf16 v47, v93, v85, v47
v_dot2_f32_bf16 v48, v94, v85, v48
v_dot2_f32_bf16 v49, v95, v85, v49
v_dot2_f32_bf16 v50, v96, v85, v50
v_dot2_f32_bf16 v51, v97, v85, v51
v_dot2_f32_bf16 v52, v90, v86, v52
v_dot2_f32_bf16 v53, v91, v86, v53
v_dot2_f32_bf16 v54, v92, v86, v54
v_dot2_f32_bf16 v55, v93, v86, v55
v_dot2_f32_bf16 v56, v94, v86, v56
v_dot2_f32_bf16 v57, v95, v86, v57
v_dot2_f32_bf16 v58, v96, v86, v58
v_dot2_f32_bf16 v59, v97, v86, v59
v_dot2_f32_bf16 v60, v90, v87, v60
v_dot2_f32_bf16 v61, v91, v87, v61
v_dot2_f32_bf16 v62, v92, v87, v62
v_dot2_f32_bf16 v63, v93, v87, v63
v_dot2_f32_bf16 v64, v94, v87, v64
v_dot2_f32_bf16 v65, v95, v87, v65
v_dot2_f32_bf16 v66, v96, v87, v66
v_dot2_f32_bf16 v67, v97, v87, v67
ds_read_b128 v[80:83], v223 offset:256
ds_read_b128 v[84:87], v223 offset:272
s_waitcnt vmcnt(0) lgkmcnt(0)
v_perm_b32 v90, v168, v164, s30
v_perm_b32 v91, v168, v164, s31
v_perm_b32 v92, v169, v165, s30
v_perm_b32 v93, v169, v165, s31
v_perm_b32 v94, v170, v166, s30
v_perm_b32 v95, v170, v166, s31
v_perm_b32 v96, v171, v167, s30
v_perm_b32 v97, v171, v167, s31
v_dot2_f32_bf16 v4, v90, v80, v4
v_dot2_f32_bf16 v5, v91, v80, v5
v_dot2_f32_bf16 v6, v92, v80, v6
v_dot2_f32_bf16 v7, v93, v80, v7
v_dot2_f32_bf16 v8, v94, v80, v8
v_dot2_f32_bf16 v9, v95, v80, v9
v_dot2_f32_bf16 v10, v96, v80, v10
v_dot2_f32_bf16 v11, v97, v80, v11
v_dot2_f32_bf16 v12, v90, v81, v12
v_dot2_f32_bf16 v13, v91, v81, v13
v_dot2_f32_bf16 v14, v92, v81, v14
v_dot2_f32_bf16 v15, v93, v81, v15
v_dot2_f32_bf16 v16, v94, v81, v16
v_dot2_f32_bf16 v17, v95, v81, v17
v_dot2_f32_bf16 v18, v96, v81, v18
v_dot2_f32_bf16 v19, v97, v81, v19
v_dot2_f32_bf16 v20, v90, v82, v20
v_dot2_f32_bf16 v21, v91, v82, v21
v_dot2_f32_bf16 v22, v92, v82, v22
v_dot2_f32_bf16 v23, v93, v82, v23
v_dot2_f32_bf16 v24, v94, v82, v24
v_dot2_f32_bf16 v25, v95, v82, v25
v_dot2_f32_bf16 v26, v96, v82, v26
v_dot2_f32_bf16 v27, v97, v82, v27
v_dot2_f32_bf16 v28, v90, v83, v28
v_dot2_f32_bf16 v29, v91, v83, v29
v_dot2_f32_bf16 v30, v92, v83, v30
v_dot2_f32_bf16 v31, v93, v83, v31
v_dot2_f32_bf16 v32, v94, v83, v32
v_dot2_f32_bf16 v33, v95, v83, v33
v_dot2_f32_bf16 v34, v96, v83, v34
v_dot2_f32_bf16 v35, v97, v83, v35
v_dot2_f32_bf16 v36, v90, v84, v36
v_dot2_f32_bf16 v37, v91, v84, v37
v_dot2_f32_bf16 v38, v92, v84, v38
v_dot2_f32_bf16 v39, v93, v84, v39
v_dot2_f32_bf16 v40, v94, v84, v40
v_dot2_f32_bf16 v41, v95, v84, v41
v_dot2_f32_bf16 v42, v96, v84, v42
v_dot2_f32_bf16 v43, v97, v84, v43
v_dot2_f32_bf16 v44, v90, v85, v44
v_dot2_f32_bf16 v45, v91, v85, v45
v_dot2_f32_bf16 v46, v92, v85, v46
v_dot2_f32_bf16 v47, v93, v85, v47
v_dot2_f32_bf16 v48, v94, v85, v48
v_dot2_f32_bf16 v49, v95, v85, v49
v_dot2_f32_bf16 v50, v96, v85, v50
v_dot2_f32_bf16 v51, v97, v85, v51
v_dot2_f32_bf16 v52, v90, v86, v52
v_dot2_f32_bf16 v53, v91, v86, v53
v_dot2_f32_bf16 v54, v92, v86, v54
v_dot2_f32_bf16 v55, v93, v86, v55
v_dot2_f32_bf16 v56, v94, v86, v56
v_dot2_f32_bf16 v57, v95, v86, v57
v_dot2_f32_bf16 v58, v96, v86, v58
v_dot2_f32_bf16 v59, v97, v86, v59
v_dot2_f32_bf16 v60, v90, v87, v60
v_dot2_f32_bf16 v61, v91, v87, v61
v_dot2_f32_bf16 v62, v92, v87, v62
v_dot2_f32_bf16 v63, v93, v87, v63
v_dot2_f32_bf16 v64, v94, v87, v64
v_dot2_f32_bf16 v65, v95, v87, v65
v_dot2_f32_bf16 v66, v96, v87, v66
v_dot2_f32_bf16 v67, v97, v87, v67
s_nop 4
v_lshlrev_b32 v225, 11, v221
v_lshl_add_u32 v225, v220, 5, v225
s_barrier
ds_write_b128 v225, v[4:7] offset:16384
ds_write_b128 v225, v[8:11] offset:16400
ds_write_b128 v225, v[12:15] offset:16640
ds_write_b128 v225, v[16:19] offset:16656
ds_write_b128 v225, v[20:23] offset:16896
ds_write_b128 v225, v[24:27] offset:16912
ds_write_b128 v225, v[28:31] offset:17152
ds_write_b128 v225, v[32:35] offset:17168
ds_write_b128 v225, v[36:39] offset:17408
ds_write_b128 v225, v[40:43] offset:17424
ds_write_b128 v225, v[44:47] offset:17664
ds_write_b128 v225, v[48:51] offset:17680
ds_write_b128 v225, v[52:55] offset:17920
ds_write_b128 v225, v[56:59] offset:17936
ds_write_b128 v225, v[60:63] offset:18176
ds_write_b128 v225, v[64:67] offset:18192
s_waitcnt lgkmcnt(0)
s_barrier
v_lshlrev_b32 v226, 3, v0
v_add_u32 v226, 16384, v226
ds_read_b64 v[4:5], v226 offset:0
ds_read_b64 v[6:7], v226 offset:2048
ds_read_b64 v[8:9], v226 offset:4096
ds_read_b64 v[10:11], v226 offset:6144
ds_read_b64 v[12:13], v226 offset:8192
ds_read_b64 v[14:15], v226 offset:10240
ds_read_b64 v[16:17], v226 offset:12288
ds_read_b64 v[18:19], v226 offset:14336
ds_read_b64 v[20:21], v226 offset:16384
ds_read_b64 v[22:23], v226 offset:18432
ds_read_b64 v[24:25], v226 offset:20480
ds_read_b64 v[26:27], v226 offset:22528
ds_read_b64 v[28:29], v226 offset:24576
ds_read_b64 v[30:31], v226 offset:26624
ds_read_b64 v[32:33], v226 offset:28672
ds_read_b64 v[34:35], v226 offset:30720
ds_read_b64 v[36:37], v226 offset:32768
ds_read_b64 v[38:39], v226 offset:34816
ds_read_b64 v[40:41], v226 offset:36864
ds_read_b64 v[42:43], v226 offset:38912
ds_read_b64 v[44:45], v226 offset:40960
ds_read_b64 v[46:47], v226 offset:43008
ds_read_b64 v[48:49], v226 offset:45056
ds_read_b64 v[50:51], v226 offset:47104
ds_read_b64 v[52:53], v226 offset:49152
ds_read_b64 v[54:55], v226 offset:51200
ds_read_b64 v[56:57], v226 offset:53248
ds_read_b64 v[58:59], v226 offset:55296
ds_read_b64 v[60:61], v226 offset:57344
ds_read_b64 v[62:63], v226 offset:59392
ds_read_b64 v[64:65], v226 offset:61440
ds_read_b64 v[66:67], v226 offset:63488
s_waitcnt lgkmcnt(0)
v_mov_b32 v210, 0
v_mov_b32 v211, 0
v_add_f32 v210, v210, v4
v_add_f32 v211, v211, v5
v_add_f32 v210, v210, v6
v_add_f32 v211, v211, v7
v_add_f32 v210, v210, v8
v_add_f32 v211, v211, v9
v_add_f32 v210, v210, v10
v_add_f32 v211, v211, v11
v_add_f32 v210, v210, v12
v_add_f32 v211, v211, v13
v_add_f32 v210, v210, v14
v_add_f32 v211, v211, v15
v_add_f32 v210, v210, v16
v_add_f32 v211, v211, v17
v_add_f32 v210, v210, v18
v_add_f32 v211, v211, v19
v_add_f32 v210, v210, v20
v_add_f32 v211, v211, v21
v_add_f32 v210, v210, v22
v_add_f32 v211, v211, v23
v_add_f32 v210, v210, v24
v_add_f32 v211, v211, v25
v_add_f32 v210, v210, v26
v_add_f32 v211, v211, v27
v_add_f32 v210, v210, v28
v_add_f32 v211, v211, v29
v_add_f32 v210, v210, v30
v_add_f32 v211, v211, v31
v_add_f32 v210, v210, v32
v_add_f32 v211, v211, v33
v_add_f32 v210, v210, v34
v_add_f32 v211, v211, v35
v_add_f32 v210, v210, v36
v_add_f32 v211, v211, v37
v_add_f32 v210, v210, v38
v_add_f32 v211, v211, v39
v_add_f32 v210, v210, v40
v_add_f32 v211, v211, v41
v_add_f32 v210, v210, v42
v_add_f32 v211, v211, v43
v_add_f32 v210, v210, v44
v_add_f32 v211, v211, v45
v_add_f32 v210, v210, v46
v_add_f32 v211, v211, v47
v_add_f32 v210, v210, v48
v_add_f32 v211, v211, v49
v_add_f32 v210, v210, v50
v_add_f32 v211, v211, v51
v_add_f32 v210, v210, v52
v_add_f32 v211, v211, v53
v_add_f32 v210, v210, v54
v_add_f32 v211, v211, v55
v_add_f32 v210, v210, v56
v_add_f32 v211, v211, v57
v_add_f32 v210, v210, v58
v_add_f32 v211, v211, v59
v_add_f32 v210, v210, v60
v_add_f32 v211, v211, v61
v_add_f32 v210, v210, v62
v_add_f32 v211, v211, v63
v_add_f32 v210, v210, v64
v_add_f32 v211, v211, v65
v_add_f32 v210, v210, v66
v_add_f32 v211, v211, v67
v_cvt_pk_bf16_f32 v210, v210, v211
v_lshlrev_b32 v204, 13, v200
v_lshl_add_u32 v204, v201, 2, v204
s_lshl_b32 s28, s2, 7
s_add_u32 s28, s28, 131072
buffer_store_dword v210, v204, s[24:27], s28 offen
k2_kernel_end:
s_endpgm
.globl k3_kernel
.p2align 8
.type k3_kernel,@function
k3_kernel:
s_cmp_ge_u32 s2, 512
s_cbranch_scc1 k3_kernel_end
s_load_dwordx2 s[8:9], s[0:1], 8
s_mov_b32 s10, 268435456
s_mov_b32 s11, 0x00020000
s_load_dwordx2 s[12:13], s[0:1], 16
s_mov_b32 s14, 268435456
s_mov_b32 s15, 0x00020000
s_load_dwordx2 s[24:25], s[0:1], 104
s_mov_b32 s26, 2097152
s_mov_b32 s27, 0x00020000
s_load_dwordx2 s[20:21], s[0:1], 96
s_mov_b32 s22, 256
s_mov_b32 s23, 0x00020000
v_lshrrev_b32 v1, 6, v0
s_nop 0
v_readfirstlane_b32 s3, v1
s_lshr_b32 s4, s2, 2
s_lshl_b32 s5, s2, 19
s_lshl_b32 s6, s3, 17
s_add_u32 s5, s5, s6
v_and_b32 v1, 63, v0
v_lshlrev_b32 v2, 4, v1
v_add_u32 v3, 4096, v2
v_and_b32 v4, 15, v0
v_lshlrev_b32 v4, 4, v4
s_lshl_b32 s6, s4, 9
s_add_u32 s6, s6, 131072
s_waitcnt lgkmcnt(0)
buffer_load_dwordx4 v[8:11], v4, s[24:27], s6 offen
buffer_load_dwordx4 v[12:15], v4, s[24:27], s6 offen offset:256
s_mov_b32 s30, 0x05040100
s_mov_b32 s31, 0x07060302
s_mov_b32 s7, 0x3e0293ee
v_mov_b32 v176, 0
v_mov_b32 v177, 0
v_mov_b32 v178, 0
v_mov_b32 v179, 0
v_mov_b32 v180, 0
v_mov_b32 v181, 0
v_mov_b32 v182, 0
v_mov_b32 v183, 0
v_mov_b32 v184, 0
v_mov_b32 v185, 0
v_mov_b32 v186, 0
v_mov_b32 v187, 0
v_mov_b32 v188, 0
v_mov_b32 v189, 0
v_mov_b32 v190, 0
v_mov_b32 v191, 0
v_mov_b32 v16, 0xf149f2ca
v_mov_b32 v17, 0xf149f2ca
v_mov_b32 v18, 0
v_mov_b32 v19, 0
buffer_load_dwordx4 v[32:35], v2, s[8:11], s5 offen offset:0 nt
buffer_load_dwordx4 v[36:39], v2, s[8:11], s5 offen offset:1024 nt
buffer_load_dwordx4 v[40:43], v2, s[8:11], s5 offen offset:2048 nt
buffer_load_dwordx4 v[44:47], v2, s[8:11], s5 offen offset:3072 nt
buffer_load_dwordx4 v[48:51], v3, s[8:11], s5 offen offset:0 nt
buffer_load_dwordx4 v[52:55], v3, s[8:11], s5 offen offset:1024 nt
buffer_load_dwordx4 v[56:59], v3, s[8:11], s5 offen offset:2048 nt
buffer_load_dwordx4 v[60:63], v3, s[8:11], s5 offen offset:3072 nt
buffer_load_dwordx4 v[96:99], v2, s[12:15], s5 offen offset:0 nt
buffer_load_dwordx4 v[100:103], v2, s[12:15], s5 offen offset:1024 nt
buffer_load_dwordx4 v[104:107], v2, s[12:15], s5 offen offset:2048 nt
buffer_load_dwordx4 v[108:111], v2, s[12:15], s5 offen offset:3072 nt
buffer_load_dwordx4 v[112:115], v3, s[12:15], s5 offen offset:0 nt
buffer_load_dwordx4 v[116:119], v3, s[12:15], s5 offen offset:1024 nt
buffer_load_dwordx4 v[120:123], v3, s[12:15], s5 offen offset:2048 nt
buffer_load_dwordx4 v[124:127], v3, s[12:15], s5 offen offset:3072 nt
s_add_u32 s5, s5, 8192
buffer_load_dwordx4 v[64:67], v2, s[8:11], s5 offen offset:0 nt
buffer_load_dwordx4 v[68:71], v2, s[8:11], s5 offen offset:1024 nt
buffer_load_dwordx4 v[72:75], v2, s[8:11], s5 offen offset:2048 nt
buffer_load_dwordx4 v[76:79], v2, s[8:11], s5 offen offset:3072 nt
buffer_load_dwordx4 v[80:83], v3, s[8:11], s5 offen offset:0 nt
buffer_load_dwordx4 v[84:87], v3, s[8:11], s5 offen offset:1024 nt
buffer_load_dwordx4 v[88:91], v3, s[8:11], s5 offen offset:2048 nt
buffer_load_dwordx4 v[92:95], v3, s[8:11], s5 offen offset:3072 nt
buffer_load_dwordx4 v[128:131], v2, s[12:15], s5 offen offset:0 nt
buffer_load_dwordx4 v[132:135], v2, s[12:15], s5 offen offset:1024 nt
buffer_load_dwordx4 v[136:139], v2, s[12:15], s5 offen offset:2048 nt
buffer_load_dwordx4 v[140:143], v2, s[12:15], s5 offen offset:3072 nt
buffer_load_dwordx4 v[144:147], v3, s[12:15], s5 offen offset:0 nt
buffer_load_dwordx4 v[148:151], v3, s[12:15], s5 offen offset:1024 nt
buffer_load_dwordx4 v[152:155], v3, s[12:15], s5 offen offset:2048 nt
buffer_load_dwordx4 v[156:159], v3, s[12:15], s5 offen offset:3072 nt
s_add_u32 s5, s5, 8192
s_mov_b32 s16, 0
k3_loop:
s_waitcnt vmcnt(24)
v_dot2_f32_bf16 v160, v32, v8, 0
v_dot2_f32_bf16 v161, v32, v12, 0
v_dot2_f32_bf16 v162, v36, v8, 0
v_dot2_f32_bf16 v163, v36, v12, 0
v_dot2_f32_bf16 v164, v40, v8, 0
v_dot2_f32_bf16 v165, v40, v12, 0
v_dot2_f32_bf16 v166, v44, v8, 0
v_dot2_f32_bf16 v167, v44, v12, 0
v_dot2_f32_bf16 v168, v48, v8, 0
v_dot2_f32_bf16 v169, v48, v12, 0
v_dot2_f32_bf16 v170, v52, v8, 0
v_dot2_f32_bf16 v171, v52, v12, 0
v_dot2_f32_bf16 v172, v56, v8, 0
v_dot2_f32_bf16 v173, v56, v12, 0
v_dot2_f32_bf16 v174, v60, v8, 0
v_dot2_f32_bf16 v175, v60, v12, 0
v_dot2_f32_bf16 v160, v33, v9, v160
v_dot2_f32_bf16 v161, v33, v13, v161
v_dot2_f32_bf16 v162, v37, v9, v162
v_dot2_f32_bf16 v163, v37, v13, v163
v_dot2_f32_bf16 v164, v41, v9, v164
v_dot2_f32_bf16 v165, v41, v13, v165
v_dot2_f32_bf16 v166, v45, v9, v166
v_dot2_f32_bf16 v167, v45, v13, v167
v_dot2_f32_bf16 v168, v49, v9, v168
v_dot2_f32_bf16 v169, v49, v13, v169
v_dot2_f32_bf16 v170, v53, v9, v170
v_dot2_f32_bf16 v171, v53, v13, v171
v_dot2_f32_bf16 v172, v57, v9, v172
v_dot2_f32_bf16 v173, v57, v13, v173
v_dot2_f32_bf16 v174, v61, v9, v174
v_dot2_f32_bf16 v175, v61, v13, v175
v_dot2_f32_bf16 v160, v34, v10, v160
v_dot2_f32_bf16 v161, v34, v14, v161
v_dot2_f32_bf16 v162, v38, v10, v162
v_dot2_f32_bf16 v163, v38, v14, v163
v_dot2_f32_bf16 v164, v42, v10, v164
v_dot2_f32_bf16 v165, v42, v14, v165
v_dot2_f32_bf16 v166, v46, v10, v166
v_dot2_f32_bf16 v167, v46, v14, v167
v_dot2_f32_bf16 v168, v50, v10, v168
v_dot2_f32_bf16 v169, v50, v14, v169
v_dot2_f32_bf16 v170, v54, v10, v170
v_dot2_f32_bf16 v171, v54, v14, v171
v_dot2_f32_bf16 v172, v58, v10, v172
v_dot2_f32_bf16 v173, v58, v14, v173
v_dot2_f32_bf16 v174, v62, v10, v174
v_dot2_f32_bf16 v175, v62, v14, v175
v_dot2_f32_bf16 v160, v35, v11, v160
v_dot2_f32_bf16 v161, v35, v15, v161
v_dot2_f32_bf16 v162, v39, v11, v162
v_dot2_f32_bf16 v163, v39, v15, v163
v_dot2_f32_bf16 v164, v43, v11, v164
v_dot2_f32_bf16 v165, v43, v15, v165
v_dot2_f32_bf16 v166, v47, v11, v166
v_dot2_f32_bf16 v167, v47, v15, v167
v_dot2_f32_bf16 v168, v51, v11, v168
v_dot2_f32_bf16 v169, v51, v15, v169
v_dot2_f32_bf16 v170, v55, v11, v170
v_dot2_f32_bf16 v171, v55, v15, v171
v_dot2_f32_bf16 v172, v59, v11, v172
v_dot2_f32_bf16 v173, v59, v15, v173
v_dot2_f32_bf16 v174, v63, v11, v174
v_dot2_f32_bf16 v175, v63, v15, v175
v_add_f32_dpp v160, v160, v160 row_ror:8 row_mask:0xf bank_mask:0xf
v_add_f32_dpp v161, v161, v161 row_ror:8 row_mask:0xf bank_mask:0xf
v_add_f32_dpp v162, v162, v162 row_ror:8 row_mask:0xf bank_mask:0xf
v_add_f32_dpp v163, v163, v163 row_ror:8 row_mask:0xf bank_mask:0xf
v_add_f32_dpp v164, v164, v164 row_ror:8 row_mask:0xf bank_mask:0xf
v_add_f32_dpp v165, v165, v165 row_ror:8 row_mask:0xf bank_mask:0xf
v_add_f32_dpp v166, v166, v166 row_ror:8 row_mask:0xf bank_mask:0xf
v_add_f32_dpp v167, v167, v167 row_ror:8 row_mask:0xf bank_mask:0xf
v_add_f32_dpp v168, v168, v168 row_ror:8 row_mask:0xf bank_mask:0xf
v_add_f32_dpp v169, v169, v169 row_ror:8 row_mask:0xf bank_mask:0xf
v_add_f32_dpp v170, v170, v170 row_ror:8 row_mask:0xf bank_mask:0xf
v_add_f32_dpp v171, v171, v171 row_ror:8 row_mask:0xf bank_mask:0xf
v_add_f32_dpp v172, v172, v172 row_ror:8 row_mask:0xf bank_mask:0xf
v_add_f32_dpp v173, v173, v173 row_ror:8 row_mask:0xf bank_mask:0xf
v_add_f32_dpp v174, v174, v174 row_ror:8 row_mask:0xf bank_mask:0xf
v_add_f32_dpp v175, v175, v175 row_ror:8 row_mask:0xf bank_mask:0xf
v_add_f32_dpp v160, v160, v160 row_ror:4 row_mask:0xf bank_mask:0xf
v_add_f32_dpp v161, v161, v161 row_ror:4 row_mask:0xf bank_mask:0xf
v_add_f32_dpp v162, v162, v162 row_ror:4 row_mask:0xf bank_mask:0xf
v_add_f32_dpp v163, v163, v163 row_ror:4 row_mask:0xf bank_mask:0xf
v_add_f32_dpp v164, v164, v164 row_ror:4 row_mask:0xf bank_mask:0xf
v_add_f32_dpp v165, v165, v165 row_ror:4 row_mask:0xf bank_mask:0xf
v_add_f32_dpp v166, v166, v166 row_ror:4 row_mask:0xf bank_mask:0xf
v_add_f32_dpp v167, v167, v167 row_ror:4 row_mask:0xf bank_mask:0xf
v_add_f32_dpp v168, v168, v168 row_ror:4 row_mask:0xf bank_mask:0xf
v_add_f32_dpp v169, v169, v169 row_ror:4 row_mask:0xf bank_mask:0xf
v_add_f32_dpp v170, v170, v170 row_ror:4 row_mask:0xf bank_mask:0xf
v_add_f32_dpp v171, v171, v171 row_ror:4 row_mask:0xf bank_mask:0xf
v_add_f32_dpp v172, v172, v172 row_ror:4 row_mask:0xf bank_mask:0xf
v_add_f32_dpp v173, v173, v173 row_ror:4 row_mask:0xf bank_mask:0xf
v_add_f32_dpp v174, v174, v174 row_ror:4 row_mask:0xf bank_mask:0xf
v_add_f32_dpp v175, v175, v175 row_ror:4 row_mask:0xf bank_mask:0xf
v_add_f32_dpp v160, v160, v160 row_ror:2 row_mask:0xf bank_mask:0xf
v_add_f32_dpp v161, v161, v161 row_ror:2 row_mask:0xf bank_mask:0xf
v_add_f32_dpp v162, v162, v162 row_ror:2 row_mask:0xf bank_mask:0xf
v_add_f32_dpp v163, v163, v163 row_ror:2 row_mask:0xf bank_mask:0xf
v_add_f32_dpp v164, v164, v164 row_ror:2 row_mask:0xf bank_mask:0xf
v_add_f32_dpp v165, v165, v165 row_ror:2 row_mask:0xf bank_mask:0xf
v_add_f32_dpp v166, v166, v166 row_ror:2 row_mask:0xf bank_mask:0xf
v_add_f32_dpp v167, v167, v167 row_ror:2 row_mask:0xf bank_mask:0xf
v_add_f32_dpp v168, v168, v168 row_ror:2 row_mask:0xf bank_mask:0xf
v_add_f32_dpp v169, v169, v169 row_ror:2 row_mask:0xf bank_mask:0xf
v_add_f32_dpp v170, v170, v170 row_ror:2 row_mask:0xf bank_mask:0xf
v_add_f32_dpp v171, v171, v171 row_ror:2 row_mask:0xf bank_mask:0xf
v_add_f32_dpp v172, v172, v172 row_ror:2 row_mask:0xf bank_mask:0xf
v_add_f32_dpp v173, v173, v173 row_ror:2 row_mask:0xf bank_mask:0xf
v_add_f32_dpp v174, v174, v174 row_ror:2 row_mask:0xf bank_mask:0xf
v_add_f32_dpp v175, v175, v175 row_ror:2 row_mask:0xf bank_mask:0xf
v_add_f32_dpp v160, v160, v160 row_ror:1 row_mask:0xf bank_mask:0xf
v_add_f32_dpp v161, v161, v161 row_ror:1 row_mask:0xf bank_mask:0xf
v_add_f32_dpp v162, v162, v162 row_ror:1 row_mask:0xf bank_mask:0xf
v_add_f32_dpp v163, v163, v163 row_ror:1 row_mask:0xf bank_mask:0xf
v_add_f32_dpp v164, v164, v164 row_ror:1 row_mask:0xf bank_mask:0xf
v_add_f32_dpp v165, v165, v165 row_ror:1 row_mask:0xf bank_mask:0xf
v_add_f32_dpp v166, v166, v166 row_ror:1 row_mask:0xf bank_mask:0xf
v_add_f32_dpp v167, v167, v167 row_ror:1 row_mask:0xf bank_mask:0xf
v_add_f32_dpp v168, v168, v168 row_ror:1 row_mask:0xf bank_mask:0xf
v_add_f32_dpp v169, v169, v169 row_ror:1 row_mask:0xf bank_mask:0xf
v_add_f32_dpp v170, v170, v170 row_ror:1 row_mask:0xf bank_mask:0xf
v_add_f32_dpp v171, v171, v171 row_ror:1 row_mask:0xf bank_mask:0xf
v_add_f32_dpp v172, v172, v172 row_ror:1 row_mask:0xf bank_mask:0xf
v_add_f32_dpp v173, v173, v173 row_ror:1 row_mask:0xf bank_mask:0xf
v_add_f32_dpp v174, v174, v174 row_ror:1 row_mask:0xf bank_mask:0xf
v_add_f32_dpp v175, v175, v175 row_ror:1 row_mask:0xf bank_mask:0xf
buffer_load_dwordx4 v[32:35], v2, s[8:11], s5 offen offset:0 nt
buffer_load_dwordx4 v[36:39], v2, s[8:11], s5 offen offset:1024 nt
buffer_load_dwordx4 v[40:43], v2, s[8:11], s5 offen offset:2048 nt
buffer_load_dwordx4 v[44:47], v2, s[8:11], s5 offen offset:3072 nt
buffer_load_dwordx4 v[48:51], v3, s[8:11], s5 offen offset:0 nt
buffer_load_dwordx4 v[52:55], v3, s[8:11], s5 offen offset:1024 nt
buffer_load_dwordx4 v[56:59], v3, s[8:11], s5 offen offset:2048 nt
buffer_load_dwordx4 v[60:63], v3, s[8:11], s5 offen offset:3072 nt
v_max3_f32 v20, v160, v162, v16
v_max3_f32 v20, v164, v166, v20
v_max3_f32 v20, v168, v170, v20
v_max3_f32 v20, v172, v174, v20
v_sub_f32 v21, v16, v20
v_mul_f32 v21, s7, v21
v_exp_f32 v21, v21
v_mov_b32 v16, v20
v_mul_f32 v22, s7, v20
v_fma_f32 v160, v160, s7, -v22
v_fma_f32 v162, v162, s7, -v22
v_fma_f32 v164, v164, s7, -v22
v_fma_f32 v166, v166, s7, -v22
v_fma_f32 v168, v168, s7, -v22
v_fma_f32 v170, v170, s7, -v22
v_fma_f32 v172, v172, s7, -v22
v_fma_f32 v174, v174, s7, -v22
v_exp_f32 v160, v160
v_exp_f32 v162, v162
v_exp_f32 v164, v164
v_exp_f32 v166, v166
v_exp_f32 v168, v168
v_exp_f32 v170, v170
v_exp_f32 v172, v172
v_exp_f32 v174, v174
v_mul_f32 v18, v18, v21
v_mul_f32 v176, v176, v21
v_mul_f32 v177, v177, v21
v_mul_f32 v178, v178, v21
v_mul_f32 v179, v179, v21
v_mul_f32 v180, v180, v21
v_mul_f32 v181, v181, v21
v_mul_f32 v182, v182, v21
v_mul_f32 v183, v183, v21
v_add_f32 v18, v18, v160
v_add_f32 v18, v18, v162
v_add_f32 v18, v18, v164
v_add_f32 v18, v18, v166
v_add_f32 v18, v18, v168
v_add_f32 v18, v18, v170
v_add_f32 v18, v18, v172
v_add_f32 v18, v18, v174
v_cvt_pk_bf16_f32 v192, v160, v162
v_cvt_pk_bf16_f32 v193, v164, v166
v_cvt_pk_bf16_f32 v194, v168, v170
v_cvt_pk_bf16_f32 v195, v172, v174
v_max3_f32 v20, v161, v163, v17
v_max3_f32 v20, v165, v167, v20
v_max3_f32 v20, v169, v171, v20
v_max3_f32 v20, v173, v175, v20
v_sub_f32 v21, v17, v20
v_mul_f32 v21, s7, v21
v_exp_f32 v21, v21
v_mov_b32 v17, v20
v_mul_f32 v22, s7, v20
v_fma_f32 v161, v161, s7, -v22
v_fma_f32 v163, v163, s7, -v22
v_fma_f32 v165, v165, s7, -v22
v_fma_f32 v167, v167, s7, -v22
v_fma_f32 v169, v169, s7, -v22
v_fma_f32 v171, v171, s7, -v22
v_fma_f32 v173, v173, s7, -v22
v_fma_f32 v175, v175, s7, -v22
v_exp_f32 v161, v161
v_exp_f32 v163, v163
v_exp_f32 v165, v165
v_exp_f32 v167, v167
v_exp_f32 v169, v169
v_exp_f32 v171, v171
v_exp_f32 v173, v173
v_exp_f32 v175, v175
v_mul_f32 v19, v19, v21
v_mul_f32 v184, v184, v21
v_mul_f32 v185, v185, v21
v_mul_f32 v186, v186, v21
v_mul_f32 v187, v187, v21
v_mul_f32 v188, v188, v21
v_mul_f32 v189, v189, v21
v_mul_f32 v190, v190, v21
v_mul_f32 v191, v191, v21
v_add_f32 v19, v19, v161
v_add_f32 v19, v19, v163
v_add_f32 v19, v19, v165
v_add_f32 v19, v19, v167
v_add_f32 v19, v19, v169
v_add_f32 v19, v19, v171
v_add_f32 v19, v19, v173
v_add_f32 v19, v19, v175
v_cvt_pk_bf16_f32 v196, v161, v163
v_cvt_pk_bf16_f32 v197, v165, v167
v_cvt_pk_bf16_f32 v198, v169, v171
v_cvt_pk_bf16_f32 v199, v173, v175
s_waitcnt vmcnt(24)
v_perm_b32 v24, v100, v96, s30
v_perm_b32 v25, v100, v96, s31
v_perm_b32 v26, v101, v97, s30
v_perm_b32 v27, v101, v97, s31
v_perm_b32 v28, v102, v98, s30
v_perm_b32 v29, v102, v98, s31
v_perm_b32 v30, v103, v99, s30
v_perm_b32 v31, v103, v99, s31
v_dot2_f32_bf16 v176, v24, v192, v176
v_dot2_f32_bf16 v177, v25, v192, v177
v_dot2_f32_bf16 v178, v26, v192, v178
v_dot2_f32_bf16 v179, v27, v192, v179
v_dot2_f32_bf16 v180, v28, v192, v180
v_dot2_f32_bf16 v181, v29, v192, v181
v_dot2_f32_bf16 v182, v30, v192, v182
v_dot2_f32_bf16 v183, v31, v192, v183
v_dot2_f32_bf16 v184, v24, v196, v184
v_dot2_f32_bf16 v185, v25, v196, v185
v_dot2_f32_bf16 v186, v26, v196, v186
v_dot2_f32_bf16 v187, v27, v196, v187
v_dot2_f32_bf16 v188, v28, v196, v188
v_dot2_f32_bf16 v189, v29, v196, v189
v_dot2_f32_bf16 v190, v30, v196, v190
v_dot2_f32_bf16 v191, v31, v196, v191
v_perm_b32 v24, v108, v104, s30
v_perm_b32 v25, v108, v104, s31
v_perm_b32 v26, v109, v105, s30
v_perm_b32 v27, v109, v105, s31
v_perm_b32 v28, v110, v106, s30
v_perm_b32 v29, v110, v106, s31
v_perm_b32 v30, v111, v107, s30
v_perm_b32 v31, v111, v107, s31
v_dot2_f32_bf16 v176, v24, v193, v176
v_dot2_f32_bf16 v177, v25, v193, v177
v_dot2_f32_bf16 v178, v26, v193, v178
v_dot2_f32_bf16 v179, v27, v193, v179
v_dot2_f32_bf16 v180, v28, v193, v180
v_dot2_f32_bf16 v181, v29, v193, v181
v_dot2_f32_bf16 v182, v30, v193, v182
v_dot2_f32_bf16 v183, v31, v193, v183
v_dot2_f32_bf16 v184, v24, v197, v184
v_dot2_f32_bf16 v185, v25, v197, v185
v_dot2_f32_bf16 v186, v26, v197, v186
v_dot2_f32_bf16 v187, v27, v197, v187
v_dot2_f32_bf16 v188, v28, v197, v188
v_dot2_f32_bf16 v189, v29, v197, v189
v_dot2_f32_bf16 v190, v30, v197, v190
v_dot2_f32_bf16 v191, v31, v197, v191
v_perm_b32 v24, v116, v112, s30
v_perm_b32 v25, v116, v112, s31
v_perm_b32 v26, v117, v113, s30
v_perm_b32 v27, v117, v113, s31
v_perm_b32 v28, v118, v114, s30
v_perm_b32 v29, v118, v114, s31
v_perm_b32 v30, v119, v115, s30
v_perm_b32 v31, v119, v115, s31
v_dot2_f32_bf16 v176, v24, v194, v176
v_dot2_f32_bf16 v177, v25, v194, v177
v_dot2_f32_bf16 v178, v26, v194, v178
v_dot2_f32_bf16 v179, v27, v194, v179
v_dot2_f32_bf16 v180, v28, v194, v180
v_dot2_f32_bf16 v181, v29, v194, v181
v_dot2_f32_bf16 v182, v30, v194, v182
v_dot2_f32_bf16 v183, v31, v194, v183
v_dot2_f32_bf16 v184, v24, v198, v184
v_dot2_f32_bf16 v185, v25, v198, v185
v_dot2_f32_bf16 v186, v26, v198, v186
v_dot2_f32_bf16 v187, v27, v198, v187
v_dot2_f32_bf16 v188, v28, v198, v188
v_dot2_f32_bf16 v189, v29, v198, v189
v_dot2_f32_bf16 v190, v30, v198, v190
v_dot2_f32_bf16 v191, v31, v198, v191
v_perm_b32 v24, v124, v120, s30
v_perm_b32 v25, v124, v120, s31
v_perm_b32 v26, v125, v121, s30
v_perm_b32 v27, v125, v121, s31
v_perm_b32 v28, v126, v122, s30
v_perm_b32 v29, v126, v122, s31
v_perm_b32 v30, v127, v123, s30
v_perm_b32 v31, v127, v123, s31
v_dot2_f32_bf16 v176, v24, v195, v176
v_dot2_f32_bf16 v177, v25, v195, v177
v_dot2_f32_bf16 v178, v26, v195, v178
v_dot2_f32_bf16 v179, v27, v195, v179
v_dot2_f32_bf16 v180, v28, v195, v180
v_dot2_f32_bf16 v181, v29, v195, v181
v_dot2_f32_bf16 v182, v30, v195, v182
v_dot2_f32_bf16 v183, v31, v195, v183
v_dot2_f32_bf16 v184, v24, v199, v184
v_dot2_f32_bf16 v185, v25, v199, v185
v_dot2_f32_bf16 v186, v26, v199, v186
v_dot2_f32_bf16 v187, v27, v199, v187
v_dot2_f32_bf16 v188, v28, v199, v188
v_dot2_f32_bf16 v189, v29, v199, v189
v_dot2_f32_bf16 v190, v30, v199, v190
v_dot2_f32_bf16 v191, v31, v199, v191
buffer_load_dwordx4 v[96:99], v2, s[12:15], s5 offen offset:0 nt
buffer_load_dwordx4 v[100:103], v2, s[12:15], s5 offen offset:1024 nt
buffer_load_dwordx4 v[104:107], v2, s[12:15], s5 offen offset:2048 nt
buffer_load_dwordx4 v[108:111], v2, s[12:15], s5 offen offset:3072 nt
buffer_load_dwordx4 v[112:115], v3, s[12:15], s5 offen offset:0 nt
buffer_load_dwordx4 v[116:119], v3, s[12:15], s5 offen offset:1024 nt
buffer_load_dwordx4 v[120:123], v3, s[12:15], s5 offen offset:2048 nt
buffer_load_dwordx4 v[124:127], v3, s[12:15], s5 offen offset:3072 nt
s_add_u32 s5, s5, 8192
s_waitcnt vmcnt(24)
v_dot2_f32_bf16 v160, v64, v8, 0
v_dot2_f32_bf16 v161, v64, v12, 0
v_dot2_f32_bf16 v162, v68, v8, 0
v_dot2_f32_bf16 v163, v68, v12, 0
v_dot2_f32_bf16 v164, v72, v8, 0
v_dot2_f32_bf16 v165, v72, v12, 0
v_dot2_f32_bf16 v166, v76, v8, 0
v_dot2_f32_bf16 v167, v76, v12, 0
v_dot2_f32_bf16 v168, v80, v8, 0
v_dot2_f32_bf16 v169, v80, v12, 0
v_dot2_f32_bf16 v170, v84, v8, 0
v_dot2_f32_bf16 v171, v84, v12, 0
v_dot2_f32_bf16 v172, v88, v8, 0
v_dot2_f32_bf16 v173, v88, v12, 0
v_dot2_f32_bf16 v174, v92, v8, 0
v_dot2_f32_bf16 v175, v92, v12, 0
v_dot2_f32_bf16 v160, v65, v9, v160
v_dot2_f32_bf16 v161, v65, v13, v161
v_dot2_f32_bf16 v162, v69, v9, v162
v_dot2_f32_bf16 v163, v69, v13, v163
v_dot2_f32_bf16 v164, v73, v9, v164
v_dot2_f32_bf16 v165, v73, v13, v165
v_dot2_f32_bf16 v166, v77, v9, v166
v_dot2_f32_bf16 v167, v77, v13, v167
v_dot2_f32_bf16 v168, v81, v9, v168
v_dot2_f32_bf16 v169, v81, v13, v169
v_dot2_f32_bf16 v170, v85, v9, v170
v_dot2_f32_bf16 v171, v85, v13, v171
v_dot2_f32_bf16 v172, v89, v9, v172
v_dot2_f32_bf16 v173, v89, v13, v173
v_dot2_f32_bf16 v174, v93, v9, v174
v_dot2_f32_bf16 v175, v93, v13, v175
v_dot2_f32_bf16 v160, v66, v10, v160
v_dot2_f32_bf16 v161, v66, v14, v161
v_dot2_f32_bf16 v162, v70, v10, v162
v_dot2_f32_bf16 v163, v70, v14, v163
v_dot2_f32_bf16 v164, v74, v10, v164
v_dot2_f32_bf16 v165, v74, v14, v165
v_dot2_f32_bf16 v166, v78, v10, v166
v_dot2_f32_bf16 v167, v78, v14, v167
v_dot2_f32_bf16 v168, v82, v10, v168
v_dot2_f32_bf16 v169, v82, v14, v169
v_dot2_f32_bf16 v170, v86, v10, v170
v_dot2_f32_bf16 v171, v86, v14, v171
v_dot2_f32_bf16 v172, v90, v10, v172
v_dot2_f32_bf16 v173, v90, v14, v173
v_dot2_f32_bf16 v174, v94, v10, v174
v_dot2_f32_bf16 v175, v94, v14, v175
v_dot2_f32_bf16 v160, v67, v11, v160
v_dot2_f32_bf16 v161, v67, v15, v161
v_dot2_f32_bf16 v162, v71, v11, v162
v_dot2_f32_bf16 v163, v71, v15, v163
v_dot2_f32_bf16 v164, v75, v11, v164
v_dot2_f32_bf16 v165, v75, v15, v165
v_dot2_f32_bf16 v166, v79, v11, v166
v_dot2_f32_bf16 v167, v79, v15, v167
v_dot2_f32_bf16 v168, v83, v11, v168
v_dot2_f32_bf16 v169, v83, v15, v169
v_dot2_f32_bf16 v170, v87, v11, v170
v_dot2_f32_bf16 v171, v87, v15, v171
v_dot2_f32_bf16 v172, v91, v11, v172
v_dot2_f32_bf16 v173, v91, v15, v173
v_dot2_f32_bf16 v174, v95, v11, v174
v_dot2_f32_bf16 v175, v95, v15, v175
v_add_f32_dpp v160, v160, v160 row_ror:8 row_mask:0xf bank_mask:0xf
v_add_f32_dpp v161, v161, v161 row_ror:8 row_mask:0xf bank_mask:0xf
v_add_f32_dpp v162, v162, v162 row_ror:8 row_mask:0xf bank_mask:0xf
v_add_f32_dpp v163, v163, v163 row_ror:8 row_mask:0xf bank_mask:0xf
v_add_f32_dpp v164, v164, v164 row_ror:8 row_mask:0xf bank_mask:0xf
v_add_f32_dpp v165, v165, v165 row_ror:8 row_mask:0xf bank_mask:0xf
v_add_f32_dpp v166, v166, v166 row_ror:8 row_mask:0xf bank_mask:0xf
v_add_f32_dpp v167, v167, v167 row_ror:8 row_mask:0xf bank_mask:0xf
v_add_f32_dpp v168, v168, v168 row_ror:8 row_mask:0xf bank_mask:0xf
v_add_f32_dpp v169, v169, v169 row_ror:8 row_mask:0xf bank_mask:0xf
v_add_f32_dpp v170, v170, v170 row_ror:8 row_mask:0xf bank_mask:0xf
v_add_f32_dpp v171, v171, v171 row_ror:8 row_mask:0xf bank_mask:0xf
v_add_f32_dpp v172, v172, v172 row_ror:8 row_mask:0xf bank_mask:0xf
v_add_f32_dpp v173, v173, v173 row_ror:8 row_mask:0xf bank_mask:0xf
v_add_f32_dpp v174, v174, v174 row_ror:8 row_mask:0xf bank_mask:0xf
v_add_f32_dpp v175, v175, v175 row_ror:8 row_mask:0xf bank_mask:0xf
v_add_f32_dpp v160, v160, v160 row_ror:4 row_mask:0xf bank_mask:0xf
v_add_f32_dpp v161, v161, v161 row_ror:4 row_mask:0xf bank_mask:0xf
v_add_f32_dpp v162, v162, v162 row_ror:4 row_mask:0xf bank_mask:0xf
v_add_f32_dpp v163, v163, v163 row_ror:4 row_mask:0xf bank_mask:0xf
v_add_f32_dpp v164, v164, v164 row_ror:4 row_mask:0xf bank_mask:0xf
v_add_f32_dpp v165, v165, v165 row_ror:4 row_mask:0xf bank_mask:0xf
v_add_f32_dpp v166, v166, v166 row_ror:4 row_mask:0xf bank_mask:0xf
v_add_f32_dpp v167, v167, v167 row_ror:4 row_mask:0xf bank_mask:0xf
v_add_f32_dpp v168, v168, v168 row_ror:4 row_mask:0xf bank_mask:0xf
v_add_f32_dpp v169, v169, v169 row_ror:4 row_mask:0xf bank_mask:0xf
v_add_f32_dpp v170, v170, v170 row_ror:4 row_mask:0xf bank_mask:0xf
v_add_f32_dpp v171, v171, v171 row_ror:4 row_mask:0xf bank_mask:0xf
v_add_f32_dpp v172, v172, v172 row_ror:4 row_mask:0xf bank_mask:0xf
v_add_f32_dpp v173, v173, v173 row_ror:4 row_mask:0xf bank_mask:0xf
v_add_f32_dpp v174, v174, v174 row_ror:4 row_mask:0xf bank_mask:0xf
v_add_f32_dpp v175, v175, v175 row_ror:4 row_mask:0xf bank_mask:0xf
v_add_f32_dpp v160, v160, v160 row_ror:2 row_mask:0xf bank_mask:0xf
v_add_f32_dpp v161, v161, v161 row_ror:2 row_mask:0xf bank_mask:0xf
v_add_f32_dpp v162, v162, v162 row_ror:2 row_mask:0xf bank_mask:0xf
v_add_f32_dpp v163, v163, v163 row_ror:2 row_mask:0xf bank_mask:0xf
v_add_f32_dpp v164, v164, v164 row_ror:2 row_mask:0xf bank_mask:0xf
v_add_f32_dpp v165, v165, v165 row_ror:2 row_mask:0xf bank_mask:0xf
v_add_f32_dpp v166, v166, v166 row_ror:2 row_mask:0xf bank_mask:0xf
v_add_f32_dpp v167, v167, v167 row_ror:2 row_mask:0xf bank_mask:0xf
v_add_f32_dpp v168, v168, v168 row_ror:2 row_mask:0xf bank_mask:0xf
v_add_f32_dpp v169, v169, v169 row_ror:2 row_mask:0xf bank_mask:0xf
v_add_f32_dpp v170, v170, v170 row_ror:2 row_mask:0xf bank_mask:0xf
v_add_f32_dpp v171, v171, v171 row_ror:2 row_mask:0xf bank_mask:0xf
v_add_f32_dpp v172, v172, v172 row_ror:2 row_mask:0xf bank_mask:0xf
v_add_f32_dpp v173, v173, v173 row_ror:2 row_mask:0xf bank_mask:0xf
v_add_f32_dpp v174, v174, v174 row_ror:2 row_mask:0xf bank_mask:0xf
v_add_f32_dpp v175, v175, v175 row_ror:2 row_mask:0xf bank_mask:0xf
v_add_f32_dpp v160, v160, v160 row_ror:1 row_mask:0xf bank_mask:0xf
v_add_f32_dpp v161, v161, v161 row_ror:1 row_mask:0xf bank_mask:0xf
v_add_f32_dpp v162, v162, v162 row_ror:1 row_mask:0xf bank_mask:0xf
v_add_f32_dpp v163, v163, v163 row_ror:1 row_mask:0xf bank_mask:0xf
v_add_f32_dpp v164, v164, v164 row_ror:1 row_mask:0xf bank_mask:0xf
v_add_f32_dpp v165, v165, v165 row_ror:1 row_mask:0xf bank_mask:0xf
v_add_f32_dpp v166, v166, v166 row_ror:1 row_mask:0xf bank_mask:0xf
v_add_f32_dpp v167, v167, v167 row_ror:1 row_mask:0xf bank_mask:0xf
v_add_f32_dpp v168, v168, v168 row_ror:1 row_mask:0xf bank_mask:0xf
v_add_f32_dpp v169, v169, v169 row_ror:1 row_mask:0xf bank_mask:0xf
v_add_f32_dpp v170, v170, v170 row_ror:1 row_mask:0xf bank_mask:0xf
v_add_f32_dpp v171, v171, v171 row_ror:1 row_mask:0xf bank_mask:0xf
v_add_f32_dpp v172, v172, v172 row_ror:1 row_mask:0xf bank_mask:0xf
v_add_f32_dpp v173, v173, v173 row_ror:1 row_mask:0xf bank_mask:0xf
v_add_f32_dpp v174, v174, v174 row_ror:1 row_mask:0xf bank_mask:0xf
v_add_f32_dpp v175, v175, v175 row_ror:1 row_mask:0xf bank_mask:0xf
buffer_load_dwordx4 v[64:67], v2, s[8:11], s5 offen offset:0 nt
buffer_load_dwordx4 v[68:71], v2, s[8:11], s5 offen offset:1024 nt
buffer_load_dwordx4 v[72:75], v2, s[8:11], s5 offen offset:2048 nt
buffer_load_dwordx4 v[76:79], v2, s[8:11], s5 offen offset:3072 nt
buffer_load_dwordx4 v[80:83], v3, s[8:11], s5 offen offset:0 nt
buffer_load_dwordx4 v[84:87], v3, s[8:11], s5 offen offset:1024 nt
buffer_load_dwordx4 v[88:91], v3, s[8:11], s5 offen offset:2048 nt
buffer_load_dwordx4 v[92:95], v3, s[8:11], s5 offen offset:3072 nt
v_max3_f32 v20, v160, v162, v16
v_max3_f32 v20, v164, v166, v20
v_max3_f32 v20, v168, v170, v20
v_max3_f32 v20, v172, v174, v20
v_sub_f32 v21, v16, v20
v_mul_f32 v21, s7, v21
v_exp_f32 v21, v21
v_mov_b32 v16, v20
v_mul_f32 v22, s7, v20
v_fma_f32 v160, v160, s7, -v22
v_fma_f32 v162, v162, s7, -v22
v_fma_f32 v164, v164, s7, -v22
v_fma_f32 v166, v166, s7, -v22
v_fma_f32 v168, v168, s7, -v22
v_fma_f32 v170, v170, s7, -v22
v_fma_f32 v172, v172, s7, -v22
v_fma_f32 v174, v174, s7, -v22
v_exp_f32 v160, v160
v_exp_f32 v162, v162
v_exp_f32 v164, v164
v_exp_f32 v166, v166
v_exp_f32 v168, v168
v_exp_f32 v170, v170
v_exp_f32 v172, v172
v_exp_f32 v174, v174
v_mul_f32 v18, v18, v21
v_mul_f32 v176, v176, v21
v_mul_f32 v177, v177, v21
v_mul_f32 v178, v178, v21
v_mul_f32 v179, v179, v21
v_mul_f32 v180, v180, v21
v_mul_f32 v181, v181, v21
v_mul_f32 v182, v182, v21
v_mul_f32 v183, v183, v21
v_add_f32 v18, v18, v160
v_add_f32 v18, v18, v162
v_add_f32 v18, v18, v164
v_add_f32 v18, v18, v166
v_add_f32 v18, v18, v168
v_add_f32 v18, v18, v170
v_add_f32 v18, v18, v172
v_add_f32 v18, v18, v174
v_cvt_pk_bf16_f32 v192, v160, v162
v_cvt_pk_bf16_f32 v193, v164, v166
v_cvt_pk_bf16_f32 v194, v168, v170
v_cvt_pk_bf16_f32 v195, v172, v174
v_max3_f32 v20, v161, v163, v17
v_max3_f32 v20, v165, v167, v20
v_max3_f32 v20, v169, v171, v20
v_max3_f32 v20, v173, v175, v20
v_sub_f32 v21, v17, v20
v_mul_f32 v21, s7, v21
v_exp_f32 v21, v21
v_mov_b32 v17, v20
v_mul_f32 v22, s7, v20
v_fma_f32 v161, v161, s7, -v22
v_fma_f32 v163, v163, s7, -v22
v_fma_f32 v165, v165, s7, -v22
v_fma_f32 v167, v167, s7, -v22
v_fma_f32 v169, v169, s7, -v22
v_fma_f32 v171, v171, s7, -v22
v_fma_f32 v173, v173, s7, -v22
v_fma_f32 v175, v175, s7, -v22
v_exp_f32 v161, v161
v_exp_f32 v163, v163
v_exp_f32 v165, v165
v_exp_f32 v167, v167
v_exp_f32 v169, v169
v_exp_f32 v171, v171
v_exp_f32 v173, v173
v_exp_f32 v175, v175
v_mul_f32 v19, v19, v21
v_mul_f32 v184, v184, v21
v_mul_f32 v185, v185, v21
v_mul_f32 v186, v186, v21
v_mul_f32 v187, v187, v21
v_mul_f32 v188, v188, v21
v_mul_f32 v189, v189, v21
v_mul_f32 v190, v190, v21
v_mul_f32 v191, v191, v21
v_add_f32 v19, v19, v161
v_add_f32 v19, v19, v163
v_add_f32 v19, v19, v165
v_add_f32 v19, v19, v167
v_add_f32 v19, v19, v169
v_add_f32 v19, v19, v171
v_add_f32 v19, v19, v173
v_add_f32 v19, v19, v175
v_cvt_pk_bf16_f32 v196, v161, v163
v_cvt_pk_bf16_f32 v197, v165, v167
v_cvt_pk_bf16_f32 v198, v169, v171
v_cvt_pk_bf16_f32 v199, v173, v175
s_waitcnt vmcnt(24)
v_perm_b32 v24, v132, v128, s30
v_perm_b32 v25, v132, v128, s31
v_perm_b32 v26, v133, v129, s30
v_perm_b32 v27, v133, v129, s31
v_perm_b32 v28, v134, v130, s30
v_perm_b32 v29, v134, v130, s31
v_perm_b32 v30, v135, v131, s30
v_perm_b32 v31, v135, v131, s31
v_dot2_f32_bf16 v176, v24, v192, v176
v_dot2_f32_bf16 v177, v25, v192, v177
v_dot2_f32_bf16 v178, v26, v192, v178
v_dot2_f32_bf16 v179, v27, v192, v179
v_dot2_f32_bf16 v180, v28, v192, v180
v_dot2_f32_bf16 v181, v29, v192, v181
v_dot2_f32_bf16 v182, v30, v192, v182
v_dot2_f32_bf16 v183, v31, v192, v183
v_dot2_f32_bf16 v184, v24, v196, v184
v_dot2_f32_bf16 v185, v25, v196, v185
v_dot2_f32_bf16 v186, v26, v196, v186
v_dot2_f32_bf16 v187, v27, v196, v187
v_dot2_f32_bf16 v188, v28, v196, v188
v_dot2_f32_bf16 v189, v29, v196, v189
v_dot2_f32_bf16 v190, v30, v196, v190
v_dot2_f32_bf16 v191, v31, v196, v191
v_perm_b32 v24, v140, v136, s30
v_perm_b32 v25, v140, v136, s31
v_perm_b32 v26, v141, v137, s30
v_perm_b32 v27, v141, v137, s31
v_perm_b32 v28, v142, v138, s30
v_perm_b32 v29, v142, v138, s31
v_perm_b32 v30, v143, v139, s30
v_perm_b32 v31, v143, v139, s31
v_dot2_f32_bf16 v176, v24, v193, v176
v_dot2_f32_bf16 v177, v25, v193, v177
v_dot2_f32_bf16 v178, v26, v193, v178
v_dot2_f32_bf16 v179, v27, v193, v179
v_dot2_f32_bf16 v180, v28, v193, v180
v_dot2_f32_bf16 v181, v29, v193, v181
v_dot2_f32_bf16 v182, v30, v193, v182
v_dot2_f32_bf16 v183, v31, v193, v183
v_dot2_f32_bf16 v184, v24, v197, v184
v_dot2_f32_bf16 v185, v25, v197, v185
v_dot2_f32_bf16 v186, v26, v197, v186
v_dot2_f32_bf16 v187, v27, v197, v187
v_dot2_f32_bf16 v188, v28, v197, v188
v_dot2_f32_bf16 v189, v29, v197, v189
v_dot2_f32_bf16 v190, v30, v197, v190
v_dot2_f32_bf16 v191, v31, v197, v191
v_perm_b32 v24, v148, v144, s30
v_perm_b32 v25, v148, v144, s31
v_perm_b32 v26, v149, v145, s30
v_perm_b32 v27, v149, v145, s31
v_perm_b32 v28, v150, v146, s30
v_perm_b32 v29, v150, v146, s31
v_perm_b32 v30, v151, v147, s30
v_perm_b32 v31, v151, v147, s31
v_dot2_f32_bf16 v176, v24, v194, v176
v_dot2_f32_bf16 v177, v25, v194, v177
v_dot2_f32_bf16 v178, v26, v194, v178
v_dot2_f32_bf16 v179, v27, v194, v179
v_dot2_f32_bf16 v180, v28, v194, v180
v_dot2_f32_bf16 v181, v29, v194, v181
v_dot2_f32_bf16 v182, v30, v194, v182
v_dot2_f32_bf16 v183, v31, v194, v183
v_dot2_f32_bf16 v184, v24, v198, v184
v_dot2_f32_bf16 v185, v25, v198, v185
v_dot2_f32_bf16 v186, v26, v198, v186
v_dot2_f32_bf16 v187, v27, v198, v187
v_dot2_f32_bf16 v188, v28, v198, v188
v_dot2_f32_bf16 v189, v29, v198, v189
v_dot2_f32_bf16 v190, v30, v198, v190
v_dot2_f32_bf16 v191, v31, v198, v191
v_perm_b32 v24, v156, v152, s30
v_perm_b32 v25, v156, v152, s31
v_perm_b32 v26, v157, v153, s30
v_perm_b32 v27, v157, v153, s31
v_perm_b32 v28, v158, v154, s30
v_perm_b32 v29, v158, v154, s31
v_perm_b32 v30, v159, v155, s30
v_perm_b32 v31, v159, v155, s31
v_dot2_f32_bf16 v176, v24, v195, v176
v_dot2_f32_bf16 v177, v25, v195, v177
v_dot2_f32_bf16 v178, v26, v195, v178
v_dot2_f32_bf16 v179, v27, v195, v179
v_dot2_f32_bf16 v180, v28, v195, v180
v_dot2_f32_bf16 v181, v29, v195, v181
v_dot2_f32_bf16 v182, v30, v195, v182
v_dot2_f32_bf16 v183, v31, v195, v183
v_dot2_f32_bf16 v184, v24, v199, v184
v_dot2_f32_bf16 v185, v25, v199, v185
v_dot2_f32_bf16 v186, v26, v199, v186
v_dot2_f32_bf16 v187, v27, v199, v187
v_dot2_f32_bf16 v188, v28, v199, v188
v_dot2_f32_bf16 v189, v29, v199, v189
v_dot2_f32_bf16 v190, v30, v199, v190
v_dot2_f32_bf16 v191, v31, v199, v191
buffer_load_dwordx4 v[128:131], v2, s[12:15], s5 offen offset:0 nt
buffer_load_dwordx4 v[132:135], v2, s[12:15], s5 offen offset:1024 nt
buffer_load_dwordx4 v[136:139], v2, s[12:15], s5 offen offset:2048 nt
buffer_load_dwordx4 v[140:143], v2, s[12:15], s5 offen offset:3072 nt
buffer_load_dwordx4 v[144:147], v3, s[12:15], s5 offen offset:0 nt
buffer_load_dwordx4 v[148:151], v3, s[12:15], s5 offen offset:1024 nt
buffer_load_dwordx4 v[152:155], v3, s[12:15], s5 offen offset:2048 nt
buffer_load_dwordx4 v[156:159], v3, s[12:15], s5 offen offset:3072 nt
s_add_u32 s5, s5, 8192
s_add_u32 s16, s16, 1
s_cmp_lt_u32 s16, 7
s_cbranch_scc1 k3_loop
s_waitcnt vmcnt(24)
v_dot2_f32_bf16 v160, v32, v8, 0
v_dot2_f32_bf16 v161, v32, v12, 0
v_dot2_f32_bf16 v162, v36, v8, 0
v_dot2_f32_bf16 v163, v36, v12, 0
v_dot2_f32_bf16 v164, v40, v8, 0
v_dot2_f32_bf16 v165, v40, v12, 0
v_dot2_f32_bf16 v166, v44, v8, 0
v_dot2_f32_bf16 v167, v44, v12, 0
v_dot2_f32_bf16 v168, v48, v8, 0
v_dot2_f32_bf16 v169, v48, v12, 0
v_dot2_f32_bf16 v170, v52, v8, 0
v_dot2_f32_bf16 v171, v52, v12, 0
v_dot2_f32_bf16 v172, v56, v8, 0
v_dot2_f32_bf16 v173, v56, v12, 0
v_dot2_f32_bf16 v174, v60, v8, 0
v_dot2_f32_bf16 v175, v60, v12, 0
v_dot2_f32_bf16 v160, v33, v9, v160
v_dot2_f32_bf16 v161, v33, v13, v161
v_dot2_f32_bf16 v162, v37, v9, v162
v_dot2_f32_bf16 v163, v37, v13, v163
v_dot2_f32_bf16 v164, v41, v9, v164
v_dot2_f32_bf16 v165, v41, v13, v165
v_dot2_f32_bf16 v166, v45, v9, v166
v_dot2_f32_bf16 v167, v45, v13, v167
v_dot2_f32_bf16 v168, v49, v9, v168
v_dot2_f32_bf16 v169, v49, v13, v169
v_dot2_f32_bf16 v170, v53, v9, v170
v_dot2_f32_bf16 v171, v53, v13, v171
v_dot2_f32_bf16 v172, v57, v9, v172
v_dot2_f32_bf16 v173, v57, v13, v173
v_dot2_f32_bf16 v174, v61, v9, v174
v_dot2_f32_bf16 v175, v61, v13, v175
v_dot2_f32_bf16 v160, v34, v10, v160
v_dot2_f32_bf16 v161, v34, v14, v161
v_dot2_f32_bf16 v162, v38, v10, v162
v_dot2_f32_bf16 v163, v38, v14, v163
v_dot2_f32_bf16 v164, v42, v10, v164
v_dot2_f32_bf16 v165, v42, v14, v165
v_dot2_f32_bf16 v166, v46, v10, v166
v_dot2_f32_bf16 v167, v46, v14, v167
v_dot2_f32_bf16 v168, v50, v10, v168
v_dot2_f32_bf16 v169, v50, v14, v169
v_dot2_f32_bf16 v170, v54, v10, v170
v_dot2_f32_bf16 v171, v54, v14, v171
v_dot2_f32_bf16 v172, v58, v10, v172
v_dot2_f32_bf16 v173, v58, v14, v173
v_dot2_f32_bf16 v174, v62, v10, v174
v_dot2_f32_bf16 v175, v62, v14, v175
v_dot2_f32_bf16 v160, v35, v11, v160
v_dot2_f32_bf16 v161, v35, v15, v161
v_dot2_f32_bf16 v162, v39, v11, v162
v_dot2_f32_bf16 v163, v39, v15, v163
v_dot2_f32_bf16 v164, v43, v11, v164
v_dot2_f32_bf16 v165, v43, v15, v165
v_dot2_f32_bf16 v166, v47, v11, v166
v_dot2_f32_bf16 v167, v47, v15, v167
v_dot2_f32_bf16 v168, v51, v11, v168
v_dot2_f32_bf16 v169, v51, v15, v169
v_dot2_f32_bf16 v170, v55, v11, v170
v_dot2_f32_bf16 v171, v55, v15, v171
v_dot2_f32_bf16 v172, v59, v11, v172
v_dot2_f32_bf16 v173, v59, v15, v173
v_dot2_f32_bf16 v174, v63, v11, v174
v_dot2_f32_bf16 v175, v63, v15, v175
v_add_f32_dpp v160, v160, v160 row_ror:8 row_mask:0xf bank_mask:0xf
v_add_f32_dpp v161, v161, v161 row_ror:8 row_mask:0xf bank_mask:0xf
v_add_f32_dpp v162, v162, v162 row_ror:8 row_mask:0xf bank_mask:0xf
v_add_f32_dpp v163, v163, v163 row_ror:8 row_mask:0xf bank_mask:0xf
v_add_f32_dpp v164, v164, v164 row_ror:8 row_mask:0xf bank_mask:0xf
v_add_f32_dpp v165, v165, v165 row_ror:8 row_mask:0xf bank_mask:0xf
v_add_f32_dpp v166, v166, v166 row_ror:8 row_mask:0xf bank_mask:0xf
v_add_f32_dpp v167, v167, v167 row_ror:8 row_mask:0xf bank_mask:0xf
v_add_f32_dpp v168, v168, v168 row_ror:8 row_mask:0xf bank_mask:0xf
v_add_f32_dpp v169, v169, v169 row_ror:8 row_mask:0xf bank_mask:0xf
v_add_f32_dpp v170, v170, v170 row_ror:8 row_mask:0xf bank_mask:0xf
v_add_f32_dpp v171, v171, v171 row_ror:8 row_mask:0xf bank_mask:0xf
v_add_f32_dpp v172, v172, v172 row_ror:8 row_mask:0xf bank_mask:0xf
v_add_f32_dpp v173, v173, v173 row_ror:8 row_mask:0xf bank_mask:0xf
v_add_f32_dpp v174, v174, v174 row_ror:8 row_mask:0xf bank_mask:0xf
v_add_f32_dpp v175, v175, v175 row_ror:8 row_mask:0xf bank_mask:0xf
v_add_f32_dpp v160, v160, v160 row_ror:4 row_mask:0xf bank_mask:0xf
v_add_f32_dpp v161, v161, v161 row_ror:4 row_mask:0xf bank_mask:0xf
v_add_f32_dpp v162, v162, v162 row_ror:4 row_mask:0xf bank_mask:0xf
v_add_f32_dpp v163, v163, v163 row_ror:4 row_mask:0xf bank_mask:0xf
v_add_f32_dpp v164, v164, v164 row_ror:4 row_mask:0xf bank_mask:0xf
v_add_f32_dpp v165, v165, v165 row_ror:4 row_mask:0xf bank_mask:0xf
v_add_f32_dpp v166, v166, v166 row_ror:4 row_mask:0xf bank_mask:0xf
v_add_f32_dpp v167, v167, v167 row_ror:4 row_mask:0xf bank_mask:0xf
v_add_f32_dpp v168, v168, v168 row_ror:4 row_mask:0xf bank_mask:0xf
v_add_f32_dpp v169, v169, v169 row_ror:4 row_mask:0xf bank_mask:0xf
v_add_f32_dpp v170, v170, v170 row_ror:4 row_mask:0xf bank_mask:0xf
v_add_f32_dpp v171, v171, v171 row_ror:4 row_mask:0xf bank_mask:0xf
v_add_f32_dpp v172, v172, v172 row_ror:4 row_mask:0xf bank_mask:0xf
v_add_f32_dpp v173, v173, v173 row_ror:4 row_mask:0xf bank_mask:0xf
v_add_f32_dpp v174, v174, v174 row_ror:4 row_mask:0xf bank_mask:0xf
v_add_f32_dpp v175, v175, v175 row_ror:4 row_mask:0xf bank_mask:0xf
v_add_f32_dpp v160, v160, v160 row_ror:2 row_mask:0xf bank_mask:0xf
v_add_f32_dpp v161, v161, v161 row_ror:2 row_mask:0xf bank_mask:0xf
v_add_f32_dpp v162, v162, v162 row_ror:2 row_mask:0xf bank_mask:0xf
v_add_f32_dpp v163, v163, v163 row_ror:2 row_mask:0xf bank_mask:0xf
v_add_f32_dpp v164, v164, v164 row_ror:2 row_mask:0xf bank_mask:0xf
v_add_f32_dpp v165, v165, v165 row_ror:2 row_mask:0xf bank_mask:0xf
v_add_f32_dpp v166, v166, v166 row_ror:2 row_mask:0xf bank_mask:0xf
v_add_f32_dpp v167, v167, v167 row_ror:2 row_mask:0xf bank_mask:0xf
v_add_f32_dpp v168, v168, v168 row_ror:2 row_mask:0xf bank_mask:0xf
v_add_f32_dpp v169, v169, v169 row_ror:2 row_mask:0xf bank_mask:0xf
v_add_f32_dpp v170, v170, v170 row_ror:2 row_mask:0xf bank_mask:0xf
v_add_f32_dpp v171, v171, v171 row_ror:2 row_mask:0xf bank_mask:0xf
v_add_f32_dpp v172, v172, v172 row_ror:2 row_mask:0xf bank_mask:0xf
v_add_f32_dpp v173, v173, v173 row_ror:2 row_mask:0xf bank_mask:0xf
v_add_f32_dpp v174, v174, v174 row_ror:2 row_mask:0xf bank_mask:0xf
v_add_f32_dpp v175, v175, v175 row_ror:2 row_mask:0xf bank_mask:0xf
v_add_f32_dpp v160, v160, v160 row_ror:1 row_mask:0xf bank_mask:0xf
v_add_f32_dpp v161, v161, v161 row_ror:1 row_mask:0xf bank_mask:0xf
v_add_f32_dpp v162, v162, v162 row_ror:1 row_mask:0xf bank_mask:0xf
v_add_f32_dpp v163, v163, v163 row_ror:1 row_mask:0xf bank_mask:0xf
v_add_f32_dpp v164, v164, v164 row_ror:1 row_mask:0xf bank_mask:0xf
v_add_f32_dpp v165, v165, v165 row_ror:1 row_mask:0xf bank_mask:0xf
v_add_f32_dpp v166, v166, v166 row_ror:1 row_mask:0xf bank_mask:0xf
v_add_f32_dpp v167, v167, v167 row_ror:1 row_mask:0xf bank_mask:0xf
v_add_f32_dpp v168, v168, v168 row_ror:1 row_mask:0xf bank_mask:0xf
v_add_f32_dpp v169, v169, v169 row_ror:1 row_mask:0xf bank_mask:0xf
v_add_f32_dpp v170, v170, v170 row_ror:1 row_mask:0xf bank_mask:0xf
v_add_f32_dpp v171, v171, v171 row_ror:1 row_mask:0xf bank_mask:0xf
v_add_f32_dpp v172, v172, v172 row_ror:1 row_mask:0xf bank_mask:0xf
v_add_f32_dpp v173, v173, v173 row_ror:1 row_mask:0xf bank_mask:0xf
v_add_f32_dpp v174, v174, v174 row_ror:1 row_mask:0xf bank_mask:0xf
v_add_f32_dpp v175, v175, v175 row_ror:1 row_mask:0xf bank_mask:0xf
v_max3_f32 v20, v160, v162, v16
v_max3_f32 v20, v164, v166, v20
v_max3_f32 v20, v168, v170, v20
v_max3_f32 v20, v172, v174, v20
v_sub_f32 v21, v16, v20
v_mul_f32 v21, s7, v21
v_exp_f32 v21, v21
v_mov_b32 v16, v20
v_mul_f32 v22, s7, v20
v_fma_f32 v160, v160, s7, -v22
v_fma_f32 v162, v162, s7, -v22
v_fma_f32 v164, v164, s7, -v22
v_fma_f32 v166, v166, s7, -v22
v_fma_f32 v168, v168, s7, -v22
v_fma_f32 v170, v170, s7, -v22
v_fma_f32 v172, v172, s7, -v22
v_fma_f32 v174, v174, s7, -v22
v_exp_f32 v160, v160
v_exp_f32 v162, v162
v_exp_f32 v164, v164
v_exp_f32 v166, v166
v_exp_f32 v168, v168
v_exp_f32 v170, v170
v_exp_f32 v172, v172
v_exp_f32 v174, v174
v_mul_f32 v18, v18, v21
v_mul_f32 v176, v176, v21
v_mul_f32 v177, v177, v21
v_mul_f32 v178, v178, v21
v_mul_f32 v179, v179, v21
v_mul_f32 v180, v180, v21
v_mul_f32 v181, v181, v21
v_mul_f32 v182, v182, v21
v_mul_f32 v183, v183, v21
v_add_f32 v18, v18, v160
v_add_f32 v18, v18, v162
v_add_f32 v18, v18, v164
v_add_f32 v18, v18, v166
v_add_f32 v18, v18, v168
v_add_f32 v18, v18, v170
v_add_f32 v18, v18, v172
v_add_f32 v18, v18, v174
v_cvt_pk_bf16_f32 v192, v160, v162
v_cvt_pk_bf16_f32 v193, v164, v166
v_cvt_pk_bf16_f32 v194, v168, v170
v_cvt_pk_bf16_f32 v195, v172, v174
v_max3_f32 v20, v161, v163, v17
v_max3_f32 v20, v165, v167, v20
v_max3_f32 v20, v169, v171, v20
v_max3_f32 v20, v173, v175, v20
v_sub_f32 v21, v17, v20
v_mul_f32 v21, s7, v21
v_exp_f32 v21, v21
v_mov_b32 v17, v20
v_mul_f32 v22, s7, v20
v_fma_f32 v161, v161, s7, -v22
v_fma_f32 v163, v163, s7, -v22
v_fma_f32 v165, v165, s7, -v22
v_fma_f32 v167, v167, s7, -v22
v_fma_f32 v169, v169, s7, -v22
v_fma_f32 v171, v171, s7, -v22
v_fma_f32 v173, v173, s7, -v22
v_fma_f32 v175, v175, s7, -v22
v_exp_f32 v161, v161
v_exp_f32 v163, v163
v_exp_f32 v165, v165
v_exp_f32 v167, v167
v_exp_f32 v169, v169
v_exp_f32 v171, v171
v_exp_f32 v173, v173
v_exp_f32 v175, v175
v_mul_f32 v19, v19, v21
v_mul_f32 v184, v184, v21
v_mul_f32 v185, v185, v21
v_mul_f32 v186, v186, v21
v_mul_f32 v187, v187, v21
v_mul_f32 v188, v188, v21
v_mul_f32 v189, v189, v21
v_mul_f32 v190, v190, v21
v_mul_f32 v191, v191, v21
v_add_f32 v19, v19, v161
v_add_f32 v19, v19, v163
v_add_f32 v19, v19, v165
v_add_f32 v19, v19, v167
v_add_f32 v19, v19, v169
v_add_f32 v19, v19, v171
v_add_f32 v19, v19, v173
v_add_f32 v19, v19, v175
v_cvt_pk_bf16_f32 v196, v161, v163
v_cvt_pk_bf16_f32 v197, v165, v167
v_cvt_pk_bf16_f32 v198, v169, v171
v_cvt_pk_bf16_f32 v199, v173, v175
s_waitcnt vmcnt(16)
v_perm_b32 v24, v100, v96, s30
v_perm_b32 v25, v100, v96, s31
v_perm_b32 v26, v101, v97, s30
v_perm_b32 v27, v101, v97, s31
v_perm_b32 v28, v102, v98, s30
v_perm_b32 v29, v102, v98, s31
v_perm_b32 v30, v103, v99, s30
v_perm_b32 v31, v103, v99, s31
v_dot2_f32_bf16 v176, v24, v192, v176
v_dot2_f32_bf16 v177, v25, v192, v177
v_dot2_f32_bf16 v178, v26, v192, v178
v_dot2_f32_bf16 v179, v27, v192, v179
v_dot2_f32_bf16 v180, v28, v192, v180
v_dot2_f32_bf16 v181, v29, v192, v181
v_dot2_f32_bf16 v182, v30, v192, v182
v_dot2_f32_bf16 v183, v31, v192, v183
v_dot2_f32_bf16 v184, v24, v196, v184
v_dot2_f32_bf16 v185, v25, v196, v185
v_dot2_f32_bf16 v186, v26, v196, v186
v_dot2_f32_bf16 v187, v27, v196, v187
v_dot2_f32_bf16 v188, v28, v196, v188
v_dot2_f32_bf16 v189, v29, v196, v189
v_dot2_f32_bf16 v190, v30, v196, v190
v_dot2_f32_bf16 v191, v31, v196, v191
v_perm_b32 v24, v108, v104, s30
v_perm_b32 v25, v108, v104, s31
v_perm_b32 v26, v109, v105, s30
v_perm_b32 v27, v109, v105, s31
v_perm_b32 v28, v110, v106, s30
v_perm_b32 v29, v110, v106, s31
v_perm_b32 v30, v111, v107, s30
v_perm_b32 v31, v111, v107, s31
v_dot2_f32_bf16 v176, v24, v193, v176
v_dot2_f32_bf16 v177, v25, v193, v177
v_dot2_f32_bf16 v178, v26, v193, v178
v_dot2_f32_bf16 v179, v27, v193, v179
v_dot2_f32_bf16 v180, v28, v193, v180
v_dot2_f32_bf16 v181, v29, v193, v181
v_dot2_f32_bf16 v182, v30, v193, v182
v_dot2_f32_bf16 v183, v31, v193, v183
v_dot2_f32_bf16 v184, v24, v197, v184
v_dot2_f32_bf16 v185, v25, v197, v185
v_dot2_f32_bf16 v186, v26, v197, v186
v_dot2_f32_bf16 v187, v27, v197, v187
v_dot2_f32_bf16 v188, v28, v197, v188
v_dot2_f32_bf16 v189, v29, v197, v189
v_dot2_f32_bf16 v190, v30, v197, v190
v_dot2_f32_bf16 v191, v31, v197, v191
v_perm_b32 v24, v116, v112, s30
v_perm_b32 v25, v116, v112, s31
v_perm_b32 v26, v117, v113, s30
v_perm_b32 v27, v117, v113, s31
v_perm_b32 v28, v118, v114, s30
v_perm_b32 v29, v118, v114, s31
v_perm_b32 v30, v119, v115, s30
v_perm_b32 v31, v119, v115, s31
v_dot2_f32_bf16 v176, v24, v194, v176
v_dot2_f32_bf16 v177, v25, v194, v177
v_dot2_f32_bf16 v178, v26, v194, v178
v_dot2_f32_bf16 v179, v27, v194, v179
v_dot2_f32_bf16 v180, v28, v194, v180
v_dot2_f32_bf16 v181, v29, v194, v181
v_dot2_f32_bf16 v182, v30, v194, v182
v_dot2_f32_bf16 v183, v31, v194, v183
v_dot2_f32_bf16 v184, v24, v198, v184
v_dot2_f32_bf16 v185, v25, v198, v185
v_dot2_f32_bf16 v186, v26, v198, v186
v_dot2_f32_bf16 v187, v27, v198, v187
v_dot2_f32_bf16 v188, v28, v198, v188
v_dot2_f32_bf16 v189, v29, v198, v189
v_dot2_f32_bf16 v190, v30, v198, v190
v_dot2_f32_bf16 v191, v31, v198, v191
v_perm_b32 v24, v124, v120, s30
v_perm_b32 v25, v124, v120, s31
v_perm_b32 v26, v125, v121, s30
v_perm_b32 v27, v125, v121, s31
v_perm_b32 v28, v126, v122, s30
v_perm_b32 v29, v126, v122, s31
v_perm_b32 v30, v127, v123, s30
v_perm_b32 v31, v127, v123, s31
v_dot2_f32_bf16 v176, v24, v195, v176
v_dot2_f32_bf16 v177, v25, v195, v177
v_dot2_f32_bf16 v178, v26, v195, v178
v_dot2_f32_bf16 v179, v27, v195, v179
v_dot2_f32_bf16 v180, v28, v195, v180
v_dot2_f32_bf16 v181, v29, v195, v181
v_dot2_f32_bf16 v182, v30, v195, v182
v_dot2_f32_bf16 v183, v31, v195, v183
v_dot2_f32_bf16 v184, v24, v199, v184
v_dot2_f32_bf16 v185, v25, v199, v185
v_dot2_f32_bf16 v186, v26, v199, v186
v_dot2_f32_bf16 v187, v27, v199, v187
v_dot2_f32_bf16 v188, v28, v199, v188
v_dot2_f32_bf16 v189, v29, v199, v189
v_dot2_f32_bf16 v190, v30, v199, v190
v_dot2_f32_bf16 v191, v31, v199, v191
s_waitcnt vmcnt(8)
v_dot2_f32_bf16 v160, v64, v8, 0
v_dot2_f32_bf16 v161, v64, v12, 0
v_dot2_f32_bf16 v162, v68, v8, 0
v_dot2_f32_bf16 v163, v68, v12, 0
v_dot2_f32_bf16 v164, v72, v8, 0
v_dot2_f32_bf16 v165, v72, v12, 0
v_dot2_f32_bf16 v166, v76, v8, 0
v_dot2_f32_bf16 v167, v76, v12, 0
v_dot2_f32_bf16 v168, v80, v8, 0
v_dot2_f32_bf16 v169, v80, v12, 0
v_dot2_f32_bf16 v170, v84, v8, 0
v_dot2_f32_bf16 v171, v84, v12, 0
v_dot2_f32_bf16 v172, v88, v8, 0
v_dot2_f32_bf16 v173, v88, v12, 0
v_dot2_f32_bf16 v174, v92, v8, 0
v_dot2_f32_bf16 v175, v92, v12, 0
v_dot2_f32_bf16 v160, v65, v9, v160
v_dot2_f32_bf16 v161, v65, v13, v161
v_dot2_f32_bf16 v162, v69, v9, v162
v_dot2_f32_bf16 v163, v69, v13, v163
v_dot2_f32_bf16 v164, v73, v9, v164
v_dot2_f32_bf16 v165, v73, v13, v165
v_dot2_f32_bf16 v166, v77, v9, v166
v_dot2_f32_bf16 v167, v77, v13, v167
v_dot2_f32_bf16 v168, v81, v9, v168
v_dot2_f32_bf16 v169, v81, v13, v169
v_dot2_f32_bf16 v170, v85, v9, v170
v_dot2_f32_bf16 v171, v85, v13, v171
v_dot2_f32_bf16 v172, v89, v9, v172
v_dot2_f32_bf16 v173, v89, v13, v173
v_dot2_f32_bf16 v174, v93, v9, v174
v_dot2_f32_bf16 v175, v93, v13, v175
v_dot2_f32_bf16 v160, v66, v10, v160
v_dot2_f32_bf16 v161, v66, v14, v161
v_dot2_f32_bf16 v162, v70, v10, v162
v_dot2_f32_bf16 v163, v70, v14, v163
v_dot2_f32_bf16 v164, v74, v10, v164
v_dot2_f32_bf16 v165, v74, v14, v165
v_dot2_f32_bf16 v166, v78, v10, v166
v_dot2_f32_bf16 v167, v78, v14, v167
v_dot2_f32_bf16 v168, v82, v10, v168
v_dot2_f32_bf16 v169, v82, v14, v169
v_dot2_f32_bf16 v170, v86, v10, v170
v_dot2_f32_bf16 v171, v86, v14, v171
v_dot2_f32_bf16 v172, v90, v10, v172
v_dot2_f32_bf16 v173, v90, v14, v173
v_dot2_f32_bf16 v174, v94, v10, v174
v_dot2_f32_bf16 v175, v94, v14, v175
v_dot2_f32_bf16 v160, v67, v11, v160
v_dot2_f32_bf16 v161, v67, v15, v161
v_dot2_f32_bf16 v162, v71, v11, v162
v_dot2_f32_bf16 v163, v71, v15, v163
v_dot2_f32_bf16 v164, v75, v11, v164
v_dot2_f32_bf16 v165, v75, v15, v165
v_dot2_f32_bf16 v166, v79, v11, v166
v_dot2_f32_bf16 v167, v79, v15, v167
v_dot2_f32_bf16 v168, v83, v11, v168
v_dot2_f32_bf16 v169, v83, v15, v169
v_dot2_f32_bf16 v170, v87, v11, v170
v_dot2_f32_bf16 v171, v87, v15, v171
v_dot2_f32_bf16 v172, v91, v11, v172
v_dot2_f32_bf16 v173, v91, v15, v173
v_dot2_f32_bf16 v174, v95, v11, v174
v_dot2_f32_bf16 v175, v95, v15, v175
v_add_f32_dpp v160, v160, v160 row_ror:8 row_mask:0xf bank_mask:0xf
v_add_f32_dpp v161, v161, v161 row_ror:8 row_mask:0xf bank_mask:0xf
v_add_f32_dpp v162, v162, v162 row_ror:8 row_mask:0xf bank_mask:0xf
v_add_f32_dpp v163, v163, v163 row_ror:8 row_mask:0xf bank_mask:0xf
v_add_f32_dpp v164, v164, v164 row_ror:8 row_mask:0xf bank_mask:0xf
v_add_f32_dpp v165, v165, v165 row_ror:8 row_mask:0xf bank_mask:0xf
v_add_f32_dpp v166, v166, v166 row_ror:8 row_mask:0xf bank_mask:0xf
v_add_f32_dpp v167, v167, v167 row_ror:8 row_mask:0xf bank_mask:0xf
v_add_f32_dpp v168, v168, v168 row_ror:8 row_mask:0xf bank_mask:0xf
v_add_f32_dpp v169, v169, v169 row_ror:8 row_mask:0xf bank_mask:0xf
v_add_f32_dpp v170, v170, v170 row_ror:8 row_mask:0xf bank_mask:0xf
v_add_f32_dpp v171, v171, v171 row_ror:8 row_mask:0xf bank_mask:0xf
v_add_f32_dpp v172, v172, v172 row_ror:8 row_mask:0xf bank_mask:0xf
v_add_f32_dpp v173, v173, v173 row_ror:8 row_mask:0xf bank_mask:0xf
v_add_f32_dpp v174, v174, v174 row_ror:8 row_mask:0xf bank_mask:0xf
v_add_f32_dpp v175, v175, v175 row_ror:8 row_mask:0xf bank_mask:0xf
v_add_f32_dpp v160, v160, v160 row_ror:4 row_mask:0xf bank_mask:0xf
v_add_f32_dpp v161, v161, v161 row_ror:4 row_mask:0xf bank_mask:0xf
v_add_f32_dpp v162, v162, v162 row_ror:4 row_mask:0xf bank_mask:0xf
v_add_f32_dpp v163, v163, v163 row_ror:4 row_mask:0xf bank_mask:0xf
v_add_f32_dpp v164, v164, v164 row_ror:4 row_mask:0xf bank_mask:0xf
v_add_f32_dpp v165, v165, v165 row_ror:4 row_mask:0xf bank_mask:0xf
v_add_f32_dpp v166, v166, v166 row_ror:4 row_mask:0xf bank_mask:0xf
v_add_f32_dpp v167, v167, v167 row_ror:4 row_mask:0xf bank_mask:0xf
v_add_f32_dpp v168, v168, v168 row_ror:4 row_mask:0xf bank_mask:0xf
v_add_f32_dpp v169, v169, v169 row_ror:4 row_mask:0xf bank_mask:0xf
v_add_f32_dpp v170, v170, v170 row_ror:4 row_mask:0xf bank_mask:0xf
v_add_f32_dpp v171, v171, v171 row_ror:4 row_mask:0xf bank_mask:0xf
v_add_f32_dpp v172, v172, v172 row_ror:4 row_mask:0xf bank_mask:0xf
v_add_f32_dpp v173, v173, v173 row_ror:4 row_mask:0xf bank_mask:0xf
v_add_f32_dpp v174, v174, v174 row_ror:4 row_mask:0xf bank_mask:0xf
v_add_f32_dpp v175, v175, v175 row_ror:4 row_mask:0xf bank_mask:0xf
v_add_f32_dpp v160, v160, v160 row_ror:2 row_mask:0xf bank_mask:0xf
v_add_f32_dpp v161, v161, v161 row_ror:2 row_mask:0xf bank_mask:0xf
v_add_f32_dpp v162, v162, v162 row_ror:2 row_mask:0xf bank_mask:0xf
v_add_f32_dpp v163, v163, v163 row_ror:2 row_mask:0xf bank_mask:0xf
v_add_f32_dpp v164, v164, v164 row_ror:2 row_mask:0xf bank_mask:0xf
v_add_f32_dpp v165, v165, v165 row_ror:2 row_mask:0xf bank_mask:0xf
v_add_f32_dpp v166, v166, v166 row_ror:2 row_mask:0xf bank_mask:0xf
v_add_f32_dpp v167, v167, v167 row_ror:2 row_mask:0xf bank_mask:0xf
v_add_f32_dpp v168, v168, v168 row_ror:2 row_mask:0xf bank_mask:0xf
v_add_f32_dpp v169, v169, v169 row_ror:2 row_mask:0xf bank_mask:0xf
v_add_f32_dpp v170, v170, v170 row_ror:2 row_mask:0xf bank_mask:0xf
v_add_f32_dpp v171, v171, v171 row_ror:2 row_mask:0xf bank_mask:0xf
v_add_f32_dpp v172, v172, v172 row_ror:2 row_mask:0xf bank_mask:0xf
v_add_f32_dpp v173, v173, v173 row_ror:2 row_mask:0xf bank_mask:0xf
v_add_f32_dpp v174, v174, v174 row_ror:2 row_mask:0xf bank_mask:0xf
v_add_f32_dpp v175, v175, v175 row_ror:2 row_mask:0xf bank_mask:0xf
v_add_f32_dpp v160, v160, v160 row_ror:1 row_mask:0xf bank_mask:0xf
v_add_f32_dpp v161, v161, v161 row_ror:1 row_mask:0xf bank_mask:0xf
v_add_f32_dpp v162, v162, v162 row_ror:1 row_mask:0xf bank_mask:0xf
v_add_f32_dpp v163, v163, v163 row_ror:1 row_mask:0xf bank_mask:0xf
v_add_f32_dpp v164, v164, v164 row_ror:1 row_mask:0xf bank_mask:0xf
v_add_f32_dpp v165, v165, v165 row_ror:1 row_mask:0xf bank_mask:0xf
v_add_f32_dpp v166, v166, v166 row_ror:1 row_mask:0xf bank_mask:0xf
v_add_f32_dpp v167, v167, v167 row_ror:1 row_mask:0xf bank_mask:0xf
v_add_f32_dpp v168, v168, v168 row_ror:1 row_mask:0xf bank_mask:0xf
v_add_f32_dpp v169, v169, v169 row_ror:1 row_mask:0xf bank_mask:0xf
v_add_f32_dpp v170, v170, v170 row_ror:1 row_mask:0xf bank_mask:0xf
v_add_f32_dpp v171, v171, v171 row_ror:1 row_mask:0xf bank_mask:0xf
v_add_f32_dpp v172, v172, v172 row_ror:1 row_mask:0xf bank_mask:0xf
v_add_f32_dpp v173, v173, v173 row_ror:1 row_mask:0xf bank_mask:0xf
v_add_f32_dpp v174, v174, v174 row_ror:1 row_mask:0xf bank_mask:0xf
v_add_f32_dpp v175, v175, v175 row_ror:1 row_mask:0xf bank_mask:0xf
v_max3_f32 v20, v160, v162, v16
v_max3_f32 v20, v164, v166, v20
v_max3_f32 v20, v168, v170, v20
v_max3_f32 v20, v172, v174, v20
v_sub_f32 v21, v16, v20
v_mul_f32 v21, s7, v21
v_exp_f32 v21, v21
v_mov_b32 v16, v20
v_mul_f32 v22, s7, v20
v_fma_f32 v160, v160, s7, -v22
v_fma_f32 v162, v162, s7, -v22
v_fma_f32 v164, v164, s7, -v22
v_fma_f32 v166, v166, s7, -v22
v_fma_f32 v168, v168, s7, -v22
v_fma_f32 v170, v170, s7, -v22
v_fma_f32 v172, v172, s7, -v22
v_fma_f32 v174, v174, s7, -v22
v_exp_f32 v160, v160
v_exp_f32 v162, v162
v_exp_f32 v164, v164
v_exp_f32 v166, v166
v_exp_f32 v168, v168
v_exp_f32 v170, v170
v_exp_f32 v172, v172
v_exp_f32 v174, v174
v_mul_f32 v18, v18, v21
v_mul_f32 v176, v176, v21
v_mul_f32 v177, v177, v21
v_mul_f32 v178, v178, v21
v_mul_f32 v179, v179, v21
v_mul_f32 v180, v180, v21
v_mul_f32 v181, v181, v21
v_mul_f32 v182, v182, v21
v_mul_f32 v183, v183, v21
v_add_f32 v18, v18, v160
v_add_f32 v18, v18, v162
v_add_f32 v18, v18, v164
v_add_f32 v18, v18, v166
v_add_f32 v18, v18, v168
v_add_f32 v18, v18, v170
v_add_f32 v18, v18, v172
v_add_f32 v18, v18, v174
v_cvt_pk_bf16_f32 v192, v160, v162
v_cvt_pk_bf16_f32 v193, v164, v166
v_cvt_pk_bf16_f32 v194, v168, v170
v_cvt_pk_bf16_f32 v195, v172, v174
v_max3_f32 v20, v161, v163, v17
v_max3_f32 v20, v165, v167, v20
v_max3_f32 v20, v169, v171, v20
v_max3_f32 v20, v173, v175, v20
v_sub_f32 v21, v17, v20
v_mul_f32 v21, s7, v21
v_exp_f32 v21, v21
v_mov_b32 v17, v20
v_mul_f32 v22, s7, v20
v_fma_f32 v161, v161, s7, -v22
v_fma_f32 v163, v163, s7, -v22
v_fma_f32 v165, v165, s7, -v22
v_fma_f32 v167, v167, s7, -v22
v_fma_f32 v169, v169, s7, -v22
v_fma_f32 v171, v171, s7, -v22
v_fma_f32 v173, v173, s7, -v22
v_fma_f32 v175, v175, s7, -v22
v_exp_f32 v161, v161
v_exp_f32 v163, v163
v_exp_f32 v165, v165
v_exp_f32 v167, v167
v_exp_f32 v169, v169
v_exp_f32 v171, v171
v_exp_f32 v173, v173
v_exp_f32 v175, v175
v_mul_f32 v19, v19, v21
v_mul_f32 v184, v184, v21
v_mul_f32 v185, v185, v21
v_mul_f32 v186, v186, v21
v_mul_f32 v187, v187, v21
v_mul_f32 v188, v188, v21
v_mul_f32 v189, v189, v21
v_mul_f32 v190, v190, v21
v_mul_f32 v191, v191, v21
v_add_f32 v19, v19, v161
v_add_f32 v19, v19, v163
v_add_f32 v19, v19, v165
v_add_f32 v19, v19, v167
v_add_f32 v19, v19, v169
v_add_f32 v19, v19, v171
v_add_f32 v19, v19, v173
v_add_f32 v19, v19, v175
v_cvt_pk_bf16_f32 v196, v161, v163
v_cvt_pk_bf16_f32 v197, v165, v167
v_cvt_pk_bf16_f32 v198, v169, v171
v_cvt_pk_bf16_f32 v199, v173, v175
s_waitcnt vmcnt(0)
v_perm_b32 v24, v132, v128, s30
v_perm_b32 v25, v132, v128, s31
v_perm_b32 v26, v133, v129, s30
v_perm_b32 v27, v133, v129, s31
v_perm_b32 v28, v134, v130, s30
v_perm_b32 v29, v134, v130, s31
v_perm_b32 v30, v135, v131, s30
v_perm_b32 v31, v135, v131, s31
v_dot2_f32_bf16 v176, v24, v192, v176
v_dot2_f32_bf16 v177, v25, v192, v177
v_dot2_f32_bf16 v178, v26, v192, v178
v_dot2_f32_bf16 v179, v27, v192, v179
v_dot2_f32_bf16 v180, v28, v192, v180
v_dot2_f32_bf16 v181, v29, v192, v181
v_dot2_f32_bf16 v182, v30, v192, v182
v_dot2_f32_bf16 v183, v31, v192, v183
v_dot2_f32_bf16 v184, v24, v196, v184
v_dot2_f32_bf16 v185, v25, v196, v185
v_dot2_f32_bf16 v186, v26, v196, v186
v_dot2_f32_bf16 v187, v27, v196, v187
v_dot2_f32_bf16 v188, v28, v196, v188
v_dot2_f32_bf16 v189, v29, v196, v189
v_dot2_f32_bf16 v190, v30, v196, v190
v_dot2_f32_bf16 v191, v31, v196, v191
v_perm_b32 v24, v140, v136, s30
v_perm_b32 v25, v140, v136, s31
v_perm_b32 v26, v141, v137, s30
v_perm_b32 v27, v141, v137, s31
v_perm_b32 v28, v142, v138, s30
v_perm_b32 v29, v142, v138, s31
v_perm_b32 v30, v143, v139, s30
v_perm_b32 v31, v143, v139, s31
v_dot2_f32_bf16 v176, v24, v193, v176
v_dot2_f32_bf16 v177, v25, v193, v177
v_dot2_f32_bf16 v178, v26, v193, v178
v_dot2_f32_bf16 v179, v27, v193, v179
v_dot2_f32_bf16 v180, v28, v193, v180
v_dot2_f32_bf16 v181, v29, v193, v181
v_dot2_f32_bf16 v182, v30, v193, v182
v_dot2_f32_bf16 v183, v31, v193, v183
v_dot2_f32_bf16 v184, v24, v197, v184
v_dot2_f32_bf16 v185, v25, v197, v185
v_dot2_f32_bf16 v186, v26, v197, v186
v_dot2_f32_bf16 v187, v27, v197, v187
v_dot2_f32_bf16 v188, v28, v197, v188
v_dot2_f32_bf16 v189, v29, v197, v189
v_dot2_f32_bf16 v190, v30, v197, v190
v_dot2_f32_bf16 v191, v31, v197, v191
v_perm_b32 v24, v148, v144, s30
v_perm_b32 v25, v148, v144, s31
v_perm_b32 v26, v149, v145, s30
v_perm_b32 v27, v149, v145, s31
v_perm_b32 v28, v150, v146, s30
v_perm_b32 v29, v150, v146, s31
v_perm_b32 v30, v151, v147, s30
v_perm_b32 v31, v151, v147, s31
v_dot2_f32_bf16 v176, v24, v194, v176
v_dot2_f32_bf16 v177, v25, v194, v177
v_dot2_f32_bf16 v178, v26, v194, v178
v_dot2_f32_bf16 v179, v27, v194, v179
v_dot2_f32_bf16 v180, v28, v194, v180
v_dot2_f32_bf16 v181, v29, v194, v181
v_dot2_f32_bf16 v182, v30, v194, v182
v_dot2_f32_bf16 v183, v31, v194, v183
v_dot2_f32_bf16 v184, v24, v198, v184
v_dot2_f32_bf16 v185, v25, v198, v185
v_dot2_f32_bf16 v186, v26, v198, v186
v_dot2_f32_bf16 v187, v27, v198, v187
v_dot2_f32_bf16 v188, v28, v198, v188
v_dot2_f32_bf16 v189, v29, v198, v189
v_dot2_f32_bf16 v190, v30, v198, v190
v_dot2_f32_bf16 v191, v31, v198, v191
v_perm_b32 v24, v156, v152, s30
v_perm_b32 v25, v156, v152, s31
v_perm_b32 v26, v157, v153, s30
v_perm_b32 v27, v157, v153, s31
v_perm_b32 v28, v158, v154, s30
v_perm_b32 v29, v158, v154, s31
v_perm_b32 v30, v159, v155, s30
v_perm_b32 v31, v159, v155, s31
v_dot2_f32_bf16 v176, v24, v195, v176
v_dot2_f32_bf16 v177, v25, v195, v177
v_dot2_f32_bf16 v178, v26, v195, v178
v_dot2_f32_bf16 v179, v27, v195, v179
v_dot2_f32_bf16 v180, v28, v195, v180
v_dot2_f32_bf16 v181, v29, v195, v181
v_dot2_f32_bf16 v182, v30, v195, v182
v_dot2_f32_bf16 v183, v31, v195, v183
v_dot2_f32_bf16 v184, v24, v199, v184
v_dot2_f32_bf16 v185, v25, v199, v185
v_dot2_f32_bf16 v186, v26, v199, v186
v_dot2_f32_bf16 v187, v27, v199, v187
v_dot2_f32_bf16 v188, v28, v199, v188
v_dot2_f32_bf16 v189, v29, v199, v189
v_dot2_f32_bf16 v190, v30, v199, v190
v_dot2_f32_bf16 v191, v31, v199, v191
s_nop 4
v_lshrrev_b32 v20, 4, v0
v_lshlrev_b32 v21, 10, v20
v_add_u32 v21, v21, v4
v_add_u32 v21, v21, v4
ds_write_b128 v21, v[176:179] offset:0
ds_write_b128 v21, v[180:183] offset:16
ds_write_b128 v21, v[184:187] offset:512
ds_write_b128 v21, v[188:191] offset:528
v_mul_f32 v16, s7, v16
v_mul_f32 v17, s7, v17
v_lshlrev_b32 v20, 4, v20
v_mov_b32 v22, v16
v_mov_b32 v23, v18
v_mov_b32 v24, v17
v_mov_b32 v25, v19
ds_write_b128 v20, v[22:25] offset:16384
s_waitcnt lgkmcnt(0)
s_barrier
v_lshrrev_b32 v20, 7, v0
v_lshlrev_b32 v21, 3, v20
v_lshlrev_b32 v22, 2, v0
ds_read_b64 v[32:33], v21 offset:16384
ds_read_b32 v64, v22 offset:0
ds_read_b64 v[34:35], v21 offset:16400
ds_read_b32 v65, v22 offset:1024
ds_read_b64 v[36:37], v21 offset:16416
ds_read_b32 v66, v22 offset:2048
ds_read_b64 v[38:39], v21 offset:16432
ds_read_b32 v67, v22 offset:3072
ds_read_b64 v[40:41], v21 offset:16448
ds_read_b32 v68, v22 offset:4096
ds_read_b64 v[42:43], v21 offset:16464
ds_read_b32 v69, v22 offset:5120
ds_read_b64 v[44:45], v21 offset:16480
ds_read_b32 v70, v22 offset:6144
ds_read_b64 v[46:47], v21 offset:16496
ds_read_b32 v71, v22 offset:7168
ds_read_b64 v[48:49], v21 offset:16512
ds_read_b32 v72, v22 offset:8192
ds_read_b64 v[50:51], v21 offset:16528
ds_read_b32 v73, v22 offset:9216
ds_read_b64 v[52:53], v21 offset:16544
ds_read_b32 v74, v22 offset:10240
ds_read_b64 v[54:55], v21 offset:16560
ds_read_b32 v75, v22 offset:11264
ds_read_b64 v[56:57], v21 offset:16576
ds_read_b32 v76, v22 offset:12288
ds_read_b64 v[58:59], v21 offset:16592
ds_read_b32 v77, v22 offset:13312
ds_read_b64 v[60:61], v21 offset:16608
ds_read_b32 v78, v22 offset:14336
ds_read_b64 v[62:63], v21 offset:16624
ds_read_b32 v79, v22 offset:15360
s_waitcnt lgkmcnt(0)
v_mov_b32 v23, v32
v_max_f32 v23, v23, v34
v_max_f32 v23, v23, v36
v_max_f32 v23, v23, v38
v_max_f32 v23, v23, v40
v_max_f32 v23, v23, v42
v_max_f32 v23, v23, v44
v_max_f32 v23, v23, v46
v_max_f32 v23, v23, v48
v_max_f32 v23, v23, v50
v_max_f32 v23, v23, v52
v_max_f32 v23, v23, v54
v_max_f32 v23, v23, v56
v_max_f32 v23, v23, v58
v_max_f32 v23, v23, v60
v_max_f32 v23, v23, v62
v_mov_b32 v24, 0
v_mov_b32 v25, 0
v_sub_f32 v26, v32, v23
v_exp_f32 v26, v26
s_nop 0
v_fmac_f32 v24, v26, v33
v_fmac_f32 v25, v26, v64
v_sub_f32 v26, v34, v23
v_exp_f32 v26, v26
s_nop 0
v_fmac_f32 v24, v26, v35
v_fmac_f32 v25, v26, v65
v_sub_f32 v26, v36, v23
v_exp_f32 v26, v26
s_nop 0
v_fmac_f32 v24, v26, v37
v_fmac_f32 v25, v26, v66
v_sub_f32 v26, v38, v23
v_exp_f32 v26, v26
s_nop 0
v_fmac_f32 v24, v26, v39
v_fmac_f32 v25, v26, v67
v_sub_f32 v26, v40, v23
v_exp_f32 v26, v26
s_nop 0
v_fmac_f32 v24, v26, v41
v_fmac_f32 v25, v26, v68
v_sub_f32 v26, v42, v23
v_exp_f32 v26, v26
s_nop 0
v_fmac_f32 v24, v26, v43
v_fmac_f32 v25, v26, v69
v_sub_f32 v26, v44, v23
v_exp_f32 v26, v26
s_nop 0
v_fmac_f32 v24, v26, v45
v_fmac_f32 v25, v26, v70
v_sub_f32 v26, v46, v23
v_exp_f32 v26, v26
s_nop 0
v_fmac_f32 v24, v26, v47
v_fmac_f32 v25, v26, v71
v_sub_f32 v26, v48, v23
v_exp_f32 v26, v26
s_nop 0
v_fmac_f32 v24, v26, v49
v_fmac_f32 v25, v26, v72
v_sub_f32 v26, v50, v23
v_exp_f32 v26, v26
s_nop 0
v_fmac_f32 v24, v26, v51
v_fmac_f32 v25, v26, v73
v_sub_f32 v26, v52, v23
v_exp_f32 v26, v26
s_nop 0
v_fmac_f32 v24, v26, v53
v_fmac_f32 v25, v26, v74
v_sub_f32 v26, v54, v23
v_exp_f32 v26, v26
s_nop 0
v_fmac_f32 v24, v26, v55
v_fmac_f32 v25, v26, v75
v_sub_f32 v26, v56, v23
v_exp_f32 v26, v26
s_nop 0
v_fmac_f32 v24, v26, v57
v_fmac_f32 v25, v26, v76
v_sub_f32 v26, v58, v23
v_exp_f32 v26, v26
s_nop 0
v_fmac_f32 v24, v26, v59
v_fmac_f32 v25, v26, v77
v_sub_f32 v26, v60, v23
v_exp_f32 v26, v26
s_nop 0
v_fmac_f32 v24, v26, v61
v_fmac_f32 v25, v26, v78
v_sub_f32 v26, v62, v23
v_exp_f32 v26, v26
s_nop 0
v_fmac_f32 v24, v26, v63
v_fmac_f32 v25, v26, v79
s_lshl_b32 s6, s2, 10
s_add_u32 s6, s6, 262144
buffer_store_dword v25, v22, s[24:27], s6 offen sc1
s_lshl_b32 s6, s2, 4
s_add_u32 s6, s6, 786432
v_mov_b32 v28, v23
v_mov_b32 v29, v24
buffer_store_dwordx2 v[28:29], v21, s[24:27], s6 offen sc1
s_waitcnt vmcnt(0)
s_barrier
s_lshr_b32 s6, s4, 1
s_lshl_b32 s6, s6, 2
s_and_b32 s17, s4, 1
s_lshl_b32 s17, s17, 4
s_lshl_b32 s18, 1, s17
v_mov_b32 v26, s18
v_mov_b32 v27, 0
ds_write_b32 v27, v27 offset:20000
v_cmp_eq_u32 vcc, 0, v0
s_and_saveexec_b64 s[28:29], vcc
s_cbranch_execz k3_na
buffer_atomic_add v26, v27, s[20:23], s6 offen sc0
s_waitcnt vmcnt(0)
ds_write_b32 v27, v26 offset:20000
s_waitcnt lgkmcnt(0)
k3_na:
s_or_b64 exec, exec, s[28:29]
s_barrier
ds_read_b32 v26, v27 offset:20000
s_waitcnt lgkmcnt(0)
v_readfirstlane_b32 s18, v26
s_lshr_b32 s18, s18, s17
s_and_b32 s18, s18, 0xffff
s_cmp_lg_u32 s18, 3
s_cbranch_scc1 k3_kernel_end
s_lshl_b32 s6, s4, 12
s_add_u32 s6, s6, 262144
s_lshl_b32 s19, s4, 6
s_add_u32 s19, s19, 786432
buffer_load_dword v64, v22, s[24:27], s6 offen offset:0 sc1
buffer_load_dwordx2 v[32:33], v21, s[24:27], s19 offen offset:0 sc1
buffer_load_dword v65, v22, s[24:27], s6 offen offset:1024 sc1
buffer_load_dwordx2 v[34:35], v21, s[24:27], s19 offen offset:16 sc1
buffer_load_dword v66, v22, s[24:27], s6 offen offset:2048 sc1
buffer_load_dwordx2 v[36:37], v21, s[24:27], s19 offen offset:32 sc1
buffer_load_dword v67, v22, s[24:27], s6 offen offset:3072 sc1
buffer_load_dwordx2 v[38:39], v21, s[24:27], s19 offen offset:48 sc1
s_waitcnt vmcnt(0)
v_max3_f32 v23, v32, v34, v36
v_max_f32 v23, v23, v38
v_mov_b32 v24, 0
v_mov_b32 v25, 0
v_sub_f32 v26, v32, v23
v_exp_f32 v26, v26
s_nop 0
v_fmac_f32 v24, v26, v33
v_fmac_f32 v25, v26, v64
v_sub_f32 v26, v34, v23
v_exp_f32 v26, v26
s_nop 0
v_fmac_f32 v24, v26, v35
v_fmac_f32 v25, v26, v65
v_sub_f32 v26, v36, v23
v_exp_f32 v26, v26
s_nop 0
v_fmac_f32 v24, v26, v37
v_fmac_f32 v25, v26, v66
v_sub_f32 v26, v38, v23
v_exp_f32 v26, v26
s_nop 0
v_fmac_f32 v24, v26, v39
v_fmac_f32 v25, v26, v67
v_rcp_f32 v24, v24
s_nop 0
v_mul_f32 v25, v25, v24
v_cvt_pk_bf16_f32 v25, v25, v25
v_lshlrev_b32 v22, 1, v0
s_lshl_b32 s6, s4, 9
s_add_u32 s6, s6, 851968
buffer_store_short v25, v22, s[24:27], s6 offen
k3_kernel_end:
s_endpgm
.globl k4_kernel
.p2align 8
.type k4_kernel,@function
k4_kernel:
s_cmp_ge_u32 s2, 72
s_cbranch_scc1 k4_kernel_end
s_load_dwordx2 s[8:9], s[0:1], 32
s_mov_b32 s10, 4718592
s_mov_b32 s11, 0x00020000
s_load_dwordx2 s[24:25], s[0:1], 104
s_mov_b32 s26, 2097152
s_mov_b32 s27, 0x00020000
s_load_dwordx2 s[20:21], s[0:1], 96
s_mov_b32 s22, 256
s_mov_b32 s23, 0x00020000
s_waitcnt lgkmcnt(0)
s_mul_hi_u32 s4, s2, 477218589
s_mul_i32 s5, s4, 9
s_sub_u32 s5, s2, s5
s_lshl_b32 s6, s4, 9
v_and_b32 v220, 7, v0
v_lshrrev_b32 v221, 3, v0
v_mul_u32_u24 v222, 18432, v221
v_lshl_add_u32 v222, v220, 4, v222
s_mul_i32 s29, s6, 1152
s_lshl_b32 s28, s5, 7
s_add_u32 s29, s29, s28
v_add_u32 v224, 0, v222
buffer_load_dwordx4 v[100:103], v224, s[8:11], s29 offen
v_add_u32 v224, 1152, v222
buffer_load_dwordx4 v[104:107], v224, s[8:11], s29 offen
v_add_u32 v224, 2304, v222
buffer_load_dwordx4 v[108:111], v224, s[8:11], s29 offen
v_add_u32 v224, 3456, v222
buffer_load_dwordx4 v[112:115], v224, s[8:11], s29 offen
v_add_u32 v224, 4608, v222
buffer_load_dwordx4 v[116:119], v224, s[8:11], s29 offen
v_add_u32 v224, 5760, v222
buffer_load_dwordx4 v[120:123], v224, s[8:11], s29 offen
v_add_u32 v224, 6912, v222
buffer_load_dwordx4 v[124:127], v224, s[8:11], s29 offen
v_add_u32 v224, 8064, v222
buffer_load_dwordx4 v[128:131], v224, s[8:11], s29 offen
v_add_u32 v224, 9216, v222
buffer_load_dwordx4 v[132:135], v224, s[8:11], s29 offen
v_add_u32 v224, 10368, v222
buffer_load_dwordx4 v[136:139], v224, s[8:11], s29 offen
v_add_u32 v224, 11520, v222
buffer_load_dwordx4 v[140:143], v224, s[8:11], s29 offen
v_add_u32 v224, 12672, v222
buffer_load_dwordx4 v[144:147], v224, s[8:11], s29 offen
v_add_u32 v224, 13824, v222
buffer_load_dwordx4 v[148:151], v224, s[8:11], s29 offen
v_add_u32 v224, 14976, v222
buffer_load_dwordx4 v[152:155], v224, s[8:11], s29 offen
v_add_u32 v224, 16128, v222
buffer_load_dwordx4 v[156:159], v224, s[8:11], s29 offen
v_add_u32 v224, 17280, v222
buffer_load_dwordx4 v[160:163], v224, s[8:11], s29 offen
v_lshrrev_b32 v200, 5, v0
v_and_b32 v201, 31, v0
v_mul_u32_u24 v204, 8192, v200
v_lshl_add_u32 v204, v201, 4, v204
s_lshl_b32 s28, s4, 10
s_add_u32 s28, s28, 851968
buffer_load_dwordx4 v[4:7], v204, s[24:27], s28 offen
buffer_load_dwordx4 v[8:11], v204, s[24:27], s28 offen offset:512
v_lshlrev_b32 v207, 7, v201
v_lshl_add_u32 v207, v200, 2, v207
s_waitcnt vmcnt(0)
ds_write_b32 v207, v4 offset:0
ds_write_b32 v207, v8 offset:4096
ds_write_b32 v207, v5 offset:32
ds_write_b32 v207, v9 offset:4128
ds_write_b32 v207, v6 offset:64
ds_write_b32 v207, v10 offset:4160
ds_write_b32 v207, v7 offset:96
ds_write_b32 v207, v11 offset:4192
s_waitcnt lgkmcnt(0)
s_barrier
s_mov_b32 s30, 0x05040100
s_mov_b32 s31, 0x07060302
v_mul_u32_u24 v223, 256, v221
v_mov_b32 v4, 0
v_mov_b32 v5, 0
v_mov_b32 v6, 0
v_mov_b32 v7, 0
v_mov_b32 v8, 0
v_mov_b32 v9, 0
v_mov_b32 v10, 0
v_mov_b32 v11, 0
v_mov_b32 v12, 0
v_mov_b32 v13, 0
v_mov_b32 v14, 0
v_mov_b32 v15, 0
v_mov_b32 v16, 0
v_mov_b32 v17, 0
v_mov_b32 v18, 0
v_mov_b32 v19, 0
v_mov_b32 v20, 0
v_mov_b32 v21, 0
v_mov_b32 v22, 0
v_mov_b32 v23, 0
v_mov_b32 v24, 0
v_mov_b32 v25, 0
v_mov_b32 v26, 0
v_mov_b32 v27, 0
v_mov_b32 v28, 0
v_mov_b32 v29, 0
v_mov_b32 v30, 0
v_mov_b32 v31, 0
v_mov_b32 v32, 0
v_mov_b32 v33, 0
v_mov_b32 v34, 0
v_mov_b32 v35, 0
v_mov_b32 v36, 0
v_mov_b32 v37, 0
v_mov_b32 v38, 0
v_mov_b32 v39, 0
v_mov_b32 v40, 0
v_mov_b32 v41, 0
v_mov_b32 v42, 0
v_mov_b32 v43, 0
v_mov_b32 v44, 0
v_mov_b32 v45, 0
v_mov_b32 v46, 0
v_mov_b32 v47, 0
v_mov_b32 v48, 0
v_mov_b32 v49, 0
v_mov_b32 v50, 0
v_mov_b32 v51, 0
v_mov_b32 v52, 0
v_mov_b32 v53, 0
v_mov_b32 v54, 0
v_mov_b32 v55, 0
v_mov_b32 v56, 0
v_mov_b32 v57, 0
v_mov_b32 v58, 0
v_mov_b32 v59, 0
v_mov_b32 v60, 0
v_mov_b32 v61, 0
v_mov_b32 v62, 0
v_mov_b32 v63, 0
v_mov_b32 v64, 0
v_mov_b32 v65, 0
v_mov_b32 v66, 0
v_mov_b32 v67, 0
ds_read_b128 v[80:83], v223 offset:0
ds_read_b128 v[84:87], v223 offset:16
s_waitcnt vmcnt(14) lgkmcnt(0)
v_perm_b32 v90, v104, v100, s30
v_perm_b32 v91, v104, v100, s31
v_perm_b32 v92, v105, v101, s30
v_perm_b32 v93, v105, v101, s31
v_perm_b32 v94, v106, v102, s30
v_perm_b32 v95, v106, v102, s31
v_perm_b32 v96, v107, v103, s30
v_perm_b32 v97, v107, v103, s31
v_dot2_f32_bf16 v4, v90, v80, v4
v_dot2_f32_bf16 v5, v91, v80, v5
v_dot2_f32_bf16 v6, v92, v80, v6
v_dot2_f32_bf16 v7, v93, v80, v7
v_dot2_f32_bf16 v8, v94, v80, v8
v_dot2_f32_bf16 v9, v95, v80, v9
v_dot2_f32_bf16 v10, v96, v80, v10
v_dot2_f32_bf16 v11, v97, v80, v11
v_dot2_f32_bf16 v12, v90, v81, v12
v_dot2_f32_bf16 v13, v91, v81, v13
v_dot2_f32_bf16 v14, v92, v81, v14
v_dot2_f32_bf16 v15, v93, v81, v15
v_dot2_f32_bf16 v16, v94, v81, v16
v_dot2_f32_bf16 v17, v95, v81, v17
v_dot2_f32_bf16 v18, v96, v81, v18
v_dot2_f32_bf16 v19, v97, v81, v19
v_dot2_f32_bf16 v20, v90, v82, v20
v_dot2_f32_bf16 v21, v91, v82, v21
v_dot2_f32_bf16 v22, v92, v82, v22
v_dot2_f32_bf16 v23, v93, v82, v23
v_dot2_f32_bf16 v24, v94, v82, v24
v_dot2_f32_bf16 v25, v95, v82, v25
v_dot2_f32_bf16 v26, v96, v82, v26
v_dot2_f32_bf16 v27, v97, v82, v27
v_dot2_f32_bf16 v28, v90, v83, v28
v_dot2_f32_bf16 v29, v91, v83, v29
v_dot2_f32_bf16 v30, v92, v83, v30
v_dot2_f32_bf16 v31, v93, v83, v31
v_dot2_f32_bf16 v32, v94, v83, v32
v_dot2_f32_bf16 v33, v95, v83, v33
v_dot2_f32_bf16 v34, v96, v83, v34
v_dot2_f32_bf16 v35, v97, v83, v35
v_dot2_f32_bf16 v36, v90, v84, v36
v_dot2_f32_bf16 v37, v91, v84, v37
v_dot2_f32_bf16 v38, v92, v84, v38
v_dot2_f32_bf16 v39, v93, v84, v39
v_dot2_f32_bf16 v40, v94, v84, v40
v_dot2_f32_bf16 v41, v95, v84, v41
v_dot2_f32_bf16 v42, v96, v84, v42
v_dot2_f32_bf16 v43, v97, v84, v43
v_dot2_f32_bf16 v44, v90, v85, v44
v_dot2_f32_bf16 v45, v91, v85, v45
v_dot2_f32_bf16 v46, v92, v85, v46
v_dot2_f32_bf16 v47, v93, v85, v47
v_dot2_f32_bf16 v48, v94, v85, v48
v_dot2_f32_bf16 v49, v95, v85, v49
v_dot2_f32_bf16 v50, v96, v85, v50
v_dot2_f32_bf16 v51, v97, v85, v51
v_dot2_f32_bf16 v52, v90, v86, v52
v_dot2_f32_bf16 v53, v91, v86, v53
v_dot2_f32_bf16 v54, v92, v86, v54
v_dot2_f32_bf16 v55, v93, v86, v55
v_dot2_f32_bf16 v56, v94, v86, v56
v_dot2_f32_bf16 v57, v95, v86, v57
v_dot2_f32_bf16 v58, v96, v86, v58
v_dot2_f32_bf16 v59, v97, v86, v59
v_dot2_f32_bf16 v60, v90, v87, v60
v_dot2_f32_bf16 v61, v91, v87, v61
v_dot2_f32_bf16 v62, v92, v87, v62
v_dot2_f32_bf16 v63, v93, v87, v63
v_dot2_f32_bf16 v64, v94, v87, v64
v_dot2_f32_bf16 v65, v95, v87, v65
v_dot2_f32_bf16 v66, v96, v87, v66
v_dot2_f32_bf16 v67, v97, v87, v67
ds_read_b128 v[80:83], v223 offset:32
ds_read_b128 v[84:87], v223 offset:48
s_waitcnt vmcnt(12) lgkmcnt(0)
v_perm_b32 v90, v112, v108, s30
v_perm_b32 v91, v112, v108, s31
v_perm_b32 v92, v113, v109, s30
v_perm_b32 v93, v113, v109, s31
v_perm_b32 v94, v114, v110, s30
v_perm_b32 v95, v114, v110, s31
v_perm_b32 v96, v115, v111, s30
v_perm_b32 v97, v115, v111, s31
v_dot2_f32_bf16 v4, v90, v80, v4
v_dot2_f32_bf16 v5, v91, v80, v5
v_dot2_f32_bf16 v6, v92, v80, v6
v_dot2_f32_bf16 v7, v93, v80, v7
v_dot2_f32_bf16 v8, v94, v80, v8
v_dot2_f32_bf16 v9, v95, v80, v9
v_dot2_f32_bf16 v10, v96, v80, v10
v_dot2_f32_bf16 v11, v97, v80, v11
v_dot2_f32_bf16 v12, v90, v81, v12
v_dot2_f32_bf16 v13, v91, v81, v13
v_dot2_f32_bf16 v14, v92, v81, v14
v_dot2_f32_bf16 v15, v93, v81, v15
v_dot2_f32_bf16 v16, v94, v81, v16
v_dot2_f32_bf16 v17, v95, v81, v17
v_dot2_f32_bf16 v18, v96, v81, v18
v_dot2_f32_bf16 v19, v97, v81, v19
v_dot2_f32_bf16 v20, v90, v82, v20
v_dot2_f32_bf16 v21, v91, v82, v21
v_dot2_f32_bf16 v22, v92, v82, v22
v_dot2_f32_bf16 v23, v93, v82, v23
v_dot2_f32_bf16 v24, v94, v82, v24
v_dot2_f32_bf16 v25, v95, v82, v25
v_dot2_f32_bf16 v26, v96, v82, v26
v_dot2_f32_bf16 v27, v97, v82, v27
v_dot2_f32_bf16 v28, v90, v83, v28
v_dot2_f32_bf16 v29, v91, v83, v29
v_dot2_f32_bf16 v30, v92, v83, v30
v_dot2_f32_bf16 v31, v93, v83, v31
v_dot2_f32_bf16 v32, v94, v83, v32
v_dot2_f32_bf16 v33, v95, v83, v33
v_dot2_f32_bf16 v34, v96, v83, v34
v_dot2_f32_bf16 v35, v97, v83, v35
v_dot2_f32_bf16 v36, v90, v84, v36
v_dot2_f32_bf16 v37, v91, v84, v37
v_dot2_f32_bf16 v38, v92, v84, v38
v_dot2_f32_bf16 v39, v93, v84, v39
v_dot2_f32_bf16 v40, v94, v84, v40
v_dot2_f32_bf16 v41, v95, v84, v41
v_dot2_f32_bf16 v42, v96, v84, v42
v_dot2_f32_bf16 v43, v97, v84, v43
v_dot2_f32_bf16 v44, v90, v85, v44
v_dot2_f32_bf16 v45, v91, v85, v45
v_dot2_f32_bf16 v46, v92, v85, v46
v_dot2_f32_bf16 v47, v93, v85, v47
v_dot2_f32_bf16 v48, v94, v85, v48
v_dot2_f32_bf16 v49, v95, v85, v49
v_dot2_f32_bf16 v50, v96, v85, v50
v_dot2_f32_bf16 v51, v97, v85, v51
v_dot2_f32_bf16 v52, v90, v86, v52
v_dot2_f32_bf16 v53, v91, v86, v53
v_dot2_f32_bf16 v54, v92, v86, v54
v_dot2_f32_bf16 v55, v93, v86, v55
v_dot2_f32_bf16 v56, v94, v86, v56
v_dot2_f32_bf16 v57, v95, v86, v57
v_dot2_f32_bf16 v58, v96, v86, v58
v_dot2_f32_bf16 v59, v97, v86, v59
v_dot2_f32_bf16 v60, v90, v87, v60
v_dot2_f32_bf16 v61, v91, v87, v61
v_dot2_f32_bf16 v62, v92, v87, v62
v_dot2_f32_bf16 v63, v93, v87, v63
v_dot2_f32_bf16 v64, v94, v87, v64
v_dot2_f32_bf16 v65, v95, v87, v65
v_dot2_f32_bf16 v66, v96, v87, v66
v_dot2_f32_bf16 v67, v97, v87, v67
ds_read_b128 v[80:83], v223 offset:64
ds_read_b128 v[84:87], v223 offset:80
s_waitcnt vmcnt(10) lgkmcnt(0)
v_perm_b32 v90, v120, v116, s30
v_perm_b32 v91, v120, v116, s31
v_perm_b32 v92, v121, v117, s30
v_perm_b32 v93, v121, v117, s31
v_perm_b32 v94, v122, v118, s30
v_perm_b32 v95, v122, v118, s31
v_perm_b32 v96, v123, v119, s30
v_perm_b32 v97, v123, v119, s31
v_dot2_f32_bf16 v4, v90, v80, v4
v_dot2_f32_bf16 v5, v91, v80, v5
v_dot2_f32_bf16 v6, v92, v80, v6
v_dot2_f32_bf16 v7, v93, v80, v7
v_dot2_f32_bf16 v8, v94, v80, v8
v_dot2_f32_bf16 v9, v95, v80, v9
v_dot2_f32_bf16 v10, v96, v80, v10
v_dot2_f32_bf16 v11, v97, v80, v11
v_dot2_f32_bf16 v12, v90, v81, v12
v_dot2_f32_bf16 v13, v91, v81, v13
v_dot2_f32_bf16 v14, v92, v81, v14
v_dot2_f32_bf16 v15, v93, v81, v15
v_dot2_f32_bf16 v16, v94, v81, v16
v_dot2_f32_bf16 v17, v95, v81, v17
v_dot2_f32_bf16 v18, v96, v81, v18
v_dot2_f32_bf16 v19, v97, v81, v19
v_dot2_f32_bf16 v20, v90, v82, v20
v_dot2_f32_bf16 v21, v91, v82, v21
v_dot2_f32_bf16 v22, v92, v82, v22
v_dot2_f32_bf16 v23, v93, v82, v23
v_dot2_f32_bf16 v24, v94, v82, v24
v_dot2_f32_bf16 v25, v95, v82, v25
v_dot2_f32_bf16 v26, v96, v82, v26
v_dot2_f32_bf16 v27, v97, v82, v27
v_dot2_f32_bf16 v28, v90, v83, v28
v_dot2_f32_bf16 v29, v91, v83, v29
v_dot2_f32_bf16 v30, v92, v83, v30
v_dot2_f32_bf16 v31, v93, v83, v31
v_dot2_f32_bf16 v32, v94, v83, v32
v_dot2_f32_bf16 v33, v95, v83, v33
v_dot2_f32_bf16 v34, v96, v83, v34
v_dot2_f32_bf16 v35, v97, v83, v35
v_dot2_f32_bf16 v36, v90, v84, v36
v_dot2_f32_bf16 v37, v91, v84, v37
v_dot2_f32_bf16 v38, v92, v84, v38
v_dot2_f32_bf16 v39, v93, v84, v39
v_dot2_f32_bf16 v40, v94, v84, v40
v_dot2_f32_bf16 v41, v95, v84, v41
v_dot2_f32_bf16 v42, v96, v84, v42
v_dot2_f32_bf16 v43, v97, v84, v43
v_dot2_f32_bf16 v44, v90, v85, v44
v_dot2_f32_bf16 v45, v91, v85, v45
v_dot2_f32_bf16 v46, v92, v85, v46
v_dot2_f32_bf16 v47, v93, v85, v47
v_dot2_f32_bf16 v48, v94, v85, v48
v_dot2_f32_bf16 v49, v95, v85, v49
v_dot2_f32_bf16 v50, v96, v85, v50
v_dot2_f32_bf16 v51, v97, v85, v51
v_dot2_f32_bf16 v52, v90, v86, v52
v_dot2_f32_bf16 v53, v91, v86, v53
v_dot2_f32_bf16 v54, v92, v86, v54
v_dot2_f32_bf16 v55, v93, v86, v55
v_dot2_f32_bf16 v56, v94, v86, v56
v_dot2_f32_bf16 v57, v95, v86, v57
v_dot2_f32_bf16 v58, v96, v86, v58
v_dot2_f32_bf16 v59, v97, v86, v59
v_dot2_f32_bf16 v60, v90, v87, v60
v_dot2_f32_bf16 v61, v91, v87, v61
v_dot2_f32_bf16 v62, v92, v87, v62
v_dot2_f32_bf16 v63, v93, v87, v63
v_dot2_f32_bf16 v64, v94, v87, v64
v_dot2_f32_bf16 v65, v95, v87, v65
v_dot2_f32_bf16 v66, v96, v87, v66
v_dot2_f32_bf16 v67, v97, v87, v67
ds_read_b128 v[80:83], v223 offset:96
ds_read_b128 v[84:87], v223 offset:112
s_waitcnt vmcnt(8) lgkmcnt(0)
v_perm_b32 v90, v128, v124, s30
v_perm_b32 v91, v128, v124, s31
v_perm_b32 v92, v129, v125, s30
v_perm_b32 v93, v129, v125, s31
v_perm_b32 v94, v130, v126, s30
v_perm_b32 v95, v130, v126, s31
v_perm_b32 v96, v131, v127, s30
v_perm_b32 v97, v131, v127, s31
v_dot2_f32_bf16 v4, v90, v80, v4
v_dot2_f32_bf16 v5, v91, v80, v5
v_dot2_f32_bf16 v6, v92, v80, v6
v_dot2_f32_bf16 v7, v93, v80, v7
v_dot2_f32_bf16 v8, v94, v80, v8
v_dot2_f32_bf16 v9, v95, v80, v9
v_dot2_f32_bf16 v10, v96, v80, v10
v_dot2_f32_bf16 v11, v97, v80, v11
v_dot2_f32_bf16 v12, v90, v81, v12
v_dot2_f32_bf16 v13, v91, v81, v13
v_dot2_f32_bf16 v14, v92, v81, v14
v_dot2_f32_bf16 v15, v93, v81, v15
v_dot2_f32_bf16 v16, v94, v81, v16
v_dot2_f32_bf16 v17, v95, v81, v17
v_dot2_f32_bf16 v18, v96, v81, v18
v_dot2_f32_bf16 v19, v97, v81, v19
v_dot2_f32_bf16 v20, v90, v82, v20
v_dot2_f32_bf16 v21, v91, v82, v21
v_dot2_f32_bf16 v22, v92, v82, v22
v_dot2_f32_bf16 v23, v93, v82, v23
v_dot2_f32_bf16 v24, v94, v82, v24
v_dot2_f32_bf16 v25, v95, v82, v25
v_dot2_f32_bf16 v26, v96, v82, v26
v_dot2_f32_bf16 v27, v97, v82, v27
v_dot2_f32_bf16 v28, v90, v83, v28
v_dot2_f32_bf16 v29, v91, v83, v29
v_dot2_f32_bf16 v30, v92, v83, v30
v_dot2_f32_bf16 v31, v93, v83, v31
v_dot2_f32_bf16 v32, v94, v83, v32
v_dot2_f32_bf16 v33, v95, v83, v33
v_dot2_f32_bf16 v34, v96, v83, v34
v_dot2_f32_bf16 v35, v97, v83, v35
v_dot2_f32_bf16 v36, v90, v84, v36
v_dot2_f32_bf16 v37, v91, v84, v37
v_dot2_f32_bf16 v38, v92, v84, v38
v_dot2_f32_bf16 v39, v93, v84, v39
v_dot2_f32_bf16 v40, v94, v84, v40
v_dot2_f32_bf16 v41, v95, v84, v41
v_dot2_f32_bf16 v42, v96, v84, v42
v_dot2_f32_bf16 v43, v97, v84, v43
v_dot2_f32_bf16 v44, v90, v85, v44
v_dot2_f32_bf16 v45, v91, v85, v45
v_dot2_f32_bf16 v46, v92, v85, v46
v_dot2_f32_bf16 v47, v93, v85, v47
v_dot2_f32_bf16 v48, v94, v85, v48
v_dot2_f32_bf16 v49, v95, v85, v49
v_dot2_f32_bf16 v50, v96, v85, v50
v_dot2_f32_bf16 v51, v97, v85, v51
v_dot2_f32_bf16 v52, v90, v86, v52
v_dot2_f32_bf16 v53, v91, v86, v53
v_dot2_f32_bf16 v54, v92, v86, v54
v_dot2_f32_bf16 v55, v93, v86, v55
v_dot2_f32_bf16 v56, v94, v86, v56
v_dot2_f32_bf16 v57, v95, v86, v57
v_dot2_f32_bf16 v58, v96, v86, v58
v_dot2_f32_bf16 v59, v97, v86, v59
v_dot2_f32_bf16 v60, v90, v87, v60
v_dot2_f32_bf16 v61, v91, v87, v61
v_dot2_f32_bf16 v62, v92, v87, v62
v_dot2_f32_bf16 v63, v93, v87, v63
v_dot2_f32_bf16 v64, v94, v87, v64
v_dot2_f32_bf16 v65, v95, v87, v65
v_dot2_f32_bf16 v66, v96, v87, v66
v_dot2_f32_bf16 v67, v97, v87, v67
ds_read_b128 v[80:83], v223 offset:128
ds_read_b128 v[84:87], v223 offset:144
s_waitcnt vmcnt(6) lgkmcnt(0)
v_perm_b32 v90, v136, v132, s30
v_perm_b32 v91, v136, v132, s31
v_perm_b32 v92, v137, v133, s30
v_perm_b32 v93, v137, v133, s31
v_perm_b32 v94, v138, v134, s30
v_perm_b32 v95, v138, v134, s31
v_perm_b32 v96, v139, v135, s30
v_perm_b32 v97, v139, v135, s31
v_dot2_f32_bf16 v4, v90, v80, v4
v_dot2_f32_bf16 v5, v91, v80, v5
v_dot2_f32_bf16 v6, v92, v80, v6
v_dot2_f32_bf16 v7, v93, v80, v7
v_dot2_f32_bf16 v8, v94, v80, v8
v_dot2_f32_bf16 v9, v95, v80, v9
v_dot2_f32_bf16 v10, v96, v80, v10
v_dot2_f32_bf16 v11, v97, v80, v11
v_dot2_f32_bf16 v12, v90, v81, v12
v_dot2_f32_bf16 v13, v91, v81, v13
v_dot2_f32_bf16 v14, v92, v81, v14
v_dot2_f32_bf16 v15, v93, v81, v15
v_dot2_f32_bf16 v16, v94, v81, v16
v_dot2_f32_bf16 v17, v95, v81, v17
v_dot2_f32_bf16 v18, v96, v81, v18
v_dot2_f32_bf16 v19, v97, v81, v19
v_dot2_f32_bf16 v20, v90, v82, v20
v_dot2_f32_bf16 v21, v91, v82, v21
v_dot2_f32_bf16 v22, v92, v82, v22
v_dot2_f32_bf16 v23, v93, v82, v23
v_dot2_f32_bf16 v24, v94, v82, v24
v_dot2_f32_bf16 v25, v95, v82, v25
v_dot2_f32_bf16 v26, v96, v82, v26
v_dot2_f32_bf16 v27, v97, v82, v27
v_dot2_f32_bf16 v28, v90, v83, v28
v_dot2_f32_bf16 v29, v91, v83, v29
v_dot2_f32_bf16 v30, v92, v83, v30
v_dot2_f32_bf16 v31, v93, v83, v31
v_dot2_f32_bf16 v32, v94, v83, v32
v_dot2_f32_bf16 v33, v95, v83, v33
v_dot2_f32_bf16 v34, v96, v83, v34
v_dot2_f32_bf16 v35, v97, v83, v35
v_dot2_f32_bf16 v36, v90, v84, v36
v_dot2_f32_bf16 v37, v91, v84, v37
v_dot2_f32_bf16 v38, v92, v84, v38
v_dot2_f32_bf16 v39, v93, v84, v39
v_dot2_f32_bf16 v40, v94, v84, v40
v_dot2_f32_bf16 v41, v95, v84, v41
v_dot2_f32_bf16 v42, v96, v84, v42
v_dot2_f32_bf16 v43, v97, v84, v43
v_dot2_f32_bf16 v44, v90, v85, v44
v_dot2_f32_bf16 v45, v91, v85, v45
v_dot2_f32_bf16 v46, v92, v85, v46
v_dot2_f32_bf16 v47, v93, v85, v47
v_dot2_f32_bf16 v48, v94, v85, v48
v_dot2_f32_bf16 v49, v95, v85, v49
v_dot2_f32_bf16 v50, v96, v85, v50
v_dot2_f32_bf16 v51, v97, v85, v51
v_dot2_f32_bf16 v52, v90, v86, v52
v_dot2_f32_bf16 v53, v91, v86, v53
v_dot2_f32_bf16 v54, v92, v86, v54
v_dot2_f32_bf16 v55, v93, v86, v55
v_dot2_f32_bf16 v56, v94, v86, v56
v_dot2_f32_bf16 v57, v95, v86, v57
v_dot2_f32_bf16 v58, v96, v86, v58
v_dot2_f32_bf16 v59, v97, v86, v59
v_dot2_f32_bf16 v60, v90, v87, v60
v_dot2_f32_bf16 v61, v91, v87, v61
v_dot2_f32_bf16 v62, v92, v87, v62
v_dot2_f32_bf16 v63, v93, v87, v63
v_dot2_f32_bf16 v64, v94, v87, v64
v_dot2_f32_bf16 v65, v95, v87, v65
v_dot2_f32_bf16 v66, v96, v87, v66
v_dot2_f32_bf16 v67, v97, v87, v67
ds_read_b128 v[80:83], v223 offset:160
ds_read_b128 v[84:87], v223 offset:176
s_waitcnt vmcnt(4) lgkmcnt(0)
v_perm_b32 v90, v144, v140, s30
v_perm_b32 v91, v144, v140, s31
v_perm_b32 v92, v145, v141, s30
v_perm_b32 v93, v145, v141, s31
v_perm_b32 v94, v146, v142, s30
v_perm_b32 v95, v146, v142, s31
v_perm_b32 v96, v147, v143, s30
v_perm_b32 v97, v147, v143, s31
v_dot2_f32_bf16 v4, v90, v80, v4
v_dot2_f32_bf16 v5, v91, v80, v5
v_dot2_f32_bf16 v6, v92, v80, v6
v_dot2_f32_bf16 v7, v93, v80, v7
v_dot2_f32_bf16 v8, v94, v80, v8
v_dot2_f32_bf16 v9, v95, v80, v9
v_dot2_f32_bf16 v10, v96, v80, v10
v_dot2_f32_bf16 v11, v97, v80, v11
v_dot2_f32_bf16 v12, v90, v81, v12
v_dot2_f32_bf16 v13, v91, v81, v13
v_dot2_f32_bf16 v14, v92, v81, v14
v_dot2_f32_bf16 v15, v93, v81, v15
v_dot2_f32_bf16 v16, v94, v81, v16
v_dot2_f32_bf16 v17, v95, v81, v17
v_dot2_f32_bf16 v18, v96, v81, v18
v_dot2_f32_bf16 v19, v97, v81, v19
v_dot2_f32_bf16 v20, v90, v82, v20
v_dot2_f32_bf16 v21, v91, v82, v21
v_dot2_f32_bf16 v22, v92, v82, v22
v_dot2_f32_bf16 v23, v93, v82, v23
v_dot2_f32_bf16 v24, v94, v82, v24
v_dot2_f32_bf16 v25, v95, v82, v25
v_dot2_f32_bf16 v26, v96, v82, v26
v_dot2_f32_bf16 v27, v97, v82, v27
v_dot2_f32_bf16 v28, v90, v83, v28
v_dot2_f32_bf16 v29, v91, v83, v29
v_dot2_f32_bf16 v30, v92, v83, v30
v_dot2_f32_bf16 v31, v93, v83, v31
v_dot2_f32_bf16 v32, v94, v83, v32
v_dot2_f32_bf16 v33, v95, v83, v33
v_dot2_f32_bf16 v34, v96, v83, v34
v_dot2_f32_bf16 v35, v97, v83, v35
v_dot2_f32_bf16 v36, v90, v84, v36
v_dot2_f32_bf16 v37, v91, v84, v37
v_dot2_f32_bf16 v38, v92, v84, v38
v_dot2_f32_bf16 v39, v93, v84, v39
v_dot2_f32_bf16 v40, v94, v84, v40
v_dot2_f32_bf16 v41, v95, v84, v41
v_dot2_f32_bf16 v42, v96, v84, v42
v_dot2_f32_bf16 v43, v97, v84, v43
v_dot2_f32_bf16 v44, v90, v85, v44
v_dot2_f32_bf16 v45, v91, v85, v45
v_dot2_f32_bf16 v46, v92, v85, v46
v_dot2_f32_bf16 v47, v93, v85, v47
v_dot2_f32_bf16 v48, v94, v85, v48
v_dot2_f32_bf16 v49, v95, v85, v49
v_dot2_f32_bf16 v50, v96, v85, v50
v_dot2_f32_bf16 v51, v97, v85, v51
v_dot2_f32_bf16 v52, v90, v86, v52
v_dot2_f32_bf16 v53, v91, v86, v53
v_dot2_f32_bf16 v54, v92, v86, v54
v_dot2_f32_bf16 v55, v93, v86, v55
v_dot2_f32_bf16 v56, v94, v86, v56
v_dot2_f32_bf16 v57, v95, v86, v57
v_dot2_f32_bf16 v58, v96, v86, v58
v_dot2_f32_bf16 v59, v97, v86, v59
v_dot2_f32_bf16 v60, v90, v87, v60
v_dot2_f32_bf16 v61, v91, v87, v61
v_dot2_f32_bf16 v62, v92, v87, v62
v_dot2_f32_bf16 v63, v93, v87, v63
v_dot2_f32_bf16 v64, v94, v87, v64
v_dot2_f32_bf16 v65, v95, v87, v65
v_dot2_f32_bf16 v66, v96, v87, v66
v_dot2_f32_bf16 v67, v97, v87, v67
ds_read_b128 v[80:83], v223 offset:192
ds_read_b128 v[84:87], v223 offset:208
s_waitcnt vmcnt(2) lgkmcnt(0)
v_perm_b32 v90, v152, v148, s30
v_perm_b32 v91, v152, v148, s31
v_perm_b32 v92, v153, v149, s30
v_perm_b32 v93, v153, v149, s31
v_perm_b32 v94, v154, v150, s30
v_perm_b32 v95, v154, v150, s31
v_perm_b32 v96, v155, v151, s30
v_perm_b32 v97, v155, v151, s31
v_dot2_f32_bf16 v4, v90, v80, v4
v_dot2_f32_bf16 v5, v91, v80, v5
v_dot2_f32_bf16 v6, v92, v80, v6
v_dot2_f32_bf16 v7, v93, v80, v7
v_dot2_f32_bf16 v8, v94, v80, v8
v_dot2_f32_bf16 v9, v95, v80, v9
v_dot2_f32_bf16 v10, v96, v80, v10
v_dot2_f32_bf16 v11, v97, v80, v11
v_dot2_f32_bf16 v12, v90, v81, v12
v_dot2_f32_bf16 v13, v91, v81, v13
v_dot2_f32_bf16 v14, v92, v81, v14
v_dot2_f32_bf16 v15, v93, v81, v15
v_dot2_f32_bf16 v16, v94, v81, v16
v_dot2_f32_bf16 v17, v95, v81, v17
v_dot2_f32_bf16 v18, v96, v81, v18
v_dot2_f32_bf16 v19, v97, v81, v19
v_dot2_f32_bf16 v20, v90, v82, v20
v_dot2_f32_bf16 v21, v91, v82, v21
v_dot2_f32_bf16 v22, v92, v82, v22
v_dot2_f32_bf16 v23, v93, v82, v23
v_dot2_f32_bf16 v24, v94, v82, v24
v_dot2_f32_bf16 v25, v95, v82, v25
v_dot2_f32_bf16 v26, v96, v82, v26
v_dot2_f32_bf16 v27, v97, v82, v27
v_dot2_f32_bf16 v28, v90, v83, v28
v_dot2_f32_bf16 v29, v91, v83, v29
v_dot2_f32_bf16 v30, v92, v83, v30
v_dot2_f32_bf16 v31, v93, v83, v31
v_dot2_f32_bf16 v32, v94, v83, v32
v_dot2_f32_bf16 v33, v95, v83, v33
v_dot2_f32_bf16 v34, v96, v83, v34
v_dot2_f32_bf16 v35, v97, v83, v35
v_dot2_f32_bf16 v36, v90, v84, v36
v_dot2_f32_bf16 v37, v91, v84, v37
v_dot2_f32_bf16 v38, v92, v84, v38
v_dot2_f32_bf16 v39, v93, v84, v39
v_dot2_f32_bf16 v40, v94, v84, v40
v_dot2_f32_bf16 v41, v95, v84, v41
v_dot2_f32_bf16 v42, v96, v84, v42
v_dot2_f32_bf16 v43, v97, v84, v43
v_dot2_f32_bf16 v44, v90, v85, v44
v_dot2_f32_bf16 v45, v91, v85, v45
v_dot2_f32_bf16 v46, v92, v85, v46
v_dot2_f32_bf16 v47, v93, v85, v47
v_dot2_f32_bf16 v48, v94, v85, v48
v_dot2_f32_bf16 v49, v95, v85, v49
v_dot2_f32_bf16 v50, v96, v85, v50
v_dot2_f32_bf16 v51, v97, v85, v51
v_dot2_f32_bf16 v52, v90, v86, v52
v_dot2_f32_bf16 v53, v91, v86, v53
v_dot2_f32_bf16 v54, v92, v86, v54
v_dot2_f32_bf16 v55, v93, v86, v55
v_dot2_f32_bf16 v56, v94, v86, v56
v_dot2_f32_bf16 v57, v95, v86, v57
v_dot2_f32_bf16 v58, v96, v86, v58
v_dot2_f32_bf16 v59, v97, v86, v59
v_dot2_f32_bf16 v60, v90, v87, v60
v_dot2_f32_bf16 v61, v91, v87, v61
v_dot2_f32_bf16 v62, v92, v87, v62
v_dot2_f32_bf16 v63, v93, v87, v63
v_dot2_f32_bf16 v64, v94, v87, v64
v_dot2_f32_bf16 v65, v95, v87, v65
v_dot2_f32_bf16 v66, v96, v87, v66
v_dot2_f32_bf16 v67, v97, v87, v67
ds_read_b128 v[80:83], v223 offset:224
ds_read_b128 v[84:87], v223 offset:240
s_waitcnt vmcnt(0) lgkmcnt(0)
v_perm_b32 v90, v160, v156, s30
v_perm_b32 v91, v160, v156, s31
v_perm_b32 v92, v161, v157, s30
v_perm_b32 v93, v161, v157, s31
v_perm_b32 v94, v162, v158, s30
v_perm_b32 v95, v162, v158, s31
v_perm_b32 v96, v163, v159, s30
v_perm_b32 v97, v163, v159, s31
v_dot2_f32_bf16 v4, v90, v80, v4
v_dot2_f32_bf16 v5, v91, v80, v5
v_dot2_f32_bf16 v6, v92, v80, v6
v_dot2_f32_bf16 v7, v93, v80, v7
v_dot2_f32_bf16 v8, v94, v80, v8
v_dot2_f32_bf16 v9, v95, v80, v9
v_dot2_f32_bf16 v10, v96, v80, v10
v_dot2_f32_bf16 v11, v97, v80, v11
v_dot2_f32_bf16 v12, v90, v81, v12
v_dot2_f32_bf16 v13, v91, v81, v13
v_dot2_f32_bf16 v14, v92, v81, v14
v_dot2_f32_bf16 v15, v93, v81, v15
v_dot2_f32_bf16 v16, v94, v81, v16
v_dot2_f32_bf16 v17, v95, v81, v17
v_dot2_f32_bf16 v18, v96, v81, v18
v_dot2_f32_bf16 v19, v97, v81, v19
v_dot2_f32_bf16 v20, v90, v82, v20
v_dot2_f32_bf16 v21, v91, v82, v21
v_dot2_f32_bf16 v22, v92, v82, v22
v_dot2_f32_bf16 v23, v93, v82, v23
v_dot2_f32_bf16 v24, v94, v82, v24
v_dot2_f32_bf16 v25, v95, v82, v25
v_dot2_f32_bf16 v26, v96, v82, v26
v_dot2_f32_bf16 v27, v97, v82, v27
v_dot2_f32_bf16 v28, v90, v83, v28
v_dot2_f32_bf16 v29, v91, v83, v29
v_dot2_f32_bf16 v30, v92, v83, v30
v_dot2_f32_bf16 v31, v93, v83, v31
v_dot2_f32_bf16 v32, v94, v83, v32
v_dot2_f32_bf16 v33, v95, v83, v33
v_dot2_f32_bf16 v34, v96, v83, v34
v_dot2_f32_bf16 v35, v97, v83, v35
v_dot2_f32_bf16 v36, v90, v84, v36
v_dot2_f32_bf16 v37, v91, v84, v37
v_dot2_f32_bf16 v38, v92, v84, v38
v_dot2_f32_bf16 v39, v93, v84, v39
v_dot2_f32_bf16 v40, v94, v84, v40
v_dot2_f32_bf16 v41, v95, v84, v41
v_dot2_f32_bf16 v42, v96, v84, v42
v_dot2_f32_bf16 v43, v97, v84, v43
v_dot2_f32_bf16 v44, v90, v85, v44
v_dot2_f32_bf16 v45, v91, v85, v45
v_dot2_f32_bf16 v46, v92, v85, v46
v_dot2_f32_bf16 v47, v93, v85, v47
v_dot2_f32_bf16 v48, v94, v85, v48
v_dot2_f32_bf16 v49, v95, v85, v49
v_dot2_f32_bf16 v50, v96, v85, v50
v_dot2_f32_bf16 v51, v97, v85, v51
v_dot2_f32_bf16 v52, v90, v86, v52
v_dot2_f32_bf16 v53, v91, v86, v53
v_dot2_f32_bf16 v54, v92, v86, v54
v_dot2_f32_bf16 v55, v93, v86, v55
v_dot2_f32_bf16 v56, v94, v86, v56
v_dot2_f32_bf16 v57, v95, v86, v57
v_dot2_f32_bf16 v58, v96, v86, v58
v_dot2_f32_bf16 v59, v97, v86, v59
v_dot2_f32_bf16 v60, v90, v87, v60
v_dot2_f32_bf16 v61, v91, v87, v61
v_dot2_f32_bf16 v62, v92, v87, v62
v_dot2_f32_bf16 v63, v93, v87, v63
v_dot2_f32_bf16 v64, v94, v87, v64
v_dot2_f32_bf16 v65, v95, v87, v65
v_dot2_f32_bf16 v66, v96, v87, v66
v_dot2_f32_bf16 v67, v97, v87, v67
s_nop 4
v_lshlrev_b32 v225, 11, v221
v_lshl_add_u32 v225, v220, 5, v225
s_barrier
ds_write_b128 v225, v[4:7] offset:16384
ds_write_b128 v225, v[8:11] offset:16400
ds_write_b128 v225, v[12:15] offset:16640
ds_write_b128 v225, v[16:19] offset:16656
ds_write_b128 v225, v[20:23] offset:16896
ds_write_b128 v225, v[24:27] offset:16912
ds_write_b128 v225, v[28:31] offset:17152
ds_write_b128 v225, v[32:35] offset:17168
ds_write_b128 v225, v[36:39] offset:17408
ds_write_b128 v225, v[40:43] offset:17424
ds_write_b128 v225, v[44:47] offset:17664
ds_write_b128 v225, v[48:51] offset:17680
ds_write_b128 v225, v[52:55] offset:17920
ds_write_b128 v225, v[56:59] offset:17936
ds_write_b128 v225, v[60:63] offset:18176
ds_write_b128 v225, v[64:67] offset:18192
s_waitcnt lgkmcnt(0)
s_barrier
v_lshlrev_b32 v226, 3, v0
v_add_u32 v226, 16384, v226
ds_read_b64 v[4:5], v226 offset:0
ds_read_b64 v[6:7], v226 offset:2048
ds_read_b64 v[8:9], v226 offset:4096
ds_read_b64 v[10:11], v226 offset:6144
ds_read_b64 v[12:13], v226 offset:8192
ds_read_b64 v[14:15], v226 offset:10240
ds_read_b64 v[16:17], v226 offset:12288
ds_read_b64 v[18:19], v226 offset:14336
ds_read_b64 v[20:21], v226 offset:16384
ds_read_b64 v[22:23], v226 offset:18432
ds_read_b64 v[24:25], v226 offset:20480
ds_read_b64 v[26:27], v226 offset:22528
ds_read_b64 v[28:29], v226 offset:24576
ds_read_b64 v[30:31], v226 offset:26624
ds_read_b64 v[32:33], v226 offset:28672
ds_read_b64 v[34:35], v226 offset:30720
ds_read_b64 v[36:37], v226 offset:32768
ds_read_b64 v[38:39], v226 offset:34816
ds_read_b64 v[40:41], v226 offset:36864
ds_read_b64 v[42:43], v226 offset:38912
ds_read_b64 v[44:45], v226 offset:40960
ds_read_b64 v[46:47], v226 offset:43008
ds_read_b64 v[48:49], v226 offset:45056
ds_read_b64 v[50:51], v226 offset:47104
ds_read_b64 v[52:53], v226 offset:49152
ds_read_b64 v[54:55], v226 offset:51200
ds_read_b64 v[56:57], v226 offset:53248
ds_read_b64 v[58:59], v226 offset:55296
ds_read_b64 v[60:61], v226 offset:57344
ds_read_b64 v[62:63], v226 offset:59392
ds_read_b64 v[64:65], v226 offset:61440
ds_read_b64 v[66:67], v226 offset:63488
s_waitcnt lgkmcnt(0)
v_mov_b32 v210, 0
v_mov_b32 v211, 0
v_add_f32 v210, v210, v4
v_add_f32 v211, v211, v5
v_add_f32 v210, v210, v6
v_add_f32 v211, v211, v7
v_add_f32 v210, v210, v8
v_add_f32 v211, v211, v9
v_add_f32 v210, v210, v10
v_add_f32 v211, v211, v11
v_add_f32 v210, v210, v12
v_add_f32 v211, v211, v13
v_add_f32 v210, v210, v14
v_add_f32 v211, v211, v15
v_add_f32 v210, v210, v16
v_add_f32 v211, v211, v17
v_add_f32 v210, v210, v18
v_add_f32 v211, v211, v19
v_add_f32 v210, v210, v20
v_add_f32 v211, v211, v21
v_add_f32 v210, v210, v22
v_add_f32 v211, v211, v23
v_add_f32 v210, v210, v24
v_add_f32 v211, v211, v25
v_add_f32 v210, v210, v26
v_add_f32 v211, v211, v27
v_add_f32 v210, v210, v28
v_add_f32 v211, v211, v29
v_add_f32 v210, v210, v30
v_add_f32 v211, v211, v31
v_add_f32 v210, v210, v32
v_add_f32 v211, v211, v33
v_add_f32 v210, v210, v34
v_add_f32 v211, v211, v35
v_add_f32 v210, v210, v36
v_add_f32 v211, v211, v37
v_add_f32 v210, v210, v38
v_add_f32 v211, v211, v39
v_add_f32 v210, v210, v40
v_add_f32 v211, v211, v41
v_add_f32 v210, v210, v42
v_add_f32 v211, v211, v43
v_add_f32 v210, v210, v44
v_add_f32 v211, v211, v45
v_add_f32 v210, v210, v46
v_add_f32 v211, v211, v47
v_add_f32 v210, v210, v48
v_add_f32 v211, v211, v49
v_add_f32 v210, v210, v50
v_add_f32 v211, v211, v51
v_add_f32 v210, v210, v52
v_add_f32 v211, v211, v53
v_add_f32 v210, v210, v54
v_add_f32 v211, v211, v55
v_add_f32 v210, v210, v56
v_add_f32 v211, v211, v57
v_add_f32 v210, v210, v58
v_add_f32 v211, v211, v59
v_add_f32 v210, v210, v60
v_add_f32 v211, v211, v61
v_add_f32 v210, v210, v62
v_add_f32 v211, v211, v63
v_add_f32 v210, v210, v64
v_add_f32 v211, v211, v65
v_add_f32 v210, v210, v66
v_add_f32 v211, v211, v67
v_mul_u32_u24 v204, 2304, v200
v_lshl_add_u32 v204, v201, 3, v204
s_mul_i32 s28, s4, 18432
s_lshl_b32 s29, s5, 8
s_add_u32 s28, s28, s29
s_add_u32 s28, s28, 917504
buffer_store_dwordx2 v[210:211], v204, s[24:27], s28 offen sc1
s_waitcnt vmcnt(0)
s_barrier
s_lshl_b32 s6, s5, 2
v_mov_b32 v26, 1
v_mov_b32 v27, 0
v_cmp_eq_u32 vcc, 0, v0
s_and_saveexec_b64 s[28:29], vcc
s_cbranch_execz k4_na
buffer_atomic_add v26, v27, s[20:23], s6 offen sc0
s_waitcnt vmcnt(0)
ds_write_b32 v27, v26
s_waitcnt lgkmcnt(0)
k4_na:
s_or_b64 exec, exec, s[28:29]
s_barrier
ds_read_b32 v26, v27
s_waitcnt lgkmcnt(0)
v_readfirstlane_b32 s7, v26
s_cmp_lg_u32 s7, 7
s_cbranch_scc1 k4_kernel_end
s_lshl_b32 s29, s5, 8
s_add_u32 s28, s29, 917504
v_add_u32 v205, 0, v204
buffer_load_dwordx2 v[30:31], v205, s[24:27], s28 offen sc1
v_add_u32 v205, 18432, v204
buffer_load_dwordx2 v[32:33], v205, s[24:27], s28 offen sc1
v_add_u32 v205, 36864, v204
buffer_load_dwordx2 v[34:35], v205, s[24:27], s28 offen sc1
v_add_u32 v205, 55296, v204
buffer_load_dwordx2 v[36:37], v205, s[24:27], s28 offen sc1
v_add_u32 v205, 73728, v204
buffer_load_dwordx2 v[38:39], v205, s[24:27], s28 offen sc1
v_add_u32 v205, 92160, v204
buffer_load_dwordx2 v[40:41], v205, s[24:27], s28 offen sc1
v_add_u32 v205, 110592, v204
buffer_load_dwordx2 v[42:43], v205, s[24:27], s28 offen sc1
v_add_u32 v205, 129024, v204
buffer_load_dwordx2 v[44:45], v205, s[24:27], s28 offen sc1
s_waitcnt vmcnt(0)
v_add_f32 v30, v30, v32
v_add_f32 v31, v31, v33
v_add_f32 v30, v30, v34
v_add_f32 v31, v31, v35
v_add_f32 v30, v30, v36
v_add_f32 v31, v31, v37
v_add_f32 v30, v30, v38
v_add_f32 v31, v31, v39
v_add_f32 v30, v30, v40
v_add_f32 v31, v31, v41
v_add_f32 v30, v30, v42
v_add_f32 v31, v31, v43
v_add_f32 v30, v30, v44
v_add_f32 v31, v31, v45
s_add_u32 s28, s29, 1146880
buffer_store_dwordx2 v[30:31], v204, s[24:27], s28 offen
k4_kernel_end:
s_endpgm
.globl k5_kernel
.p2align 8
.type k5_kernel,@function
k5_kernel:
s_cmp_ge_u32 s2, 72
s_cbranch_scc1 k5_kernel_end
s_load_dwordx2 s[8:9], s[0:1], 48
s_mov_b32 s10, 5308416
s_mov_b32 s11, 0x00020000
s_load_dwordx2 s[12:13], s[0:1], 56
s_mov_b32 s14, 5308416
s_mov_b32 s15, 0x00020000
s_load_dwordx2 s[16:17], s[0:1], 0
s_mov_b32 s18, 9216
s_mov_b32 s19, 0x00020000
s_load_dwordx2 s[24:25], s[0:1], 104
s_mov_b32 s26, 2097152
s_mov_b32 s27, 0x00020000
s_waitcnt lgkmcnt(0)
v_lshrrev_b32 v200, 5, v0
v_and_b32 v201, 31, v0
v_mul_u32_u24 v204, 1152, v200
v_lshl_add_u32 v204, v201, 2, v204
buffer_load_dword v44, v204, s[16:19], 0 offen offset:0
buffer_load_dword v45, v204, s[16:19], 0 offen offset:128
buffer_load_dword v46, v204, s[16:19], 0 offen offset:256
buffer_load_dword v47, v204, s[16:19], 0 offen offset:384
buffer_load_dword v48, v204, s[16:19], 0 offen offset:512
buffer_load_dword v49, v204, s[16:19], 0 offen offset:640
buffer_load_dword v50, v204, s[16:19], 0 offen offset:768
buffer_load_dword v51, v204, s[16:19], 0 offen offset:896
buffer_load_dword v52, v204, s[16:19], 0 offen offset:1024
v_lshlrev_b32 v205, 1, v204
v_add_u32 v205, 1146880, v205
buffer_load_dwordx2 v[60:61], v205, s[24:27], 0 offen offset:0
buffer_load_dwordx2 v[62:63], v205, s[24:27], 0 offen offset:256
buffer_load_dwordx2 v[64:65], v205, s[24:27], 0 offen offset:512
buffer_load_dwordx2 v[66:67], v205, s[24:27], 0 offen offset:768
buffer_load_dwordx2 v[68:69], v205, s[24:27], 0 offen offset:1024
buffer_load_dwordx2 v[70:71], v205, s[24:27], 0 offen offset:1280
buffer_load_dwordx2 v[72:73], v205, s[24:27], 0 offen offset:1536
buffer_load_dwordx2 v[74:75], v205, s[24:27], 0 offen offset:1792
buffer_load_dwordx2 v[76:77], v205, s[24:27], 0 offen offset:2048
v_mul_u32_u24 v206, 0x3600, v200
v_lshl_add_u32 v206, v201, 3, v206
v_add_u32 v206, 4608, v206
buffer_load_dwordx2 v[4:5], v206, s[24:27], 0 offen offset:0
buffer_load_dwordx2 v[6:7], v206, s[24:27], 0 offen offset:256
buffer_load_dwordx2 v[8:9], v206, s[24:27], 0 offen offset:512
buffer_load_dwordx2 v[10:11], v206, s[24:27], 0 offen offset:768
buffer_load_dwordx2 v[12:13], v206, s[24:27], 0 offen offset:1024
buffer_load_dwordx2 v[14:15], v206, s[24:27], 0 offen offset:1280
buffer_load_dwordx2 v[16:17], v206, s[24:27], 0 offen offset:1536
buffer_load_dwordx2 v[18:19], v206, s[24:27], 0 offen offset:1792
buffer_load_dwordx2 v[20:21], v206, s[24:27], 0 offen offset:2048
v_and_b32 v220, 7, v0
v_lshrrev_b32 v221, 3, v0
v_mul_u32_u24 v222, 165888, v221
v_lshl_add_u32 v222, v220, 4, v222
s_mov_b32 s29, 0
s_lshl_b32 s28, s2, 7
s_add_u32 s29, s29, s28
v_add_u32 v224, 0, v222
buffer_load_dwordx4 v[100:103], v224, s[8:11], s29 offen
v_add_u32 v224, 9216, v222
buffer_load_dwordx4 v[104:107], v224, s[8:11], s29 offen
v_add_u32 v224, 18432, v222
buffer_load_dwordx4 v[108:111], v224, s[8:11], s29 offen
v_add_u32 v224, 27648, v222
buffer_load_dwordx4 v[112:115], v224, s[8:11], s29 offen
v_add_u32 v224, 36864, v222
buffer_load_dwordx4 v[116:119], v224, s[8:11], s29 offen
v_add_u32 v224, 46080, v222
buffer_load_dwordx4 v[120:123], v224, s[8:11], s29 offen
v_add_u32 v224, 55296, v222
buffer_load_dwordx4 v[124:127], v224, s[8:11], s29 offen
v_add_u32 v224, 64512, v222
buffer_load_dwordx4 v[128:131], v224, s[8:11], s29 offen
v_add_u32 v224, 73728, v222
buffer_load_dwordx4 v[132:135], v224, s[8:11], s29 offen
v_add_u32 v224, 82944, v222
buffer_load_dwordx4 v[136:139], v224, s[8:11], s29 offen
v_add_u32 v224, 92160, v222
buffer_load_dwordx4 v[140:143], v224, s[8:11], s29 offen
v_add_u32 v224, 101376, v222
buffer_load_dwordx4 v[144:147], v224, s[8:11], s29 offen
v_add_u32 v224, 110592, v222
buffer_load_dwordx4 v[148:151], v224, s[8:11], s29 offen
v_add_u32 v224, 119808, v222
buffer_load_dwordx4 v[152:155], v224, s[8:11], s29 offen
v_add_u32 v224, 129024, v222
buffer_load_dwordx4 v[156:159], v224, s[8:11], s29 offen
v_add_u32 v224, 138240, v222
buffer_load_dwordx4 v[160:163], v224, s[8:11], s29 offen
v_add_u32 v224, 147456, v222
buffer_load_dwordx4 v[164:167], v224, s[8:11], s29 offen
v_add_u32 v224, 156672, v222
buffer_load_dwordx4 v[168:171], v224, s[8:11], s29 offen
s_waitcnt vmcnt(18)
v_lshlrev_b32 v24, 16, v44
v_and_b32 v25, 0xffff0000, v44
v_lshlrev_b32 v26, 16, v45
v_and_b32 v27, 0xffff0000, v45
v_lshlrev_b32 v28, 16, v46
v_and_b32 v29, 0xffff0000, v46
v_lshlrev_b32 v30, 16, v47
v_and_b32 v31, 0xffff0000, v47
v_lshlrev_b32 v32, 16, v48
v_and_b32 v33, 0xffff0000, v48
v_lshlrev_b32 v34, 16, v49
v_and_b32 v35, 0xffff0000, v49
v_lshlrev_b32 v36, 16, v50
v_and_b32 v37, 0xffff0000, v50
v_lshlrev_b32 v38, 16, v51
v_and_b32 v39, 0xffff0000, v51
v_lshlrev_b32 v40, 16, v52
v_and_b32 v41, 0xffff0000, v52
v_cvt_pk_bf16_f32 v209, v60, v60
v_lshlrev_b32 v60, 16, v209
v_fma_f32 v60, v60, v4, v24
v_cvt_pk_bf16_f32 v209, v60, v60
v_lshlrev_b32 v60, 16, v209
v_cvt_pk_bf16_f32 v209, v61, v61
v_lshlrev_b32 v61, 16, v209
v_fma_f32 v61, v61, v5, v25
v_cvt_pk_bf16_f32 v209, v61, v61
v_lshlrev_b32 v61, 16, v209
v_cvt_pk_bf16_f32 v209, v62, v62
v_lshlrev_b32 v62, 16, v209
v_fma_f32 v62, v62, v6, v26
v_cvt_pk_bf16_f32 v209, v62, v62
v_lshlrev_b32 v62, 16, v209
v_cvt_pk_bf16_f32 v209, v63, v63
v_lshlrev_b32 v63, 16, v209
v_fma_f32 v63, v63, v7, v27
v_cvt_pk_bf16_f32 v209, v63, v63
v_lshlrev_b32 v63, 16, v209
v_cvt_pk_bf16_f32 v209, v64, v64
v_lshlrev_b32 v64, 16, v209
v_fma_f32 v64, v64, v8, v28
v_cvt_pk_bf16_f32 v209, v64, v64
v_lshlrev_b32 v64, 16, v209
v_cvt_pk_bf16_f32 v209, v65, v65
v_lshlrev_b32 v65, 16, v209
v_fma_f32 v65, v65, v9, v29
v_cvt_pk_bf16_f32 v209, v65, v65
v_lshlrev_b32 v65, 16, v209
v_cvt_pk_bf16_f32 v209, v66, v66
v_lshlrev_b32 v66, 16, v209
v_fma_f32 v66, v66, v10, v30
v_cvt_pk_bf16_f32 v209, v66, v66
v_lshlrev_b32 v66, 16, v209
v_cvt_pk_bf16_f32 v209, v67, v67
v_lshlrev_b32 v67, 16, v209
v_fma_f32 v67, v67, v11, v31
v_cvt_pk_bf16_f32 v209, v67, v67
v_lshlrev_b32 v67, 16, v209
v_cvt_pk_bf16_f32 v209, v68, v68
v_lshlrev_b32 v68, 16, v209
v_fma_f32 v68, v68, v12, v32
v_cvt_pk_bf16_f32 v209, v68, v68
v_lshlrev_b32 v68, 16, v209
v_cvt_pk_bf16_f32 v209, v69, v69
v_lshlrev_b32 v69, 16, v209
v_fma_f32 v69, v69, v13, v33
v_cvt_pk_bf16_f32 v209, v69, v69
v_lshlrev_b32 v69, 16, v209
v_cvt_pk_bf16_f32 v209, v70, v70
v_lshlrev_b32 v70, 16, v209
v_fma_f32 v70, v70, v14, v34
v_cvt_pk_bf16_f32 v209, v70, v70
v_lshlrev_b32 v70, 16, v209
v_cvt_pk_bf16_f32 v209, v71, v71
v_lshlrev_b32 v71, 16, v209
v_fma_f32 v71, v71, v15, v35
v_cvt_pk_bf16_f32 v209, v71, v71
v_lshlrev_b32 v71, 16, v209
v_cvt_pk_bf16_f32 v209, v72, v72
v_lshlrev_b32 v72, 16, v209
v_fma_f32 v72, v72, v16, v36
v_cvt_pk_bf16_f32 v209, v72, v72
v_lshlrev_b32 v72, 16, v209
v_cvt_pk_bf16_f32 v209, v73, v73
v_lshlrev_b32 v73, 16, v209
v_fma_f32 v73, v73, v17, v37
v_cvt_pk_bf16_f32 v209, v73, v73
v_lshlrev_b32 v73, 16, v209
v_cvt_pk_bf16_f32 v209, v74, v74
v_lshlrev_b32 v74, 16, v209
v_fma_f32 v74, v74, v18, v38
v_cvt_pk_bf16_f32 v209, v74, v74
v_lshlrev_b32 v74, 16, v209
v_cvt_pk_bf16_f32 v209, v75, v75
v_lshlrev_b32 v75, 16, v209
v_fma_f32 v75, v75, v19, v39
v_cvt_pk_bf16_f32 v209, v75, v75
v_lshlrev_b32 v75, 16, v209
v_cvt_pk_bf16_f32 v209, v76, v76
v_lshlrev_b32 v76, 16, v209
v_fma_f32 v76, v76, v20, v40
v_cvt_pk_bf16_f32 v209, v76, v76
v_lshlrev_b32 v76, 16, v209
v_cvt_pk_bf16_f32 v209, v77, v77
v_lshlrev_b32 v77, 16, v209
v_fma_f32 v77, v77, v21, v41
v_cvt_pk_bf16_f32 v209, v77, v77
v_lshlrev_b32 v77, 16, v209
s_cmp_lg_u32 s2, 0
s_cbranch_scc1 k5_nx
v_lshlrev_b32 v205, 1, v204
s_mov_b32 s28, 1114112
buffer_store_dwordx2 v[60:61], v205, s[24:27], s28 offen offset:0
buffer_store_dwordx2 v[62:63], v205, s[24:27], s28 offen offset:256
buffer_store_dwordx2 v[64:65], v205, s[24:27], s28 offen offset:512
buffer_store_dwordx2 v[66:67], v205, s[24:27], s28 offen offset:768
buffer_store_dwordx2 v[68:69], v205, s[24:27], s28 offen offset:1024
buffer_store_dwordx2 v[70:71], v205, s[24:27], s28 offen offset:1280
buffer_store_dwordx2 v[72:73], v205, s[24:27], s28 offen offset:1536
buffer_store_dwordx2 v[74:75], v205, s[24:27], s28 offen offset:1792
buffer_store_dwordx2 v[76:77], v205, s[24:27], s28 offen offset:2048
k5_nx:
v_mov_b32 v202, 0
v_add_f32 v202, v202, v60
v_add_f32 v202, v202, v61
v_add_f32 v202, v202, v62
v_add_f32 v202, v202, v63
v_add_f32 v202, v202, v64
v_add_f32 v202, v202, v65
v_add_f32 v202, v202, v66
v_add_f32 v202, v202, v67
v_add_f32 v202, v202, v68
v_add_f32 v202, v202, v69
v_add_f32 v202, v202, v70
v_add_f32 v202, v202, v71
v_add_f32 v202, v202, v72
v_add_f32 v202, v202, v73
v_add_f32 v202, v202, v74
v_add_f32 v202, v202, v75
v_add_f32 v202, v202, v76
v_add_f32 v202, v202, v77
s_nop 1
v_add_f32_dpp v202, v202, v202 row_ror:8 row_mask:0xf bank_mask:0xf
s_nop 1
v_add_f32_dpp v202, v202, v202 row_ror:4 row_mask:0xf bank_mask:0xf
s_nop 1
v_add_f32_dpp v202, v202, v202 row_ror:2 row_mask:0xf bank_mask:0xf
s_nop 1
v_add_f32_dpp v202, v202, v202 row_ror:1 row_mask:0xf bank_mask:0xf
ds_swizzle_b32 v250, v202 offset:0x401F
s_waitcnt lgkmcnt(0)
v_add_f32 v202, v250, v202
v_mul_f32 v202, 0x3ae38e39, v202
v_mov_b32 v203, 0
v_sub_f32 v60, v60, v202
v_fmac_f32 v203, v60, v60
v_sub_f32 v61, v61, v202
v_fmac_f32 v203, v61, v61
v_sub_f32 v62, v62, v202
v_fmac_f32 v203, v62, v62
v_sub_f32 v63, v63, v202
v_fmac_f32 v203, v63, v63
v_sub_f32 v64, v64, v202
v_fmac_f32 v203, v64, v64
v_sub_f32 v65, v65, v202
v_fmac_f32 v203, v65, v65
v_sub_f32 v66, v66, v202
v_fmac_f32 v203, v66, v66
v_sub_f32 v67, v67, v202
v_fmac_f32 v203, v67, v67
v_sub_f32 v68, v68, v202
v_fmac_f32 v203, v68, v68
v_sub_f32 v69, v69, v202
v_fmac_f32 v203, v69, v69
v_sub_f32 v70, v70, v202
v_fmac_f32 v203, v70, v70
v_sub_f32 v71, v71, v202
v_fmac_f32 v203, v71, v71
v_sub_f32 v72, v72, v202
v_fmac_f32 v203, v72, v72
v_sub_f32 v73, v73, v202
v_fmac_f32 v203, v73, v73
v_sub_f32 v74, v74, v202
v_fmac_f32 v203, v74, v74
v_sub_f32 v75, v75, v202
v_fmac_f32 v203, v75, v75
v_sub_f32 v76, v76, v202
v_fmac_f32 v203, v76, v76
v_sub_f32 v77, v77, v202
v_fmac_f32 v203, v77, v77
s_nop 1
v_add_f32_dpp v203, v203, v203 row_ror:8 row_mask:0xf bank_mask:0xf
s_nop 1
v_add_f32_dpp v203, v203, v203 row_ror:4 row_mask:0xf bank_mask:0xf
s_nop 1
v_add_f32_dpp v203, v203, v203 row_ror:2 row_mask:0xf bank_mask:0xf
s_nop 1
v_add_f32_dpp v203, v203, v203 row_ror:1 row_mask:0xf bank_mask:0xf
ds_swizzle_b32 v250, v203 offset:0x401F
s_waitcnt lgkmcnt(0)
v_add_f32 v203, v250, v203
v_mul_f32 v203, 0x3ae38e39, v203
v_add_f32 v203, 0x3727c5ac, v203
v_rsq_f32 v203, v203
v_mul_u32_u24 v204, 0x3600, v200
v_lshl_add_u32 v204, v201, 3, v204
v_add_u32 v205, 6912, v204
v_add_u32 v206, 9216, v204
buffer_load_dwordx2 v[4:5], v205, s[24:27], 0 offen offset:0
buffer_load_dwordx2 v[24:25], v206, s[24:27], 0 offen offset:0
buffer_load_dwordx2 v[6:7], v205, s[24:27], 0 offen offset:256
buffer_load_dwordx2 v[26:27], v206, s[24:27], 0 offen offset:256
buffer_load_dwordx2 v[8:9], v205, s[24:27], 0 offen offset:512
buffer_load_dwordx2 v[28:29], v206, s[24:27], 0 offen offset:512
buffer_load_dwordx2 v[10:11], v205, s[24:27], 0 offen offset:768
buffer_load_dwordx2 v[30:31], v206, s[24:27], 0 offen offset:768
buffer_load_dwordx2 v[12:13], v205, s[24:27], 0 offen offset:1024
buffer_load_dwordx2 v[32:33], v206, s[24:27], 0 offen offset:1024
buffer_load_dwordx2 v[14:15], v205, s[24:27], 0 offen offset:1280
buffer_load_dwordx2 v[34:35], v206, s[24:27], 0 offen offset:1280
buffer_load_dwordx2 v[16:17], v205, s[24:27], 0 offen offset:1536
buffer_load_dwordx2 v[36:37], v206, s[24:27], 0 offen offset:1536
buffer_load_dwordx2 v[18:19], v205, s[24:27], 0 offen offset:1792
buffer_load_dwordx2 v[38:39], v206, s[24:27], 0 offen offset:1792
buffer_load_dwordx2 v[20:21], v205, s[24:27], 0 offen offset:2048
buffer_load_dwordx2 v[40:41], v206, s[24:27], 0 offen offset:2048
s_waitcnt vmcnt(0)
v_lshlrev_b32 v207, 5, v201
v_lshl_add_u32 v207, v200, 2, v207
v_mul_f32 v60, v60, v203
v_add_f32 v24, 1.0, v24
v_fma_f32 v60, v60, v24, v4
v_mul_f32 v61, v61, v203
v_add_f32 v25, 1.0, v25
v_fma_f32 v61, v61, v25, v5
v_cvt_pk_bf16_f32 v208, v60, v61
ds_write_b32 v207, v208 offset:0
v_mul_f32 v62, v62, v203
v_add_f32 v26, 1.0, v26
v_fma_f32 v62, v62, v26, v6
v_mul_f32 v63, v63, v203
v_add_f32 v27, 1.0, v27
v_fma_f32 v63, v63, v27, v7
v_cvt_pk_bf16_f32 v208, v62, v63
ds_write_b32 v207, v208 offset:1024
v_mul_f32 v64, v64, v203
v_add_f32 v28, 1.0, v28
v_fma_f32 v64, v64, v28, v8
v_mul_f32 v65, v65, v203
v_add_f32 v29, 1.0, v29
v_fma_f32 v65, v65, v29, v9
v_cvt_pk_bf16_f32 v208, v64, v65
ds_write_b32 v207, v208 offset:2048
v_mul_f32 v66, v66, v203
v_add_f32 v30, 1.0, v30
v_fma_f32 v66, v66, v30, v10
v_mul_f32 v67, v67, v203
v_add_f32 v31, 1.0, v31
v_fma_f32 v67, v67, v31, v11
v_cvt_pk_bf16_f32 v208, v66, v67
ds_write_b32 v207, v208 offset:3072
v_mul_f32 v68, v68, v203
v_add_f32 v32, 1.0, v32
v_fma_f32 v68, v68, v32, v12
v_mul_f32 v69, v69, v203
v_add_f32 v33, 1.0, v33
v_fma_f32 v69, v69, v33, v13
v_cvt_pk_bf16_f32 v208, v68, v69
ds_write_b32 v207, v208 offset:4096
v_mul_f32 v70, v70, v203
v_add_f32 v34, 1.0, v34
v_fma_f32 v70, v70, v34, v14
v_mul_f32 v71, v71, v203
v_add_f32 v35, 1.0, v35
v_fma_f32 v71, v71, v35, v15
v_cvt_pk_bf16_f32 v208, v70, v71
ds_write_b32 v207, v208 offset:5120
v_mul_f32 v72, v72, v203
v_add_f32 v36, 1.0, v36
v_fma_f32 v72, v72, v36, v16
v_mul_f32 v73, v73, v203
v_add_f32 v37, 1.0, v37
v_fma_f32 v73, v73, v37, v17
v_cvt_pk_bf16_f32 v208, v72, v73
ds_write_b32 v207, v208 offset:6144
v_mul_f32 v74, v74, v203
v_add_f32 v38, 1.0, v38
v_fma_f32 v74, v74, v38, v18
v_mul_f32 v75, v75, v203
v_add_f32 v39, 1.0, v39
v_fma_f32 v75, v75, v39, v19
v_cvt_pk_bf16_f32 v208, v74, v75
ds_write_b32 v207, v208 offset:7168
v_mul_f32 v76, v76, v203
v_add_f32 v40, 1.0, v40
v_fma_f32 v76, v76, v40, v20
v_mul_f32 v77, v77, v203
v_add_f32 v41, 1.0, v41
v_fma_f32 v77, v77, v41, v21
v_cvt_pk_bf16_f32 v208, v76, v77
ds_write_b32 v207, v208 offset:8192
s_waitcnt lgkmcnt(0)
s_barrier
s_mov_b32 s30, 0x05040100
s_mov_b32 s31, 0x07060302
v_mul_u32_u24 v223, 288, v221
v_mov_b32 v4, 0
v_mov_b32 v5, 0
v_mov_b32 v6, 0
v_mov_b32 v7, 0
v_mov_b32 v8, 0
v_mov_b32 v9, 0
v_mov_b32 v10, 0
v_mov_b32 v11, 0
v_mov_b32 v12, 0
v_mov_b32 v13, 0
v_mov_b32 v14, 0
v_mov_b32 v15, 0
v_mov_b32 v16, 0
v_mov_b32 v17, 0
v_mov_b32 v18, 0
v_mov_b32 v19, 0
v_mov_b32 v20, 0
v_mov_b32 v21, 0
v_mov_b32 v22, 0
v_mov_b32 v23, 0
v_mov_b32 v24, 0
v_mov_b32 v25, 0
v_mov_b32 v26, 0
v_mov_b32 v27, 0
v_mov_b32 v28, 0
v_mov_b32 v29, 0
v_mov_b32 v30, 0
v_mov_b32 v31, 0
v_mov_b32 v32, 0
v_mov_b32 v33, 0
v_mov_b32 v34, 0
v_mov_b32 v35, 0
v_mov_b32 v36, 0
v_mov_b32 v37, 0
v_mov_b32 v38, 0
v_mov_b32 v39, 0
v_mov_b32 v40, 0
v_mov_b32 v41, 0
v_mov_b32 v42, 0
v_mov_b32 v43, 0
v_mov_b32 v44, 0
v_mov_b32 v45, 0
v_mov_b32 v46, 0
v_mov_b32 v47, 0
v_mov_b32 v48, 0
v_mov_b32 v49, 0
v_mov_b32 v50, 0
v_mov_b32 v51, 0
v_mov_b32 v52, 0
v_mov_b32 v53, 0
v_mov_b32 v54, 0
v_mov_b32 v55, 0
v_mov_b32 v56, 0
v_mov_b32 v57, 0
v_mov_b32 v58, 0
v_mov_b32 v59, 0
v_mov_b32 v60, 0
v_mov_b32 v61, 0
v_mov_b32 v62, 0
v_mov_b32 v63, 0
v_mov_b32 v64, 0
v_mov_b32 v65, 0
v_mov_b32 v66, 0
v_mov_b32 v67, 0
ds_read_b128 v[80:83], v223 offset:0
ds_read_b128 v[84:87], v223 offset:16
s_waitcnt vmcnt(16) lgkmcnt(0)
v_perm_b32 v90, v104, v100, s30
v_perm_b32 v91, v104, v100, s31
v_perm_b32 v92, v105, v101, s30
v_perm_b32 v93, v105, v101, s31
v_perm_b32 v94, v106, v102, s30
v_perm_b32 v95, v106, v102, s31
v_perm_b32 v96, v107, v103, s30
v_perm_b32 v97, v107, v103, s31
v_dot2_f32_bf16 v4, v90, v80, v4
v_dot2_f32_bf16 v5, v91, v80, v5
v_dot2_f32_bf16 v6, v92, v80, v6
v_dot2_f32_bf16 v7, v93, v80, v7
v_dot2_f32_bf16 v8, v94, v80, v8
v_dot2_f32_bf16 v9, v95, v80, v9
v_dot2_f32_bf16 v10, v96, v80, v10
v_dot2_f32_bf16 v11, v97, v80, v11
v_dot2_f32_bf16 v12, v90, v81, v12
v_dot2_f32_bf16 v13, v91, v81, v13
v_dot2_f32_bf16 v14, v92, v81, v14
v_dot2_f32_bf16 v15, v93, v81, v15
v_dot2_f32_bf16 v16, v94, v81, v16
v_dot2_f32_bf16 v17, v95, v81, v17
v_dot2_f32_bf16 v18, v96, v81, v18
v_dot2_f32_bf16 v19, v97, v81, v19
v_dot2_f32_bf16 v20, v90, v82, v20
v_dot2_f32_bf16 v21, v91, v82, v21
v_dot2_f32_bf16 v22, v92, v82, v22
v_dot2_f32_bf16 v23, v93, v82, v23
v_dot2_f32_bf16 v24, v94, v82, v24
v_dot2_f32_bf16 v25, v95, v82, v25
v_dot2_f32_bf16 v26, v96, v82, v26
v_dot2_f32_bf16 v27, v97, v82, v27
v_dot2_f32_bf16 v28, v90, v83, v28
v_dot2_f32_bf16 v29, v91, v83, v29
v_dot2_f32_bf16 v30, v92, v83, v30
v_dot2_f32_bf16 v31, v93, v83, v31
v_dot2_f32_bf16 v32, v94, v83, v32
v_dot2_f32_bf16 v33, v95, v83, v33
v_dot2_f32_bf16 v34, v96, v83, v34
v_dot2_f32_bf16 v35, v97, v83, v35
v_dot2_f32_bf16 v36, v90, v84, v36
v_dot2_f32_bf16 v37, v91, v84, v37
v_dot2_f32_bf16 v38, v92, v84, v38
v_dot2_f32_bf16 v39, v93, v84, v39
v_dot2_f32_bf16 v40, v94, v84, v40
v_dot2_f32_bf16 v41, v95, v84, v41
v_dot2_f32_bf16 v42, v96, v84, v42
v_dot2_f32_bf16 v43, v97, v84, v43
v_dot2_f32_bf16 v44, v90, v85, v44
v_dot2_f32_bf16 v45, v91, v85, v45
v_dot2_f32_bf16 v46, v92, v85, v46
v_dot2_f32_bf16 v47, v93, v85, v47
v_dot2_f32_bf16 v48, v94, v85, v48
v_dot2_f32_bf16 v49, v95, v85, v49
v_dot2_f32_bf16 v50, v96, v85, v50
v_dot2_f32_bf16 v51, v97, v85, v51
v_dot2_f32_bf16 v52, v90, v86, v52
v_dot2_f32_bf16 v53, v91, v86, v53
v_dot2_f32_bf16 v54, v92, v86, v54
v_dot2_f32_bf16 v55, v93, v86, v55
v_dot2_f32_bf16 v56, v94, v86, v56
v_dot2_f32_bf16 v57, v95, v86, v57
v_dot2_f32_bf16 v58, v96, v86, v58
v_dot2_f32_bf16 v59, v97, v86, v59
v_dot2_f32_bf16 v60, v90, v87, v60
v_dot2_f32_bf16 v61, v91, v87, v61
v_dot2_f32_bf16 v62, v92, v87, v62
v_dot2_f32_bf16 v63, v93, v87, v63
v_dot2_f32_bf16 v64, v94, v87, v64
v_dot2_f32_bf16 v65, v95, v87, v65
v_dot2_f32_bf16 v66, v96, v87, v66
v_dot2_f32_bf16 v67, v97, v87, v67
ds_read_b128 v[80:83], v223 offset:32
ds_read_b128 v[84:87], v223 offset:48
s_waitcnt vmcnt(14) lgkmcnt(0)
v_perm_b32 v90, v112, v108, s30
v_perm_b32 v91, v112, v108, s31
v_perm_b32 v92, v113, v109, s30
v_perm_b32 v93, v113, v109, s31
v_perm_b32 v94, v114, v110, s30
v_perm_b32 v95, v114, v110, s31
v_perm_b32 v96, v115, v111, s30
v_perm_b32 v97, v115, v111, s31
v_dot2_f32_bf16 v4, v90, v80, v4
v_dot2_f32_bf16 v5, v91, v80, v5
v_dot2_f32_bf16 v6, v92, v80, v6
v_dot2_f32_bf16 v7, v93, v80, v7
v_dot2_f32_bf16 v8, v94, v80, v8
v_dot2_f32_bf16 v9, v95, v80, v9
v_dot2_f32_bf16 v10, v96, v80, v10
v_dot2_f32_bf16 v11, v97, v80, v11
v_dot2_f32_bf16 v12, v90, v81, v12
v_dot2_f32_bf16 v13, v91, v81, v13
v_dot2_f32_bf16 v14, v92, v81, v14
v_dot2_f32_bf16 v15, v93, v81, v15
v_dot2_f32_bf16 v16, v94, v81, v16
v_dot2_f32_bf16 v17, v95, v81, v17
v_dot2_f32_bf16 v18, v96, v81, v18
v_dot2_f32_bf16 v19, v97, v81, v19
v_dot2_f32_bf16 v20, v90, v82, v20
v_dot2_f32_bf16 v21, v91, v82, v21
v_dot2_f32_bf16 v22, v92, v82, v22
v_dot2_f32_bf16 v23, v93, v82, v23
v_dot2_f32_bf16 v24, v94, v82, v24
v_dot2_f32_bf16 v25, v95, v82, v25
v_dot2_f32_bf16 v26, v96, v82, v26
v_dot2_f32_bf16 v27, v97, v82, v27
v_dot2_f32_bf16 v28, v90, v83, v28
v_dot2_f32_bf16 v29, v91, v83, v29
v_dot2_f32_bf16 v30, v92, v83, v30
v_dot2_f32_bf16 v31, v93, v83, v31
v_dot2_f32_bf16 v32, v94, v83, v32
v_dot2_f32_bf16 v33, v95, v83, v33
v_dot2_f32_bf16 v34, v96, v83, v34
v_dot2_f32_bf16 v35, v97, v83, v35
v_dot2_f32_bf16 v36, v90, v84, v36
v_dot2_f32_bf16 v37, v91, v84, v37
v_dot2_f32_bf16 v38, v92, v84, v38
v_dot2_f32_bf16 v39, v93, v84, v39
v_dot2_f32_bf16 v40, v94, v84, v40
v_dot2_f32_bf16 v41, v95, v84, v41
v_dot2_f32_bf16 v42, v96, v84, v42
v_dot2_f32_bf16 v43, v97, v84, v43
v_dot2_f32_bf16 v44, v90, v85, v44
v_dot2_f32_bf16 v45, v91, v85, v45
v_dot2_f32_bf16 v46, v92, v85, v46
v_dot2_f32_bf16 v47, v93, v85, v47
v_dot2_f32_bf16 v48, v94, v85, v48
v_dot2_f32_bf16 v49, v95, v85, v49
v_dot2_f32_bf16 v50, v96, v85, v50
v_dot2_f32_bf16 v51, v97, v85, v51
v_dot2_f32_bf16 v52, v90, v86, v52
v_dot2_f32_bf16 v53, v91, v86, v53
v_dot2_f32_bf16 v54, v92, v86, v54
v_dot2_f32_bf16 v55, v93, v86, v55
v_dot2_f32_bf16 v56, v94, v86, v56
v_dot2_f32_bf16 v57, v95, v86, v57
v_dot2_f32_bf16 v58, v96, v86, v58
v_dot2_f32_bf16 v59, v97, v86, v59
v_dot2_f32_bf16 v60, v90, v87, v60
v_dot2_f32_bf16 v61, v91, v87, v61
v_dot2_f32_bf16 v62, v92, v87, v62
v_dot2_f32_bf16 v63, v93, v87, v63
v_dot2_f32_bf16 v64, v94, v87, v64
v_dot2_f32_bf16 v65, v95, v87, v65
v_dot2_f32_bf16 v66, v96, v87, v66
v_dot2_f32_bf16 v67, v97, v87, v67
ds_read_b128 v[80:83], v223 offset:64
ds_read_b128 v[84:87], v223 offset:80
s_waitcnt vmcnt(12) lgkmcnt(0)
v_perm_b32 v90, v120, v116, s30
v_perm_b32 v91, v120, v116, s31
v_perm_b32 v92, v121, v117, s30
v_perm_b32 v93, v121, v117, s31
v_perm_b32 v94, v122, v118, s30
v_perm_b32 v95, v122, v118, s31
v_perm_b32 v96, v123, v119, s30
v_perm_b32 v97, v123, v119, s31
v_dot2_f32_bf16 v4, v90, v80, v4
v_dot2_f32_bf16 v5, v91, v80, v5
v_dot2_f32_bf16 v6, v92, v80, v6
v_dot2_f32_bf16 v7, v93, v80, v7
v_dot2_f32_bf16 v8, v94, v80, v8
v_dot2_f32_bf16 v9, v95, v80, v9
v_dot2_f32_bf16 v10, v96, v80, v10
v_dot2_f32_bf16 v11, v97, v80, v11
v_dot2_f32_bf16 v12, v90, v81, v12
v_dot2_f32_bf16 v13, v91, v81, v13
v_dot2_f32_bf16 v14, v92, v81, v14
v_dot2_f32_bf16 v15, v93, v81, v15
v_dot2_f32_bf16 v16, v94, v81, v16
v_dot2_f32_bf16 v17, v95, v81, v17
v_dot2_f32_bf16 v18, v96, v81, v18
v_dot2_f32_bf16 v19, v97, v81, v19
v_dot2_f32_bf16 v20, v90, v82, v20
v_dot2_f32_bf16 v21, v91, v82, v21
v_dot2_f32_bf16 v22, v92, v82, v22
v_dot2_f32_bf16 v23, v93, v82, v23
v_dot2_f32_bf16 v24, v94, v82, v24
v_dot2_f32_bf16 v25, v95, v82, v25
v_dot2_f32_bf16 v26, v96, v82, v26
v_dot2_f32_bf16 v27, v97, v82, v27
v_dot2_f32_bf16 v28, v90, v83, v28
v_dot2_f32_bf16 v29, v91, v83, v29
v_dot2_f32_bf16 v30, v92, v83, v30
v_dot2_f32_bf16 v31, v93, v83, v31
v_dot2_f32_bf16 v32, v94, v83, v32
v_dot2_f32_bf16 v33, v95, v83, v33
v_dot2_f32_bf16 v34, v96, v83, v34
v_dot2_f32_bf16 v35, v97, v83, v35
v_dot2_f32_bf16 v36, v90, v84, v36
v_dot2_f32_bf16 v37, v91, v84, v37
v_dot2_f32_bf16 v38, v92, v84, v38
v_dot2_f32_bf16 v39, v93, v84, v39
v_dot2_f32_bf16 v40, v94, v84, v40
v_dot2_f32_bf16 v41, v95, v84, v41
v_dot2_f32_bf16 v42, v96, v84, v42
v_dot2_f32_bf16 v43, v97, v84, v43
v_dot2_f32_bf16 v44, v90, v85, v44
v_dot2_f32_bf16 v45, v91, v85, v45
v_dot2_f32_bf16 v46, v92, v85, v46
v_dot2_f32_bf16 v47, v93, v85, v47
v_dot2_f32_bf16 v48, v94, v85, v48
v_dot2_f32_bf16 v49, v95, v85, v49
v_dot2_f32_bf16 v50, v96, v85, v50
v_dot2_f32_bf16 v51, v97, v85, v51
v_dot2_f32_bf16 v52, v90, v86, v52
v_dot2_f32_bf16 v53, v91, v86, v53
v_dot2_f32_bf16 v54, v92, v86, v54
v_dot2_f32_bf16 v55, v93, v86, v55
v_dot2_f32_bf16 v56, v94, v86, v56
v_dot2_f32_bf16 v57, v95, v86, v57
v_dot2_f32_bf16 v58, v96, v86, v58
v_dot2_f32_bf16 v59, v97, v86, v59
v_dot2_f32_bf16 v60, v90, v87, v60
v_dot2_f32_bf16 v61, v91, v87, v61
v_dot2_f32_bf16 v62, v92, v87, v62
v_dot2_f32_bf16 v63, v93, v87, v63
v_dot2_f32_bf16 v64, v94, v87, v64
v_dot2_f32_bf16 v65, v95, v87, v65
v_dot2_f32_bf16 v66, v96, v87, v66
v_dot2_f32_bf16 v67, v97, v87, v67
ds_read_b128 v[80:83], v223 offset:96
ds_read_b128 v[84:87], v223 offset:112
s_waitcnt vmcnt(10) lgkmcnt(0)
v_perm_b32 v90, v128, v124, s30
v_perm_b32 v91, v128, v124, s31
v_perm_b32 v92, v129, v125, s30
v_perm_b32 v93, v129, v125, s31
v_perm_b32 v94, v130, v126, s30
v_perm_b32 v95, v130, v126, s31
v_perm_b32 v96, v131, v127, s30
v_perm_b32 v97, v131, v127, s31
v_dot2_f32_bf16 v4, v90, v80, v4
v_dot2_f32_bf16 v5, v91, v80, v5
v_dot2_f32_bf16 v6, v92, v80, v6
v_dot2_f32_bf16 v7, v93, v80, v7
v_dot2_f32_bf16 v8, v94, v80, v8
v_dot2_f32_bf16 v9, v95, v80, v9
v_dot2_f32_bf16 v10, v96, v80, v10
v_dot2_f32_bf16 v11, v97, v80, v11
v_dot2_f32_bf16 v12, v90, v81, v12
v_dot2_f32_bf16 v13, v91, v81, v13
v_dot2_f32_bf16 v14, v92, v81, v14
v_dot2_f32_bf16 v15, v93, v81, v15
v_dot2_f32_bf16 v16, v94, v81, v16
v_dot2_f32_bf16 v17, v95, v81, v17
v_dot2_f32_bf16 v18, v96, v81, v18
v_dot2_f32_bf16 v19, v97, v81, v19
v_dot2_f32_bf16 v20, v90, v82, v20
v_dot2_f32_bf16 v21, v91, v82, v21
v_dot2_f32_bf16 v22, v92, v82, v22
v_dot2_f32_bf16 v23, v93, v82, v23
v_dot2_f32_bf16 v24, v94, v82, v24
v_dot2_f32_bf16 v25, v95, v82, v25
v_dot2_f32_bf16 v26, v96, v82, v26
v_dot2_f32_bf16 v27, v97, v82, v27
v_dot2_f32_bf16 v28, v90, v83, v28
v_dot2_f32_bf16 v29, v91, v83, v29
v_dot2_f32_bf16 v30, v92, v83, v30
v_dot2_f32_bf16 v31, v93, v83, v31
v_dot2_f32_bf16 v32, v94, v83, v32
v_dot2_f32_bf16 v33, v95, v83, v33
v_dot2_f32_bf16 v34, v96, v83, v34
v_dot2_f32_bf16 v35, v97, v83, v35
v_dot2_f32_bf16 v36, v90, v84, v36
v_dot2_f32_bf16 v37, v91, v84, v37
v_dot2_f32_bf16 v38, v92, v84, v38
v_dot2_f32_bf16 v39, v93, v84, v39
v_dot2_f32_bf16 v40, v94, v84, v40
v_dot2_f32_bf16 v41, v95, v84, v41
v_dot2_f32_bf16 v42, v96, v84, v42
v_dot2_f32_bf16 v43, v97, v84, v43
v_dot2_f32_bf16 v44, v90, v85, v44
v_dot2_f32_bf16 v45, v91, v85, v45
v_dot2_f32_bf16 v46, v92, v85, v46
v_dot2_f32_bf16 v47, v93, v85, v47
v_dot2_f32_bf16 v48, v94, v85, v48
v_dot2_f32_bf16 v49, v95, v85, v49
v_dot2_f32_bf16 v50, v96, v85, v50
v_dot2_f32_bf16 v51, v97, v85, v51
v_dot2_f32_bf16 v52, v90, v86, v52
v_dot2_f32_bf16 v53, v91, v86, v53
v_dot2_f32_bf16 v54, v92, v86, v54
v_dot2_f32_bf16 v55, v93, v86, v55
v_dot2_f32_bf16 v56, v94, v86, v56
v_dot2_f32_bf16 v57, v95, v86, v57
v_dot2_f32_bf16 v58, v96, v86, v58
v_dot2_f32_bf16 v59, v97, v86, v59
v_dot2_f32_bf16 v60, v90, v87, v60
v_dot2_f32_bf16 v61, v91, v87, v61
v_dot2_f32_bf16 v62, v92, v87, v62
v_dot2_f32_bf16 v63, v93, v87, v63
v_dot2_f32_bf16 v64, v94, v87, v64
v_dot2_f32_bf16 v65, v95, v87, v65
v_dot2_f32_bf16 v66, v96, v87, v66
v_dot2_f32_bf16 v67, v97, v87, v67
ds_read_b128 v[80:83], v223 offset:128
ds_read_b128 v[84:87], v223 offset:144
s_waitcnt vmcnt(8) lgkmcnt(0)
v_perm_b32 v90, v136, v132, s30
v_perm_b32 v91, v136, v132, s31
v_perm_b32 v92, v137, v133, s30
v_perm_b32 v93, v137, v133, s31
v_perm_b32 v94, v138, v134, s30
v_perm_b32 v95, v138, v134, s31
v_perm_b32 v96, v139, v135, s30
v_perm_b32 v97, v139, v135, s31
v_dot2_f32_bf16 v4, v90, v80, v4
v_dot2_f32_bf16 v5, v91, v80, v5
v_dot2_f32_bf16 v6, v92, v80, v6
v_dot2_f32_bf16 v7, v93, v80, v7
v_dot2_f32_bf16 v8, v94, v80, v8
v_dot2_f32_bf16 v9, v95, v80, v9
v_dot2_f32_bf16 v10, v96, v80, v10
v_dot2_f32_bf16 v11, v97, v80, v11
v_dot2_f32_bf16 v12, v90, v81, v12
v_dot2_f32_bf16 v13, v91, v81, v13
v_dot2_f32_bf16 v14, v92, v81, v14
v_dot2_f32_bf16 v15, v93, v81, v15
v_dot2_f32_bf16 v16, v94, v81, v16
v_dot2_f32_bf16 v17, v95, v81, v17
v_dot2_f32_bf16 v18, v96, v81, v18
v_dot2_f32_bf16 v19, v97, v81, v19
v_dot2_f32_bf16 v20, v90, v82, v20
v_dot2_f32_bf16 v21, v91, v82, v21
v_dot2_f32_bf16 v22, v92, v82, v22
v_dot2_f32_bf16 v23, v93, v82, v23
v_dot2_f32_bf16 v24, v94, v82, v24
v_dot2_f32_bf16 v25, v95, v82, v25
v_dot2_f32_bf16 v26, v96, v82, v26
v_dot2_f32_bf16 v27, v97, v82, v27
v_dot2_f32_bf16 v28, v90, v83, v28
v_dot2_f32_bf16 v29, v91, v83, v29
v_dot2_f32_bf16 v30, v92, v83, v30
v_dot2_f32_bf16 v31, v93, v83, v31
v_dot2_f32_bf16 v32, v94, v83, v32
v_dot2_f32_bf16 v33, v95, v83, v33
v_dot2_f32_bf16 v34, v96, v83, v34
v_dot2_f32_bf16 v35, v97, v83, v35
v_dot2_f32_bf16 v36, v90, v84, v36
v_dot2_f32_bf16 v37, v91, v84, v37
v_dot2_f32_bf16 v38, v92, v84, v38
v_dot2_f32_bf16 v39, v93, v84, v39
v_dot2_f32_bf16 v40, v94, v84, v40
v_dot2_f32_bf16 v41, v95, v84, v41
v_dot2_f32_bf16 v42, v96, v84, v42
v_dot2_f32_bf16 v43, v97, v84, v43
v_dot2_f32_bf16 v44, v90, v85, v44
v_dot2_f32_bf16 v45, v91, v85, v45
v_dot2_f32_bf16 v46, v92, v85, v46
v_dot2_f32_bf16 v47, v93, v85, v47
v_dot2_f32_bf16 v48, v94, v85, v48
v_dot2_f32_bf16 v49, v95, v85, v49
v_dot2_f32_bf16 v50, v96, v85, v50
v_dot2_f32_bf16 v51, v97, v85, v51
v_dot2_f32_bf16 v52, v90, v86, v52
v_dot2_f32_bf16 v53, v91, v86, v53
v_dot2_f32_bf16 v54, v92, v86, v54
v_dot2_f32_bf16 v55, v93, v86, v55
v_dot2_f32_bf16 v56, v94, v86, v56
v_dot2_f32_bf16 v57, v95, v86, v57
v_dot2_f32_bf16 v58, v96, v86, v58
v_dot2_f32_bf16 v59, v97, v86, v59
v_dot2_f32_bf16 v60, v90, v87, v60
v_dot2_f32_bf16 v61, v91, v87, v61
v_dot2_f32_bf16 v62, v92, v87, v62
v_dot2_f32_bf16 v63, v93, v87, v63
v_dot2_f32_bf16 v64, v94, v87, v64
v_dot2_f32_bf16 v65, v95, v87, v65
v_dot2_f32_bf16 v66, v96, v87, v66
v_dot2_f32_bf16 v67, v97, v87, v67
ds_read_b128 v[80:83], v223 offset:160
ds_read_b128 v[84:87], v223 offset:176
s_waitcnt vmcnt(6) lgkmcnt(0)
v_perm_b32 v90, v144, v140, s30
v_perm_b32 v91, v144, v140, s31
v_perm_b32 v92, v145, v141, s30
v_perm_b32 v93, v145, v141, s31
v_perm_b32 v94, v146, v142, s30
v_perm_b32 v95, v146, v142, s31
v_perm_b32 v96, v147, v143, s30
v_perm_b32 v97, v147, v143, s31
v_dot2_f32_bf16 v4, v90, v80, v4
v_dot2_f32_bf16 v5, v91, v80, v5
v_dot2_f32_bf16 v6, v92, v80, v6
v_dot2_f32_bf16 v7, v93, v80, v7
v_dot2_f32_bf16 v8, v94, v80, v8
v_dot2_f32_bf16 v9, v95, v80, v9
v_dot2_f32_bf16 v10, v96, v80, v10
v_dot2_f32_bf16 v11, v97, v80, v11
v_dot2_f32_bf16 v12, v90, v81, v12
v_dot2_f32_bf16 v13, v91, v81, v13
v_dot2_f32_bf16 v14, v92, v81, v14
v_dot2_f32_bf16 v15, v93, v81, v15
v_dot2_f32_bf16 v16, v94, v81, v16
v_dot2_f32_bf16 v17, v95, v81, v17
v_dot2_f32_bf16 v18, v96, v81, v18
v_dot2_f32_bf16 v19, v97, v81, v19
v_dot2_f32_bf16 v20, v90, v82, v20
v_dot2_f32_bf16 v21, v91, v82, v21
v_dot2_f32_bf16 v22, v92, v82, v22
v_dot2_f32_bf16 v23, v93, v82, v23
v_dot2_f32_bf16 v24, v94, v82, v24
v_dot2_f32_bf16 v25, v95, v82, v25
v_dot2_f32_bf16 v26, v96, v82, v26
v_dot2_f32_bf16 v27, v97, v82, v27
v_dot2_f32_bf16 v28, v90, v83, v28
v_dot2_f32_bf16 v29, v91, v83, v29
v_dot2_f32_bf16 v30, v92, v83, v30
v_dot2_f32_bf16 v31, v93, v83, v31
v_dot2_f32_bf16 v32, v94, v83, v32
v_dot2_f32_bf16 v33, v95, v83, v33
v_dot2_f32_bf16 v34, v96, v83, v34
v_dot2_f32_bf16 v35, v97, v83, v35
v_dot2_f32_bf16 v36, v90, v84, v36
v_dot2_f32_bf16 v37, v91, v84, v37
v_dot2_f32_bf16 v38, v92, v84, v38
v_dot2_f32_bf16 v39, v93, v84, v39
v_dot2_f32_bf16 v40, v94, v84, v40
v_dot2_f32_bf16 v41, v95, v84, v41
v_dot2_f32_bf16 v42, v96, v84, v42
v_dot2_f32_bf16 v43, v97, v84, v43
v_dot2_f32_bf16 v44, v90, v85, v44
v_dot2_f32_bf16 v45, v91, v85, v45
v_dot2_f32_bf16 v46, v92, v85, v46
v_dot2_f32_bf16 v47, v93, v85, v47
v_dot2_f32_bf16 v48, v94, v85, v48
v_dot2_f32_bf16 v49, v95, v85, v49
v_dot2_f32_bf16 v50, v96, v85, v50
v_dot2_f32_bf16 v51, v97, v85, v51
v_dot2_f32_bf16 v52, v90, v86, v52
v_dot2_f32_bf16 v53, v91, v86, v53
v_dot2_f32_bf16 v54, v92, v86, v54
v_dot2_f32_bf16 v55, v93, v86, v55
v_dot2_f32_bf16 v56, v94, v86, v56
v_dot2_f32_bf16 v57, v95, v86, v57
v_dot2_f32_bf16 v58, v96, v86, v58
v_dot2_f32_bf16 v59, v97, v86, v59
v_dot2_f32_bf16 v60, v90, v87, v60
v_dot2_f32_bf16 v61, v91, v87, v61
v_dot2_f32_bf16 v62, v92, v87, v62
v_dot2_f32_bf16 v63, v93, v87, v63
v_dot2_f32_bf16 v64, v94, v87, v64
v_dot2_f32_bf16 v65, v95, v87, v65
v_dot2_f32_bf16 v66, v96, v87, v66
v_dot2_f32_bf16 v67, v97, v87, v67
ds_read_b128 v[80:83], v223 offset:192
ds_read_b128 v[84:87], v223 offset:208
s_waitcnt vmcnt(4) lgkmcnt(0)
v_perm_b32 v90, v152, v148, s30
v_perm_b32 v91, v152, v148, s31
v_perm_b32 v92, v153, v149, s30
v_perm_b32 v93, v153, v149, s31
v_perm_b32 v94, v154, v150, s30
v_perm_b32 v95, v154, v150, s31
v_perm_b32 v96, v155, v151, s30
v_perm_b32 v97, v155, v151, s31
v_dot2_f32_bf16 v4, v90, v80, v4
v_dot2_f32_bf16 v5, v91, v80, v5
v_dot2_f32_bf16 v6, v92, v80, v6
v_dot2_f32_bf16 v7, v93, v80, v7
v_dot2_f32_bf16 v8, v94, v80, v8
v_dot2_f32_bf16 v9, v95, v80, v9
v_dot2_f32_bf16 v10, v96, v80, v10
v_dot2_f32_bf16 v11, v97, v80, v11
v_dot2_f32_bf16 v12, v90, v81, v12
v_dot2_f32_bf16 v13, v91, v81, v13
v_dot2_f32_bf16 v14, v92, v81, v14
v_dot2_f32_bf16 v15, v93, v81, v15
v_dot2_f32_bf16 v16, v94, v81, v16
v_dot2_f32_bf16 v17, v95, v81, v17
v_dot2_f32_bf16 v18, v96, v81, v18
v_dot2_f32_bf16 v19, v97, v81, v19
v_dot2_f32_bf16 v20, v90, v82, v20
v_dot2_f32_bf16 v21, v91, v82, v21
v_dot2_f32_bf16 v22, v92, v82, v22
v_dot2_f32_bf16 v23, v93, v82, v23
v_dot2_f32_bf16 v24, v94, v82, v24
v_dot2_f32_bf16 v25, v95, v82, v25
v_dot2_f32_bf16 v26, v96, v82, v26
v_dot2_f32_bf16 v27, v97, v82, v27
v_dot2_f32_bf16 v28, v90, v83, v28
v_dot2_f32_bf16 v29, v91, v83, v29
v_dot2_f32_bf16 v30, v92, v83, v30
v_dot2_f32_bf16 v31, v93, v83, v31
v_dot2_f32_bf16 v32, v94, v83, v32
v_dot2_f32_bf16 v33, v95, v83, v33
v_dot2_f32_bf16 v34, v96, v83, v34
v_dot2_f32_bf16 v35, v97, v83, v35
v_dot2_f32_bf16 v36, v90, v84, v36
v_dot2_f32_bf16 v37, v91, v84, v37
v_dot2_f32_bf16 v38, v92, v84, v38
v_dot2_f32_bf16 v39, v93, v84, v39
v_dot2_f32_bf16 v40, v94, v84, v40
v_dot2_f32_bf16 v41, v95, v84, v41
v_dot2_f32_bf16 v42, v96, v84, v42
v_dot2_f32_bf16 v43, v97, v84, v43
v_dot2_f32_bf16 v44, v90, v85, v44
v_dot2_f32_bf16 v45, v91, v85, v45
v_dot2_f32_bf16 v46, v92, v85, v46
v_dot2_f32_bf16 v47, v93, v85, v47
v_dot2_f32_bf16 v48, v94, v85, v48
v_dot2_f32_bf16 v49, v95, v85, v49
v_dot2_f32_bf16 v50, v96, v85, v50
v_dot2_f32_bf16 v51, v97, v85, v51
v_dot2_f32_bf16 v52, v90, v86, v52
v_dot2_f32_bf16 v53, v91, v86, v53
v_dot2_f32_bf16 v54, v92, v86, v54
v_dot2_f32_bf16 v55, v93, v86, v55
v_dot2_f32_bf16 v56, v94, v86, v56
v_dot2_f32_bf16 v57, v95, v86, v57
v_dot2_f32_bf16 v58, v96, v86, v58
v_dot2_f32_bf16 v59, v97, v86, v59
v_dot2_f32_bf16 v60, v90, v87, v60
v_dot2_f32_bf16 v61, v91, v87, v61
v_dot2_f32_bf16 v62, v92, v87, v62
v_dot2_f32_bf16 v63, v93, v87, v63
v_dot2_f32_bf16 v64, v94, v87, v64
v_dot2_f32_bf16 v65, v95, v87, v65
v_dot2_f32_bf16 v66, v96, v87, v66
v_dot2_f32_bf16 v67, v97, v87, v67
ds_read_b128 v[80:83], v223 offset:224
ds_read_b128 v[84:87], v223 offset:240
s_waitcnt vmcnt(2) lgkmcnt(0)
v_perm_b32 v90, v160, v156, s30
v_perm_b32 v91, v160, v156, s31
v_perm_b32 v92, v161, v157, s30
v_perm_b32 v93, v161, v157, s31
v_perm_b32 v94, v162, v158, s30
v_perm_b32 v95, v162, v158, s31
v_perm_b32 v96, v163, v159, s30
v_perm_b32 v97, v163, v159, s31
v_dot2_f32_bf16 v4, v90, v80, v4
v_dot2_f32_bf16 v5, v91, v80, v5
v_dot2_f32_bf16 v6, v92, v80, v6
v_dot2_f32_bf16 v7, v93, v80, v7
v_dot2_f32_bf16 v8, v94, v80, v8
v_dot2_f32_bf16 v9, v95, v80, v9
v_dot2_f32_bf16 v10, v96, v80, v10
v_dot2_f32_bf16 v11, v97, v80, v11
v_dot2_f32_bf16 v12, v90, v81, v12
v_dot2_f32_bf16 v13, v91, v81, v13
v_dot2_f32_bf16 v14, v92, v81, v14
v_dot2_f32_bf16 v15, v93, v81, v15
v_dot2_f32_bf16 v16, v94, v81, v16
v_dot2_f32_bf16 v17, v95, v81, v17
v_dot2_f32_bf16 v18, v96, v81, v18
v_dot2_f32_bf16 v19, v97, v81, v19
v_dot2_f32_bf16 v20, v90, v82, v20
v_dot2_f32_bf16 v21, v91, v82, v21
v_dot2_f32_bf16 v22, v92, v82, v22
v_dot2_f32_bf16 v23, v93, v82, v23
v_dot2_f32_bf16 v24, v94, v82, v24
v_dot2_f32_bf16 v25, v95, v82, v25
v_dot2_f32_bf16 v26, v96, v82, v26
v_dot2_f32_bf16 v27, v97, v82, v27
v_dot2_f32_bf16 v28, v90, v83, v28
v_dot2_f32_bf16 v29, v91, v83, v29
v_dot2_f32_bf16 v30, v92, v83, v30
v_dot2_f32_bf16 v31, v93, v83, v31
v_dot2_f32_bf16 v32, v94, v83, v32
v_dot2_f32_bf16 v33, v95, v83, v33
v_dot2_f32_bf16 v34, v96, v83, v34
v_dot2_f32_bf16 v35, v97, v83, v35
v_dot2_f32_bf16 v36, v90, v84, v36
v_dot2_f32_bf16 v37, v91, v84, v37
v_dot2_f32_bf16 v38, v92, v84, v38
v_dot2_f32_bf16 v39, v93, v84, v39
v_dot2_f32_bf16 v40, v94, v84, v40
v_dot2_f32_bf16 v41, v95, v84, v41
v_dot2_f32_bf16 v42, v96, v84, v42
v_dot2_f32_bf16 v43, v97, v84, v43
v_dot2_f32_bf16 v44, v90, v85, v44
v_dot2_f32_bf16 v45, v91, v85, v45
v_dot2_f32_bf16 v46, v92, v85, v46
v_dot2_f32_bf16 v47, v93, v85, v47
v_dot2_f32_bf16 v48, v94, v85, v48
v_dot2_f32_bf16 v49, v95, v85, v49
v_dot2_f32_bf16 v50, v96, v85, v50
v_dot2_f32_bf16 v51, v97, v85, v51
v_dot2_f32_bf16 v52, v90, v86, v52
v_dot2_f32_bf16 v53, v91, v86, v53
v_dot2_f32_bf16 v54, v92, v86, v54
v_dot2_f32_bf16 v55, v93, v86, v55
v_dot2_f32_bf16 v56, v94, v86, v56
v_dot2_f32_bf16 v57, v95, v86, v57
v_dot2_f32_bf16 v58, v96, v86, v58
v_dot2_f32_bf16 v59, v97, v86, v59
v_dot2_f32_bf16 v60, v90, v87, v60
v_dot2_f32_bf16 v61, v91, v87, v61
v_dot2_f32_bf16 v62, v92, v87, v62
v_dot2_f32_bf16 v63, v93, v87, v63
v_dot2_f32_bf16 v64, v94, v87, v64
v_dot2_f32_bf16 v65, v95, v87, v65
v_dot2_f32_bf16 v66, v96, v87, v66
v_dot2_f32_bf16 v67, v97, v87, v67
ds_read_b128 v[80:83], v223 offset:256
ds_read_b128 v[84:87], v223 offset:272
s_waitcnt vmcnt(0) lgkmcnt(0)
v_perm_b32 v90, v168, v164, s30
v_perm_b32 v91, v168, v164, s31
v_perm_b32 v92, v169, v165, s30
v_perm_b32 v93, v169, v165, s31
v_perm_b32 v94, v170, v166, s30
v_perm_b32 v95, v170, v166, s31
v_perm_b32 v96, v171, v167, s30
v_perm_b32 v97, v171, v167, s31
v_dot2_f32_bf16 v4, v90, v80, v4
v_dot2_f32_bf16 v5, v91, v80, v5
v_dot2_f32_bf16 v6, v92, v80, v6
v_dot2_f32_bf16 v7, v93, v80, v7
v_dot2_f32_bf16 v8, v94, v80, v8
v_dot2_f32_bf16 v9, v95, v80, v9
v_dot2_f32_bf16 v10, v96, v80, v10
v_dot2_f32_bf16 v11, v97, v80, v11
v_dot2_f32_bf16 v12, v90, v81, v12
v_dot2_f32_bf16 v13, v91, v81, v13
v_dot2_f32_bf16 v14, v92, v81, v14
v_dot2_f32_bf16 v15, v93, v81, v15
v_dot2_f32_bf16 v16, v94, v81, v16
v_dot2_f32_bf16 v17, v95, v81, v17
v_dot2_f32_bf16 v18, v96, v81, v18
v_dot2_f32_bf16 v19, v97, v81, v19
v_dot2_f32_bf16 v20, v90, v82, v20
v_dot2_f32_bf16 v21, v91, v82, v21
v_dot2_f32_bf16 v22, v92, v82, v22
v_dot2_f32_bf16 v23, v93, v82, v23
v_dot2_f32_bf16 v24, v94, v82, v24
v_dot2_f32_bf16 v25, v95, v82, v25
v_dot2_f32_bf16 v26, v96, v82, v26
v_dot2_f32_bf16 v27, v97, v82, v27
v_dot2_f32_bf16 v28, v90, v83, v28
v_dot2_f32_bf16 v29, v91, v83, v29
v_dot2_f32_bf16 v30, v92, v83, v30
v_dot2_f32_bf16 v31, v93, v83, v31
v_dot2_f32_bf16 v32, v94, v83, v32
v_dot2_f32_bf16 v33, v95, v83, v33
v_dot2_f32_bf16 v34, v96, v83, v34
v_dot2_f32_bf16 v35, v97, v83, v35
v_dot2_f32_bf16 v36, v90, v84, v36
v_dot2_f32_bf16 v37, v91, v84, v37
v_dot2_f32_bf16 v38, v92, v84, v38
v_dot2_f32_bf16 v39, v93, v84, v39
v_dot2_f32_bf16 v40, v94, v84, v40
v_dot2_f32_bf16 v41, v95, v84, v41
v_dot2_f32_bf16 v42, v96, v84, v42
v_dot2_f32_bf16 v43, v97, v84, v43
v_dot2_f32_bf16 v44, v90, v85, v44
v_dot2_f32_bf16 v45, v91, v85, v45
v_dot2_f32_bf16 v46, v92, v85, v46
v_dot2_f32_bf16 v47, v93, v85, v47
v_dot2_f32_bf16 v48, v94, v85, v48
v_dot2_f32_bf16 v49, v95, v85, v49
v_dot2_f32_bf16 v50, v96, v85, v50
v_dot2_f32_bf16 v51, v97, v85, v51
v_dot2_f32_bf16 v52, v90, v86, v52
v_dot2_f32_bf16 v53, v91, v86, v53
v_dot2_f32_bf16 v54, v92, v86, v54
v_dot2_f32_bf16 v55, v93, v86, v55
v_dot2_f32_bf16 v56, v94, v86, v56
v_dot2_f32_bf16 v57, v95, v86, v57
v_dot2_f32_bf16 v58, v96, v86, v58
v_dot2_f32_bf16 v59, v97, v86, v59
v_dot2_f32_bf16 v60, v90, v87, v60
v_dot2_f32_bf16 v61, v91, v87, v61
v_dot2_f32_bf16 v62, v92, v87, v62
v_dot2_f32_bf16 v63, v93, v87, v63
v_dot2_f32_bf16 v64, v94, v87, v64
v_dot2_f32_bf16 v65, v95, v87, v65
v_dot2_f32_bf16 v66, v96, v87, v66
v_dot2_f32_bf16 v67, v97, v87, v67
s_nop 4
v_lshlrev_b32 v225, 11, v221
v_lshl_add_u32 v225, v220, 5, v225
s_barrier
ds_write_b128 v225, v[4:7] offset:16384
ds_write_b128 v225, v[8:11] offset:16400
ds_write_b128 v225, v[12:15] offset:16640
ds_write_b128 v225, v[16:19] offset:16656
ds_write_b128 v225, v[20:23] offset:16896
ds_write_b128 v225, v[24:27] offset:16912
ds_write_b128 v225, v[28:31] offset:17152
ds_write_b128 v225, v[32:35] offset:17168
ds_write_b128 v225, v[36:39] offset:17408
ds_write_b128 v225, v[40:43] offset:17424
ds_write_b128 v225, v[44:47] offset:17664
ds_write_b128 v225, v[48:51] offset:17680
ds_write_b128 v225, v[52:55] offset:17920
ds_write_b128 v225, v[56:59] offset:17936
ds_write_b128 v225, v[60:63] offset:18176
ds_write_b128 v225, v[64:67] offset:18192
s_waitcnt lgkmcnt(0)
s_barrier
v_lshlrev_b32 v226, 3, v0
v_add_u32 v226, 16384, v226
ds_read_b64 v[4:5], v226 offset:0
ds_read_b64 v[6:7], v226 offset:2048
ds_read_b64 v[8:9], v226 offset:4096
ds_read_b64 v[10:11], v226 offset:6144
ds_read_b64 v[12:13], v226 offset:8192
ds_read_b64 v[14:15], v226 offset:10240
ds_read_b64 v[16:17], v226 offset:12288
ds_read_b64 v[18:19], v226 offset:14336
ds_read_b64 v[20:21], v226 offset:16384
ds_read_b64 v[22:23], v226 offset:18432
ds_read_b64 v[24:25], v226 offset:20480
ds_read_b64 v[26:27], v226 offset:22528
ds_read_b64 v[28:29], v226 offset:24576
ds_read_b64 v[30:31], v226 offset:26624
ds_read_b64 v[32:33], v226 offset:28672
ds_read_b64 v[34:35], v226 offset:30720
ds_read_b64 v[36:37], v226 offset:32768
ds_read_b64 v[38:39], v226 offset:34816
ds_read_b64 v[40:41], v226 offset:36864
ds_read_b64 v[42:43], v226 offset:38912
ds_read_b64 v[44:45], v226 offset:40960
ds_read_b64 v[46:47], v226 offset:43008
ds_read_b64 v[48:49], v226 offset:45056
ds_read_b64 v[50:51], v226 offset:47104
ds_read_b64 v[52:53], v226 offset:49152
ds_read_b64 v[54:55], v226 offset:51200
ds_read_b64 v[56:57], v226 offset:53248
ds_read_b64 v[58:59], v226 offset:55296
ds_read_b64 v[60:61], v226 offset:57344
ds_read_b64 v[62:63], v226 offset:59392
ds_read_b64 v[64:65], v226 offset:61440
ds_read_b64 v[66:67], v226 offset:63488
s_waitcnt lgkmcnt(0)
v_mov_b32 v210, 0
v_mov_b32 v211, 0
v_add_f32 v210, v210, v4
v_add_f32 v211, v211, v5
v_add_f32 v210, v210, v6
v_add_f32 v211, v211, v7
v_add_f32 v210, v210, v8
v_add_f32 v211, v211, v9
v_add_f32 v210, v210, v10
v_add_f32 v211, v211, v11
v_add_f32 v210, v210, v12
v_add_f32 v211, v211, v13
v_add_f32 v210, v210, v14
v_add_f32 v211, v211, v15
v_add_f32 v210, v210, v16
v_add_f32 v211, v211, v17
v_add_f32 v210, v210, v18
v_add_f32 v211, v211, v19
v_add_f32 v210, v210, v20
v_add_f32 v211, v211, v21
v_add_f32 v210, v210, v22
v_add_f32 v211, v211, v23
v_add_f32 v210, v210, v24
v_add_f32 v211, v211, v25
v_add_f32 v210, v210, v26
v_add_f32 v211, v211, v27
v_add_f32 v210, v210, v28
v_add_f32 v211, v211, v29
v_add_f32 v210, v210, v30
v_add_f32 v211, v211, v31
v_add_f32 v210, v210, v32
v_add_f32 v211, v211, v33
v_add_f32 v210, v210, v34
v_add_f32 v211, v211, v35
v_add_f32 v210, v210, v36
v_add_f32 v211, v211, v37
v_add_f32 v210, v210, v38
v_add_f32 v211, v211, v39
v_add_f32 v210, v210, v40
v_add_f32 v211, v211, v41
v_add_f32 v210, v210, v42
v_add_f32 v211, v211, v43
v_add_f32 v210, v210, v44
v_add_f32 v211, v211, v45
v_add_f32 v210, v210, v46
v_add_f32 v211, v211, v47
v_add_f32 v210, v210, v48
v_add_f32 v211, v211, v49
v_add_f32 v210, v210, v50
v_add_f32 v211, v211, v51
v_add_f32 v210, v210, v52
v_add_f32 v211, v211, v53
v_add_f32 v210, v210, v54
v_add_f32 v211, v211, v55
v_add_f32 v210, v210, v56
v_add_f32 v211, v211, v57
v_add_f32 v210, v210, v58
v_add_f32 v211, v211, v59
v_add_f32 v210, v210, v60
v_add_f32 v211, v211, v61
v_add_f32 v210, v210, v62
v_add_f32 v211, v211, v63
v_add_f32 v210, v210, v64
v_add_f32 v211, v211, v65
v_add_f32 v210, v210, v66
v_add_f32 v211, v211, v67
v_mov_b32 v4, 0
v_mov_b32 v5, 0
v_mov_b32 v6, 0
v_mov_b32 v7, 0
v_mov_b32 v8, 0
v_mov_b32 v9, 0
v_mov_b32 v10, 0
v_mov_b32 v11, 0
v_mov_b32 v12, 0
v_mov_b32 v13, 0
v_mov_b32 v14, 0
v_mov_b32 v15, 0
v_mov_b32 v16, 0
v_mov_b32 v17, 0
v_mov_b32 v18, 0
v_mov_b32 v19, 0
v_mov_b32 v20, 0
v_mov_b32 v21, 0
v_mov_b32 v22, 0
v_mov_b32 v23, 0
v_mov_b32 v24, 0
v_mov_b32 v25, 0
v_mov_b32 v26, 0
v_mov_b32 v27, 0
v_mov_b32 v28, 0
v_mov_b32 v29, 0
v_mov_b32 v30, 0
v_mov_b32 v31, 0
v_mov_b32 v32, 0
v_mov_b32 v33, 0
v_mov_b32 v34, 0
v_mov_b32 v35, 0
v_mov_b32 v36, 0
v_mov_b32 v37, 0
v_mov_b32 v38, 0
v_mov_b32 v39, 0
v_mov_b32 v40, 0
v_mov_b32 v41, 0
v_mov_b32 v42, 0
v_mov_b32 v43, 0
v_mov_b32 v44, 0
v_mov_b32 v45, 0
v_mov_b32 v46, 0
v_mov_b32 v47, 0
v_mov_b32 v48, 0
v_mov_b32 v49, 0
v_mov_b32 v50, 0
v_mov_b32 v51, 0
v_mov_b32 v52, 0
v_mov_b32 v53, 0
v_mov_b32 v54, 0
v_mov_b32 v55, 0
v_mov_b32 v56, 0
v_mov_b32 v57, 0
v_mov_b32 v58, 0
v_mov_b32 v59, 0
v_mov_b32 v60, 0
v_mov_b32 v61, 0
v_mov_b32 v62, 0
v_mov_b32 v63, 0
v_mov_b32 v64, 0
v_mov_b32 v65, 0
v_mov_b32 v66, 0
v_mov_b32 v67, 0
v_add_u32 v224, 0, v222
buffer_load_dwordx4 v[100:103], v224, s[12:15], s29 offen
v_add_u32 v224, 9216, v222
buffer_load_dwordx4 v[104:107], v224, s[12:15], s29 offen
v_add_u32 v224, 18432, v222
buffer_load_dwordx4 v[108:111], v224, s[12:15], s29 offen
v_add_u32 v224, 27648, v222
buffer_load_dwordx4 v[112:115], v224, s[12:15], s29 offen
v_add_u32 v224, 36864, v222
buffer_load_dwordx4 v[116:119], v224, s[12:15], s29 offen
v_add_u32 v224, 46080, v222
buffer_load_dwordx4 v[120:123], v224, s[12:15], s29 offen
v_add_u32 v224, 55296, v222
buffer_load_dwordx4 v[124:127], v224, s[12:15], s29 offen
v_add_u32 v224, 64512, v222
buffer_load_dwordx4 v[128:131], v224, s[12:15], s29 offen
v_add_u32 v224, 73728, v222
buffer_load_dwordx4 v[132:135], v224, s[12:15], s29 offen
v_add_u32 v224, 82944, v222
buffer_load_dwordx4 v[136:139], v224, s[12:15], s29 offen
v_add_u32 v224, 92160, v222
buffer_load_dwordx4 v[140:143], v224, s[12:15], s29 offen
v_add_u32 v224, 101376, v222
buffer_load_dwordx4 v[144:147], v224, s[12:15], s29 offen
v_add_u32 v224, 110592, v222
buffer_load_dwordx4 v[148:151], v224, s[12:15], s29 offen
v_add_u32 v224, 119808, v222
buffer_load_dwordx4 v[152:155], v224, s[12:15], s29 offen
v_add_u32 v224, 129024, v222
buffer_load_dwordx4 v[156:159], v224, s[12:15], s29 offen
v_add_u32 v224, 138240, v222
buffer_load_dwordx4 v[160:163], v224, s[12:15], s29 offen
v_add_u32 v224, 147456, v222
buffer_load_dwordx4 v[164:167], v224, s[12:15], s29 offen
v_add_u32 v224, 156672, v222
buffer_load_dwordx4 v[168:171], v224, s[12:15], s29 offen
ds_read_b128 v[80:83], v223 offset:0
ds_read_b128 v[84:87], v223 offset:16
s_waitcnt vmcnt(16) lgkmcnt(0)
v_perm_b32 v90, v104, v100, s30
v_perm_b32 v91, v104, v100, s31
v_perm_b32 v92, v105, v101, s30
v_perm_b32 v93, v105, v101, s31
v_perm_b32 v94, v106, v102, s30
v_perm_b32 v95, v106, v102, s31
v_perm_b32 v96, v107, v103, s30
v_perm_b32 v97, v107, v103, s31
v_dot2_f32_bf16 v4, v90, v80, v4
v_dot2_f32_bf16 v5, v91, v80, v5
v_dot2_f32_bf16 v6, v92, v80, v6
v_dot2_f32_bf16 v7, v93, v80, v7
v_dot2_f32_bf16 v8, v94, v80, v8
v_dot2_f32_bf16 v9, v95, v80, v9
v_dot2_f32_bf16 v10, v96, v80, v10
v_dot2_f32_bf16 v11, v97, v80, v11
v_dot2_f32_bf16 v12, v90, v81, v12
v_dot2_f32_bf16 v13, v91, v81, v13
v_dot2_f32_bf16 v14, v92, v81, v14
v_dot2_f32_bf16 v15, v93, v81, v15
v_dot2_f32_bf16 v16, v94, v81, v16
v_dot2_f32_bf16 v17, v95, v81, v17
v_dot2_f32_bf16 v18, v96, v81, v18
v_dot2_f32_bf16 v19, v97, v81, v19
v_dot2_f32_bf16 v20, v90, v82, v20
v_dot2_f32_bf16 v21, v91, v82, v21
v_dot2_f32_bf16 v22, v92, v82, v22
v_dot2_f32_bf16 v23, v93, v82, v23
v_dot2_f32_bf16 v24, v94, v82, v24
v_dot2_f32_bf16 v25, v95, v82, v25
v_dot2_f32_bf16 v26, v96, v82, v26
v_dot2_f32_bf16 v27, v97, v82, v27
v_dot2_f32_bf16 v28, v90, v83, v28
v_dot2_f32_bf16 v29, v91, v83, v29
v_dot2_f32_bf16 v30, v92, v83, v30
v_dot2_f32_bf16 v31, v93, v83, v31
v_dot2_f32_bf16 v32, v94, v83, v32
v_dot2_f32_bf16 v33, v95, v83, v33
v_dot2_f32_bf16 v34, v96, v83, v34
v_dot2_f32_bf16 v35, v97, v83, v35
v_dot2_f32_bf16 v36, v90, v84, v36
v_dot2_f32_bf16 v37, v91, v84, v37
v_dot2_f32_bf16 v38, v92, v84, v38
v_dot2_f32_bf16 v39, v93, v84, v39
v_dot2_f32_bf16 v40, v94, v84, v40
v_dot2_f32_bf16 v41, v95, v84, v41
v_dot2_f32_bf16 v42, v96, v84, v42
v_dot2_f32_bf16 v43, v97, v84, v43
v_dot2_f32_bf16 v44, v90, v85, v44
v_dot2_f32_bf16 v45, v91, v85, v45
v_dot2_f32_bf16 v46, v92, v85, v46
v_dot2_f32_bf16 v47, v93, v85, v47
v_dot2_f32_bf16 v48, v94, v85, v48
v_dot2_f32_bf16 v49, v95, v85, v49
v_dot2_f32_bf16 v50, v96, v85, v50
v_dot2_f32_bf16 v51, v97, v85, v51
v_dot2_f32_bf16 v52, v90, v86, v52
v_dot2_f32_bf16 v53, v91, v86, v53
v_dot2_f32_bf16 v54, v92, v86, v54
v_dot2_f32_bf16 v55, v93, v86, v55
v_dot2_f32_bf16 v56, v94, v86, v56
v_dot2_f32_bf16 v57, v95, v86, v57
v_dot2_f32_bf16 v58, v96, v86, v58
v_dot2_f32_bf16 v59, v97, v86, v59
v_dot2_f32_bf16 v60, v90, v87, v60
v_dot2_f32_bf16 v61, v91, v87, v61
v_dot2_f32_bf16 v62, v92, v87, v62
v_dot2_f32_bf16 v63, v93, v87, v63
v_dot2_f32_bf16 v64, v94, v87, v64
v_dot2_f32_bf16 v65, v95, v87, v65
v_dot2_f32_bf16 v66, v96, v87, v66
v_dot2_f32_bf16 v67, v97, v87, v67
ds_read_b128 v[80:83], v223 offset:32
ds_read_b128 v[84:87], v223 offset:48
s_waitcnt vmcnt(14) lgkmcnt(0)
v_perm_b32 v90, v112, v108, s30
v_perm_b32 v91, v112, v108, s31
v_perm_b32 v92, v113, v109, s30
v_perm_b32 v93, v113, v109, s31
v_perm_b32 v94, v114, v110, s30
v_perm_b32 v95, v114, v110, s31
v_perm_b32 v96, v115, v111, s30
v_perm_b32 v97, v115, v111, s31
v_dot2_f32_bf16 v4, v90, v80, v4
v_dot2_f32_bf16 v5, v91, v80, v5
v_dot2_f32_bf16 v6, v92, v80, v6
v_dot2_f32_bf16 v7, v93, v80, v7
v_dot2_f32_bf16 v8, v94, v80, v8
v_dot2_f32_bf16 v9, v95, v80, v9
v_dot2_f32_bf16 v10, v96, v80, v10
v_dot2_f32_bf16 v11, v97, v80, v11
v_dot2_f32_bf16 v12, v90, v81, v12
v_dot2_f32_bf16 v13, v91, v81, v13
v_dot2_f32_bf16 v14, v92, v81, v14
v_dot2_f32_bf16 v15, v93, v81, v15
v_dot2_f32_bf16 v16, v94, v81, v16
v_dot2_f32_bf16 v17, v95, v81, v17
v_dot2_f32_bf16 v18, v96, v81, v18
v_dot2_f32_bf16 v19, v97, v81, v19
v_dot2_f32_bf16 v20, v90, v82, v20
v_dot2_f32_bf16 v21, v91, v82, v21
v_dot2_f32_bf16 v22, v92, v82, v22
v_dot2_f32_bf16 v23, v93, v82, v23
v_dot2_f32_bf16 v24, v94, v82, v24
v_dot2_f32_bf16 v25, v95, v82, v25
v_dot2_f32_bf16 v26, v96, v82, v26
v_dot2_f32_bf16 v27, v97, v82, v27
v_dot2_f32_bf16 v28, v90, v83, v28
v_dot2_f32_bf16 v29, v91, v83, v29
v_dot2_f32_bf16 v30, v92, v83, v30
v_dot2_f32_bf16 v31, v93, v83, v31
v_dot2_f32_bf16 v32, v94, v83, v32
v_dot2_f32_bf16 v33, v95, v83, v33
v_dot2_f32_bf16 v34, v96, v83, v34
v_dot2_f32_bf16 v35, v97, v83, v35
v_dot2_f32_bf16 v36, v90, v84, v36
v_dot2_f32_bf16 v37, v91, v84, v37
v_dot2_f32_bf16 v38, v92, v84, v38
v_dot2_f32_bf16 v39, v93, v84, v39
v_dot2_f32_bf16 v40, v94, v84, v40
v_dot2_f32_bf16 v41, v95, v84, v41
v_dot2_f32_bf16 v42, v96, v84, v42
v_dot2_f32_bf16 v43, v97, v84, v43
v_dot2_f32_bf16 v44, v90, v85, v44
v_dot2_f32_bf16 v45, v91, v85, v45
v_dot2_f32_bf16 v46, v92, v85, v46
v_dot2_f32_bf16 v47, v93, v85, v47
v_dot2_f32_bf16 v48, v94, v85, v48
v_dot2_f32_bf16 v49, v95, v85, v49
v_dot2_f32_bf16 v50, v96, v85, v50
v_dot2_f32_bf16 v51, v97, v85, v51
v_dot2_f32_bf16 v52, v90, v86, v52
v_dot2_f32_bf16 v53, v91, v86, v53
v_dot2_f32_bf16 v54, v92, v86, v54
v_dot2_f32_bf16 v55, v93, v86, v55
v_dot2_f32_bf16 v56, v94, v86, v56
v_dot2_f32_bf16 v57, v95, v86, v57
v_dot2_f32_bf16 v58, v96, v86, v58
v_dot2_f32_bf16 v59, v97, v86, v59
v_dot2_f32_bf16 v60, v90, v87, v60
v_dot2_f32_bf16 v61, v91, v87, v61
v_dot2_f32_bf16 v62, v92, v87, v62
v_dot2_f32_bf16 v63, v93, v87, v63
v_dot2_f32_bf16 v64, v94, v87, v64
v_dot2_f32_bf16 v65, v95, v87, v65
v_dot2_f32_bf16 v66, v96, v87, v66
v_dot2_f32_bf16 v67, v97, v87, v67
ds_read_b128 v[80:83], v223 offset:64
ds_read_b128 v[84:87], v223 offset:80
s_waitcnt vmcnt(12) lgkmcnt(0)
v_perm_b32 v90, v120, v116, s30
v_perm_b32 v91, v120, v116, s31
v_perm_b32 v92, v121, v117, s30
v_perm_b32 v93, v121, v117, s31
v_perm_b32 v94, v122, v118, s30
v_perm_b32 v95, v122, v118, s31
v_perm_b32 v96, v123, v119, s30
v_perm_b32 v97, v123, v119, s31
v_dot2_f32_bf16 v4, v90, v80, v4
v_dot2_f32_bf16 v5, v91, v80, v5
v_dot2_f32_bf16 v6, v92, v80, v6
v_dot2_f32_bf16 v7, v93, v80, v7
v_dot2_f32_bf16 v8, v94, v80, v8
v_dot2_f32_bf16 v9, v95, v80, v9
v_dot2_f32_bf16 v10, v96, v80, v10
v_dot2_f32_bf16 v11, v97, v80, v11
v_dot2_f32_bf16 v12, v90, v81, v12
v_dot2_f32_bf16 v13, v91, v81, v13
v_dot2_f32_bf16 v14, v92, v81, v14
v_dot2_f32_bf16 v15, v93, v81, v15
v_dot2_f32_bf16 v16, v94, v81, v16
v_dot2_f32_bf16 v17, v95, v81, v17
v_dot2_f32_bf16 v18, v96, v81, v18
v_dot2_f32_bf16 v19, v97, v81, v19
v_dot2_f32_bf16 v20, v90, v82, v20
v_dot2_f32_bf16 v21, v91, v82, v21
v_dot2_f32_bf16 v22, v92, v82, v22
v_dot2_f32_bf16 v23, v93, v82, v23
v_dot2_f32_bf16 v24, v94, v82, v24
v_dot2_f32_bf16 v25, v95, v82, v25
v_dot2_f32_bf16 v26, v96, v82, v26
v_dot2_f32_bf16 v27, v97, v82, v27
v_dot2_f32_bf16 v28, v90, v83, v28
v_dot2_f32_bf16 v29, v91, v83, v29
v_dot2_f32_bf16 v30, v92, v83, v30
v_dot2_f32_bf16 v31, v93, v83, v31
v_dot2_f32_bf16 v32, v94, v83, v32
v_dot2_f32_bf16 v33, v95, v83, v33
v_dot2_f32_bf16 v34, v96, v83, v34
v_dot2_f32_bf16 v35, v97, v83, v35
v_dot2_f32_bf16 v36, v90, v84, v36
v_dot2_f32_bf16 v37, v91, v84, v37
v_dot2_f32_bf16 v38, v92, v84, v38
v_dot2_f32_bf16 v39, v93, v84, v39
v_dot2_f32_bf16 v40, v94, v84, v40
v_dot2_f32_bf16 v41, v95, v84, v41
v_dot2_f32_bf16 v42, v96, v84, v42
v_dot2_f32_bf16 v43, v97, v84, v43
v_dot2_f32_bf16 v44, v90, v85, v44
v_dot2_f32_bf16 v45, v91, v85, v45
v_dot2_f32_bf16 v46, v92, v85, v46
v_dot2_f32_bf16 v47, v93, v85, v47
v_dot2_f32_bf16 v48, v94, v85, v48
v_dot2_f32_bf16 v49, v95, v85, v49
v_dot2_f32_bf16 v50, v96, v85, v50
v_dot2_f32_bf16 v51, v97, v85, v51
v_dot2_f32_bf16 v52, v90, v86, v52
v_dot2_f32_bf16 v53, v91, v86, v53
v_dot2_f32_bf16 v54, v92, v86, v54
v_dot2_f32_bf16 v55, v93, v86, v55
v_dot2_f32_bf16 v56, v94, v86, v56
v_dot2_f32_bf16 v57, v95, v86, v57
v_dot2_f32_bf16 v58, v96, v86, v58
v_dot2_f32_bf16 v59, v97, v86, v59
v_dot2_f32_bf16 v60, v90, v87, v60
v_dot2_f32_bf16 v61, v91, v87, v61
v_dot2_f32_bf16 v62, v92, v87, v62
v_dot2_f32_bf16 v63, v93, v87, v63
v_dot2_f32_bf16 v64, v94, v87, v64
v_dot2_f32_bf16 v65, v95, v87, v65
v_dot2_f32_bf16 v66, v96, v87, v66
v_dot2_f32_bf16 v67, v97, v87, v67
ds_read_b128 v[80:83], v223 offset:96
ds_read_b128 v[84:87], v223 offset:112
s_waitcnt vmcnt(10) lgkmcnt(0)
v_perm_b32 v90, v128, v124, s30
v_perm_b32 v91, v128, v124, s31
v_perm_b32 v92, v129, v125, s30
v_perm_b32 v93, v129, v125, s31
v_perm_b32 v94, v130, v126, s30
v_perm_b32 v95, v130, v126, s31
v_perm_b32 v96, v131, v127, s30
v_perm_b32 v97, v131, v127, s31
v_dot2_f32_bf16 v4, v90, v80, v4
v_dot2_f32_bf16 v5, v91, v80, v5
v_dot2_f32_bf16 v6, v92, v80, v6
v_dot2_f32_bf16 v7, v93, v80, v7
v_dot2_f32_bf16 v8, v94, v80, v8
v_dot2_f32_bf16 v9, v95, v80, v9
v_dot2_f32_bf16 v10, v96, v80, v10
v_dot2_f32_bf16 v11, v97, v80, v11
v_dot2_f32_bf16 v12, v90, v81, v12
v_dot2_f32_bf16 v13, v91, v81, v13
v_dot2_f32_bf16 v14, v92, v81, v14
v_dot2_f32_bf16 v15, v93, v81, v15
v_dot2_f32_bf16 v16, v94, v81, v16
v_dot2_f32_bf16 v17, v95, v81, v17
v_dot2_f32_bf16 v18, v96, v81, v18
v_dot2_f32_bf16 v19, v97, v81, v19
v_dot2_f32_bf16 v20, v90, v82, v20
v_dot2_f32_bf16 v21, v91, v82, v21
v_dot2_f32_bf16 v22, v92, v82, v22
v_dot2_f32_bf16 v23, v93, v82, v23
v_dot2_f32_bf16 v24, v94, v82, v24
v_dot2_f32_bf16 v25, v95, v82, v25
v_dot2_f32_bf16 v26, v96, v82, v26
v_dot2_f32_bf16 v27, v97, v82, v27
v_dot2_f32_bf16 v28, v90, v83, v28
v_dot2_f32_bf16 v29, v91, v83, v29
v_dot2_f32_bf16 v30, v92, v83, v30
v_dot2_f32_bf16 v31, v93, v83, v31
v_dot2_f32_bf16 v32, v94, v83, v32
v_dot2_f32_bf16 v33, v95, v83, v33
v_dot2_f32_bf16 v34, v96, v83, v34
v_dot2_f32_bf16 v35, v97, v83, v35
v_dot2_f32_bf16 v36, v90, v84, v36
v_dot2_f32_bf16 v37, v91, v84, v37
v_dot2_f32_bf16 v38, v92, v84, v38
v_dot2_f32_bf16 v39, v93, v84, v39
v_dot2_f32_bf16 v40, v94, v84, v40
v_dot2_f32_bf16 v41, v95, v84, v41
v_dot2_f32_bf16 v42, v96, v84, v42
v_dot2_f32_bf16 v43, v97, v84, v43
v_dot2_f32_bf16 v44, v90, v85, v44
v_dot2_f32_bf16 v45, v91, v85, v45
v_dot2_f32_bf16 v46, v92, v85, v46
v_dot2_f32_bf16 v47, v93, v85, v47
v_dot2_f32_bf16 v48, v94, v85, v48
v_dot2_f32_bf16 v49, v95, v85, v49
v_dot2_f32_bf16 v50, v96, v85, v50
v_dot2_f32_bf16 v51, v97, v85, v51
v_dot2_f32_bf16 v52, v90, v86, v52
v_dot2_f32_bf16 v53, v91, v86, v53
v_dot2_f32_bf16 v54, v92, v86, v54
v_dot2_f32_bf16 v55, v93, v86, v55
v_dot2_f32_bf16 v56, v94, v86, v56
v_dot2_f32_bf16 v57, v95, v86, v57
v_dot2_f32_bf16 v58, v96, v86, v58
v_dot2_f32_bf16 v59, v97, v86, v59
v_dot2_f32_bf16 v60, v90, v87, v60
v_dot2_f32_bf16 v61, v91, v87, v61
v_dot2_f32_bf16 v62, v92, v87, v62
v_dot2_f32_bf16 v63, v93, v87, v63
v_dot2_f32_bf16 v64, v94, v87, v64
v_dot2_f32_bf16 v65, v95, v87, v65
v_dot2_f32_bf16 v66, v96, v87, v66
v_dot2_f32_bf16 v67, v97, v87, v67
ds_read_b128 v[80:83], v223 offset:128
ds_read_b128 v[84:87], v223 offset:144
s_waitcnt vmcnt(8) lgkmcnt(0)
v_perm_b32 v90, v136, v132, s30
v_perm_b32 v91, v136, v132, s31
v_perm_b32 v92, v137, v133, s30
v_perm_b32 v93, v137, v133, s31
v_perm_b32 v94, v138, v134, s30
v_perm_b32 v95, v138, v134, s31
v_perm_b32 v96, v139, v135, s30
v_perm_b32 v97, v139, v135, s31
v_dot2_f32_bf16 v4, v90, v80, v4
v_dot2_f32_bf16 v5, v91, v80, v5
v_dot2_f32_bf16 v6, v92, v80, v6
v_dot2_f32_bf16 v7, v93, v80, v7
v_dot2_f32_bf16 v8, v94, v80, v8
v_dot2_f32_bf16 v9, v95, v80, v9
v_dot2_f32_bf16 v10, v96, v80, v10
v_dot2_f32_bf16 v11, v97, v80, v11
v_dot2_f32_bf16 v12, v90, v81, v12
v_dot2_f32_bf16 v13, v91, v81, v13
v_dot2_f32_bf16 v14, v92, v81, v14
v_dot2_f32_bf16 v15, v93, v81, v15
v_dot2_f32_bf16 v16, v94, v81, v16
v_dot2_f32_bf16 v17, v95, v81, v17
v_dot2_f32_bf16 v18, v96, v81, v18
v_dot2_f32_bf16 v19, v97, v81, v19
v_dot2_f32_bf16 v20, v90, v82, v20
v_dot2_f32_bf16 v21, v91, v82, v21
v_dot2_f32_bf16 v22, v92, v82, v22
v_dot2_f32_bf16 v23, v93, v82, v23
v_dot2_f32_bf16 v24, v94, v82, v24
v_dot2_f32_bf16 v25, v95, v82, v25
v_dot2_f32_bf16 v26, v96, v82, v26
v_dot2_f32_bf16 v27, v97, v82, v27
v_dot2_f32_bf16 v28, v90, v83, v28
v_dot2_f32_bf16 v29, v91, v83, v29
v_dot2_f32_bf16 v30, v92, v83, v30
v_dot2_f32_bf16 v31, v93, v83, v31
v_dot2_f32_bf16 v32, v94, v83, v32
v_dot2_f32_bf16 v33, v95, v83, v33
v_dot2_f32_bf16 v34, v96, v83, v34
v_dot2_f32_bf16 v35, v97, v83, v35
v_dot2_f32_bf16 v36, v90, v84, v36
v_dot2_f32_bf16 v37, v91, v84, v37
v_dot2_f32_bf16 v38, v92, v84, v38
v_dot2_f32_bf16 v39, v93, v84, v39
v_dot2_f32_bf16 v40, v94, v84, v40
v_dot2_f32_bf16 v41, v95, v84, v41
v_dot2_f32_bf16 v42, v96, v84, v42
v_dot2_f32_bf16 v43, v97, v84, v43
v_dot2_f32_bf16 v44, v90, v85, v44
v_dot2_f32_bf16 v45, v91, v85, v45
v_dot2_f32_bf16 v46, v92, v85, v46
v_dot2_f32_bf16 v47, v93, v85, v47
v_dot2_f32_bf16 v48, v94, v85, v48
v_dot2_f32_bf16 v49, v95, v85, v49
v_dot2_f32_bf16 v50, v96, v85, v50
v_dot2_f32_bf16 v51, v97, v85, v51
v_dot2_f32_bf16 v52, v90, v86, v52
v_dot2_f32_bf16 v53, v91, v86, v53
v_dot2_f32_bf16 v54, v92, v86, v54
v_dot2_f32_bf16 v55, v93, v86, v55
v_dot2_f32_bf16 v56, v94, v86, v56
v_dot2_f32_bf16 v57, v95, v86, v57
v_dot2_f32_bf16 v58, v96, v86, v58
v_dot2_f32_bf16 v59, v97, v86, v59
v_dot2_f32_bf16 v60, v90, v87, v60
v_dot2_f32_bf16 v61, v91, v87, v61
v_dot2_f32_bf16 v62, v92, v87, v62
v_dot2_f32_bf16 v63, v93, v87, v63
v_dot2_f32_bf16 v64, v94, v87, v64
v_dot2_f32_bf16 v65, v95, v87, v65
v_dot2_f32_bf16 v66, v96, v87, v66
v_dot2_f32_bf16 v67, v97, v87, v67
ds_read_b128 v[80:83], v223 offset:160
ds_read_b128 v[84:87], v223 offset:176
s_waitcnt vmcnt(6) lgkmcnt(0)
v_perm_b32 v90, v144, v140, s30
v_perm_b32 v91, v144, v140, s31
v_perm_b32 v92, v145, v141, s30
v_perm_b32 v93, v145, v141, s31
v_perm_b32 v94, v146, v142, s30
v_perm_b32 v95, v146, v142, s31
v_perm_b32 v96, v147, v143, s30
v_perm_b32 v97, v147, v143, s31
v_dot2_f32_bf16 v4, v90, v80, v4
v_dot2_f32_bf16 v5, v91, v80, v5
v_dot2_f32_bf16 v6, v92, v80, v6
v_dot2_f32_bf16 v7, v93, v80, v7
v_dot2_f32_bf16 v8, v94, v80, v8
v_dot2_f32_bf16 v9, v95, v80, v9
v_dot2_f32_bf16 v10, v96, v80, v10
v_dot2_f32_bf16 v11, v97, v80, v11
v_dot2_f32_bf16 v12, v90, v81, v12
v_dot2_f32_bf16 v13, v91, v81, v13
v_dot2_f32_bf16 v14, v92, v81, v14
v_dot2_f32_bf16 v15, v93, v81, v15
v_dot2_f32_bf16 v16, v94, v81, v16
v_dot2_f32_bf16 v17, v95, v81, v17
v_dot2_f32_bf16 v18, v96, v81, v18
v_dot2_f32_bf16 v19, v97, v81, v19
v_dot2_f32_bf16 v20, v90, v82, v20
v_dot2_f32_bf16 v21, v91, v82, v21
v_dot2_f32_bf16 v22, v92, v82, v22
v_dot2_f32_bf16 v23, v93, v82, v23
v_dot2_f32_bf16 v24, v94, v82, v24
v_dot2_f32_bf16 v25, v95, v82, v25
v_dot2_f32_bf16 v26, v96, v82, v26
v_dot2_f32_bf16 v27, v97, v82, v27
v_dot2_f32_bf16 v28, v90, v83, v28
v_dot2_f32_bf16 v29, v91, v83, v29
v_dot2_f32_bf16 v30, v92, v83, v30
v_dot2_f32_bf16 v31, v93, v83, v31
v_dot2_f32_bf16 v32, v94, v83, v32
v_dot2_f32_bf16 v33, v95, v83, v33
v_dot2_f32_bf16 v34, v96, v83, v34
v_dot2_f32_bf16 v35, v97, v83, v35
v_dot2_f32_bf16 v36, v90, v84, v36
v_dot2_f32_bf16 v37, v91, v84, v37
v_dot2_f32_bf16 v38, v92, v84, v38
v_dot2_f32_bf16 v39, v93, v84, v39
v_dot2_f32_bf16 v40, v94, v84, v40
v_dot2_f32_bf16 v41, v95, v84, v41
v_dot2_f32_bf16 v42, v96, v84, v42
v_dot2_f32_bf16 v43, v97, v84, v43
v_dot2_f32_bf16 v44, v90, v85, v44
v_dot2_f32_bf16 v45, v91, v85, v45
v_dot2_f32_bf16 v46, v92, v85, v46
v_dot2_f32_bf16 v47, v93, v85, v47
v_dot2_f32_bf16 v48, v94, v85, v48
v_dot2_f32_bf16 v49, v95, v85, v49
v_dot2_f32_bf16 v50, v96, v85, v50
v_dot2_f32_bf16 v51, v97, v85, v51
v_dot2_f32_bf16 v52, v90, v86, v52
v_dot2_f32_bf16 v53, v91, v86, v53
v_dot2_f32_bf16 v54, v92, v86, v54
v_dot2_f32_bf16 v55, v93, v86, v55
v_dot2_f32_bf16 v56, v94, v86, v56
v_dot2_f32_bf16 v57, v95, v86, v57
v_dot2_f32_bf16 v58, v96, v86, v58
v_dot2_f32_bf16 v59, v97, v86, v59
v_dot2_f32_bf16 v60, v90, v87, v60
v_dot2_f32_bf16 v61, v91, v87, v61
v_dot2_f32_bf16 v62, v92, v87, v62
v_dot2_f32_bf16 v63, v93, v87, v63
v_dot2_f32_bf16 v64, v94, v87, v64
v_dot2_f32_bf16 v65, v95, v87, v65
v_dot2_f32_bf16 v66, v96, v87, v66
v_dot2_f32_bf16 v67, v97, v87, v67
ds_read_b128 v[80:83], v223 offset:192
ds_read_b128 v[84:87], v223 offset:208
s_waitcnt vmcnt(4) lgkmcnt(0)
v_perm_b32 v90, v152, v148, s30
v_perm_b32 v91, v152, v148, s31
v_perm_b32 v92, v153, v149, s30
v_perm_b32 v93, v153, v149, s31
v_perm_b32 v94, v154, v150, s30
v_perm_b32 v95, v154, v150, s31
v_perm_b32 v96, v155, v151, s30
v_perm_b32 v97, v155, v151, s31
v_dot2_f32_bf16 v4, v90, v80, v4
v_dot2_f32_bf16 v5, v91, v80, v5
v_dot2_f32_bf16 v6, v92, v80, v6
v_dot2_f32_bf16 v7, v93, v80, v7
v_dot2_f32_bf16 v8, v94, v80, v8
v_dot2_f32_bf16 v9, v95, v80, v9
v_dot2_f32_bf16 v10, v96, v80, v10
v_dot2_f32_bf16 v11, v97, v80, v11
v_dot2_f32_bf16 v12, v90, v81, v12
v_dot2_f32_bf16 v13, v91, v81, v13
v_dot2_f32_bf16 v14, v92, v81, v14
v_dot2_f32_bf16 v15, v93, v81, v15
v_dot2_f32_bf16 v16, v94, v81, v16
v_dot2_f32_bf16 v17, v95, v81, v17
v_dot2_f32_bf16 v18, v96, v81, v18
v_dot2_f32_bf16 v19, v97, v81, v19
v_dot2_f32_bf16 v20, v90, v82, v20
v_dot2_f32_bf16 v21, v91, v82, v21
v_dot2_f32_bf16 v22, v92, v82, v22
v_dot2_f32_bf16 v23, v93, v82, v23
v_dot2_f32_bf16 v24, v94, v82, v24
v_dot2_f32_bf16 v25, v95, v82, v25
v_dot2_f32_bf16 v26, v96, v82, v26
v_dot2_f32_bf16 v27, v97, v82, v27
v_dot2_f32_bf16 v28, v90, v83, v28
v_dot2_f32_bf16 v29, v91, v83, v29
v_dot2_f32_bf16 v30, v92, v83, v30
v_dot2_f32_bf16 v31, v93, v83, v31
v_dot2_f32_bf16 v32, v94, v83, v32
v_dot2_f32_bf16 v33, v95, v83, v33
v_dot2_f32_bf16 v34, v96, v83, v34
v_dot2_f32_bf16 v35, v97, v83, v35
v_dot2_f32_bf16 v36, v90, v84, v36
v_dot2_f32_bf16 v37, v91, v84, v37
v_dot2_f32_bf16 v38, v92, v84, v38
v_dot2_f32_bf16 v39, v93, v84, v39
v_dot2_f32_bf16 v40, v94, v84, v40
v_dot2_f32_bf16 v41, v95, v84, v41
v_dot2_f32_bf16 v42, v96, v84, v42
v_dot2_f32_bf16 v43, v97, v84, v43
v_dot2_f32_bf16 v44, v90, v85, v44
v_dot2_f32_bf16 v45, v91, v85, v45
v_dot2_f32_bf16 v46, v92, v85, v46
v_dot2_f32_bf16 v47, v93, v85, v47
v_dot2_f32_bf16 v48, v94, v85, v48
v_dot2_f32_bf16 v49, v95, v85, v49
v_dot2_f32_bf16 v50, v96, v85, v50
v_dot2_f32_bf16 v51, v97, v85, v51
v_dot2_f32_bf16 v52, v90, v86, v52
v_dot2_f32_bf16 v53, v91, v86, v53
v_dot2_f32_bf16 v54, v92, v86, v54
v_dot2_f32_bf16 v55, v93, v86, v55
v_dot2_f32_bf16 v56, v94, v86, v56
v_dot2_f32_bf16 v57, v95, v86, v57
v_dot2_f32_bf16 v58, v96, v86, v58
v_dot2_f32_bf16 v59, v97, v86, v59
v_dot2_f32_bf16 v60, v90, v87, v60
v_dot2_f32_bf16 v61, v91, v87, v61
v_dot2_f32_bf16 v62, v92, v87, v62
v_dot2_f32_bf16 v63, v93, v87, v63
v_dot2_f32_bf16 v64, v94, v87, v64
v_dot2_f32_bf16 v65, v95, v87, v65
v_dot2_f32_bf16 v66, v96, v87, v66
v_dot2_f32_bf16 v67, v97, v87, v67
ds_read_b128 v[80:83], v223 offset:224
ds_read_b128 v[84:87], v223 offset:240
s_waitcnt vmcnt(2) lgkmcnt(0)
v_perm_b32 v90, v160, v156, s30
v_perm_b32 v91, v160, v156, s31
v_perm_b32 v92, v161, v157, s30
v_perm_b32 v93, v161, v157, s31
v_perm_b32 v94, v162, v158, s30
v_perm_b32 v95, v162, v158, s31
v_perm_b32 v96, v163, v159, s30
v_perm_b32 v97, v163, v159, s31
v_dot2_f32_bf16 v4, v90, v80, v4
v_dot2_f32_bf16 v5, v91, v80, v5
v_dot2_f32_bf16 v6, v92, v80, v6
v_dot2_f32_bf16 v7, v93, v80, v7
v_dot2_f32_bf16 v8, v94, v80, v8
v_dot2_f32_bf16 v9, v95, v80, v9
v_dot2_f32_bf16 v10, v96, v80, v10
v_dot2_f32_bf16 v11, v97, v80, v11
v_dot2_f32_bf16 v12, v90, v81, v12
v_dot2_f32_bf16 v13, v91, v81, v13
v_dot2_f32_bf16 v14, v92, v81, v14
v_dot2_f32_bf16 v15, v93, v81, v15
v_dot2_f32_bf16 v16, v94, v81, v16
v_dot2_f32_bf16 v17, v95, v81, v17
v_dot2_f32_bf16 v18, v96, v81, v18
v_dot2_f32_bf16 v19, v97, v81, v19
v_dot2_f32_bf16 v20, v90, v82, v20
v_dot2_f32_bf16 v21, v91, v82, v21
v_dot2_f32_bf16 v22, v92, v82, v22
v_dot2_f32_bf16 v23, v93, v82, v23
v_dot2_f32_bf16 v24, v94, v82, v24
v_dot2_f32_bf16 v25, v95, v82, v25
v_dot2_f32_bf16 v26, v96, v82, v26
v_dot2_f32_bf16 v27, v97, v82, v27
v_dot2_f32_bf16 v28, v90, v83, v28
v_dot2_f32_bf16 v29, v91, v83, v29
v_dot2_f32_bf16 v30, v92, v83, v30
v_dot2_f32_bf16 v31, v93, v83, v31
v_dot2_f32_bf16 v32, v94, v83, v32
v_dot2_f32_bf16 v33, v95, v83, v33
v_dot2_f32_bf16 v34, v96, v83, v34
v_dot2_f32_bf16 v35, v97, v83, v35
v_dot2_f32_bf16 v36, v90, v84, v36
v_dot2_f32_bf16 v37, v91, v84, v37
v_dot2_f32_bf16 v38, v92, v84, v38
v_dot2_f32_bf16 v39, v93, v84, v39
v_dot2_f32_bf16 v40, v94, v84, v40
v_dot2_f32_bf16 v41, v95, v84, v41
v_dot2_f32_bf16 v42, v96, v84, v42
v_dot2_f32_bf16 v43, v97, v84, v43
v_dot2_f32_bf16 v44, v90, v85, v44
v_dot2_f32_bf16 v45, v91, v85, v45
v_dot2_f32_bf16 v46, v92, v85, v46
v_dot2_f32_bf16 v47, v93, v85, v47
v_dot2_f32_bf16 v48, v94, v85, v48
v_dot2_f32_bf16 v49, v95, v85, v49
v_dot2_f32_bf16 v50, v96, v85, v50
v_dot2_f32_bf16 v51, v97, v85, v51
v_dot2_f32_bf16 v52, v90, v86, v52
v_dot2_f32_bf16 v53, v91, v86, v53
v_dot2_f32_bf16 v54, v92, v86, v54
v_dot2_f32_bf16 v55, v93, v86, v55
v_dot2_f32_bf16 v56, v94, v86, v56
v_dot2_f32_bf16 v57, v95, v86, v57
v_dot2_f32_bf16 v58, v96, v86, v58
v_dot2_f32_bf16 v59, v97, v86, v59
v_dot2_f32_bf16 v60, v90, v87, v60
v_dot2_f32_bf16 v61, v91, v87, v61
v_dot2_f32_bf16 v62, v92, v87, v62
v_dot2_f32_bf16 v63, v93, v87, v63
v_dot2_f32_bf16 v64, v94, v87, v64
v_dot2_f32_bf16 v65, v95, v87, v65
v_dot2_f32_bf16 v66, v96, v87, v66
v_dot2_f32_bf16 v67, v97, v87, v67
ds_read_b128 v[80:83], v223 offset:256
ds_read_b128 v[84:87], v223 offset:272
s_waitcnt vmcnt(0) lgkmcnt(0)
v_perm_b32 v90, v168, v164, s30
v_perm_b32 v91, v168, v164, s31
v_perm_b32 v92, v169, v165, s30
v_perm_b32 v93, v169, v165, s31
v_perm_b32 v94, v170, v166, s30
v_perm_b32 v95, v170, v166, s31
v_perm_b32 v96, v171, v167, s30
v_perm_b32 v97, v171, v167, s31
v_dot2_f32_bf16 v4, v90, v80, v4
v_dot2_f32_bf16 v5, v91, v80, v5
v_dot2_f32_bf16 v6, v92, v80, v6
v_dot2_f32_bf16 v7, v93, v80, v7
v_dot2_f32_bf16 v8, v94, v80, v8
v_dot2_f32_bf16 v9, v95, v80, v9
v_dot2_f32_bf16 v10, v96, v80, v10
v_dot2_f32_bf16 v11, v97, v80, v11
v_dot2_f32_bf16 v12, v90, v81, v12
v_dot2_f32_bf16 v13, v91, v81, v13
v_dot2_f32_bf16 v14, v92, v81, v14
v_dot2_f32_bf16 v15, v93, v81, v15
v_dot2_f32_bf16 v16, v94, v81, v16
v_dot2_f32_bf16 v17, v95, v81, v17
v_dot2_f32_bf16 v18, v96, v81, v18
v_dot2_f32_bf16 v19, v97, v81, v19
v_dot2_f32_bf16 v20, v90, v82, v20
v_dot2_f32_bf16 v21, v91, v82, v21
v_dot2_f32_bf16 v22, v92, v82, v22
v_dot2_f32_bf16 v23, v93, v82, v23
v_dot2_f32_bf16 v24, v94, v82, v24
v_dot2_f32_bf16 v25, v95, v82, v25
v_dot2_f32_bf16 v26, v96, v82, v26
v_dot2_f32_bf16 v27, v97, v82, v27
v_dot2_f32_bf16 v28, v90, v83, v28
v_dot2_f32_bf16 v29, v91, v83, v29
v_dot2_f32_bf16 v30, v92, v83, v30
v_dot2_f32_bf16 v31, v93, v83, v31
v_dot2_f32_bf16 v32, v94, v83, v32
v_dot2_f32_bf16 v33, v95, v83, v33
v_dot2_f32_bf16 v34, v96, v83, v34
v_dot2_f32_bf16 v35, v97, v83, v35
v_dot2_f32_bf16 v36, v90, v84, v36
v_dot2_f32_bf16 v37, v91, v84, v37
v_dot2_f32_bf16 v38, v92, v84, v38
v_dot2_f32_bf16 v39, v93, v84, v39
v_dot2_f32_bf16 v40, v94, v84, v40
v_dot2_f32_bf16 v41, v95, v84, v41
v_dot2_f32_bf16 v42, v96, v84, v42
v_dot2_f32_bf16 v43, v97, v84, v43
v_dot2_f32_bf16 v44, v90, v85, v44
v_dot2_f32_bf16 v45, v91, v85, v45
v_dot2_f32_bf16 v46, v92, v85, v46
v_dot2_f32_bf16 v47, v93, v85, v47
v_dot2_f32_bf16 v48, v94, v85, v48
v_dot2_f32_bf16 v49, v95, v85, v49
v_dot2_f32_bf16 v50, v96, v85, v50
v_dot2_f32_bf16 v51, v97, v85, v51
v_dot2_f32_bf16 v52, v90, v86, v52
v_dot2_f32_bf16 v53, v91, v86, v53
v_dot2_f32_bf16 v54, v92, v86, v54
v_dot2_f32_bf16 v55, v93, v86, v55
v_dot2_f32_bf16 v56, v94, v86, v56
v_dot2_f32_bf16 v57, v95, v86, v57
v_dot2_f32_bf16 v58, v96, v86, v58
v_dot2_f32_bf16 v59, v97, v86, v59
v_dot2_f32_bf16 v60, v90, v87, v60
v_dot2_f32_bf16 v61, v91, v87, v61
v_dot2_f32_bf16 v62, v92, v87, v62
v_dot2_f32_bf16 v63, v93, v87, v63
v_dot2_f32_bf16 v64, v94, v87, v64
v_dot2_f32_bf16 v65, v95, v87, v65
v_dot2_f32_bf16 v66, v96, v87, v66
v_dot2_f32_bf16 v67, v97, v87, v67
s_nop 4
v_lshlrev_b32 v225, 11, v221
v_lshl_add_u32 v225, v220, 5, v225
s_barrier
ds_write_b128 v225, v[4:7] offset:16384
ds_write_b128 v225, v[8:11] offset:16400
ds_write_b128 v225, v[12:15] offset:16640
ds_write_b128 v225, v[16:19] offset:16656
ds_write_b128 v225, v[20:23] offset:16896
ds_write_b128 v225, v[24:27] offset:16912
ds_write_b128 v225, v[28:31] offset:17152
ds_write_b128 v225, v[32:35] offset:17168
ds_write_b128 v225, v[36:39] offset:17408
ds_write_b128 v225, v[40:43] offset:17424
ds_write_b128 v225, v[44:47] offset:17664
ds_write_b128 v225, v[48:51] offset:17680
ds_write_b128 v225, v[52:55] offset:17920
ds_write_b128 v225, v[56:59] offset:17936
ds_write_b128 v225, v[60:63] offset:18176
ds_write_b128 v225, v[64:67] offset:18192
s_waitcnt lgkmcnt(0)
s_barrier
v_lshlrev_b32 v226, 3, v0
v_add_u32 v226, 16384, v226
ds_read_b64 v[4:5], v226 offset:0
ds_read_b64 v[6:7], v226 offset:2048
ds_read_b64 v[8:9], v226 offset:4096
ds_read_b64 v[10:11], v226 offset:6144
ds_read_b64 v[12:13], v226 offset:8192
ds_read_b64 v[14:15], v226 offset:10240
ds_read_b64 v[16:17], v226 offset:12288
ds_read_b64 v[18:19], v226 offset:14336
ds_read_b64 v[20:21], v226 offset:16384
ds_read_b64 v[22:23], v226 offset:18432
ds_read_b64 v[24:25], v226 offset:20480
ds_read_b64 v[26:27], v226 offset:22528
ds_read_b64 v[28:29], v226 offset:24576
ds_read_b64 v[30:31], v226 offset:26624
ds_read_b64 v[32:33], v226 offset:28672
ds_read_b64 v[34:35], v226 offset:30720
ds_read_b64 v[36:37], v226 offset:32768
ds_read_b64 v[38:39], v226 offset:34816
ds_read_b64 v[40:41], v226 offset:36864
ds_read_b64 v[42:43], v226 offset:38912
ds_read_b64 v[44:45], v226 offset:40960
ds_read_b64 v[46:47], v226 offset:43008
ds_read_b64 v[48:49], v226 offset:45056
ds_read_b64 v[50:51], v226 offset:47104
ds_read_b64 v[52:53], v226 offset:49152
ds_read_b64 v[54:55], v226 offset:51200
ds_read_b64 v[56:57], v226 offset:53248
ds_read_b64 v[58:59], v226 offset:55296
ds_read_b64 v[60:61], v226 offset:57344
ds_read_b64 v[62:63], v226 offset:59392
ds_read_b64 v[64:65], v226 offset:61440
ds_read_b64 v[66:67], v226 offset:63488
s_waitcnt lgkmcnt(0)
v_mov_b32 v212, 0
v_mov_b32 v213, 0
v_add_f32 v212, v212, v4
v_add_f32 v213, v213, v5
v_add_f32 v212, v212, v6
v_add_f32 v213, v213, v7
v_add_f32 v212, v212, v8
v_add_f32 v213, v213, v9
v_add_f32 v212, v212, v10
v_add_f32 v213, v213, v11
v_add_f32 v212, v212, v12
v_add_f32 v213, v213, v13
v_add_f32 v212, v212, v14
v_add_f32 v213, v213, v15
v_add_f32 v212, v212, v16
v_add_f32 v213, v213, v17
v_add_f32 v212, v212, v18
v_add_f32 v213, v213, v19
v_add_f32 v212, v212, v20
v_add_f32 v213, v213, v21
v_add_f32 v212, v212, v22
v_add_f32 v213, v213, v23
v_add_f32 v212, v212, v24
v_add_f32 v213, v213, v25
v_add_f32 v212, v212, v26
v_add_f32 v213, v213, v27
v_add_f32 v212, v212, v28
v_add_f32 v213, v213, v29
v_add_f32 v212, v212, v30
v_add_f32 v213, v213, v31
v_add_f32 v212, v212, v32
v_add_f32 v213, v213, v33
v_add_f32 v212, v212, v34
v_add_f32 v213, v213, v35
v_add_f32 v212, v212, v36
v_add_f32 v213, v213, v37
v_add_f32 v212, v212, v38
v_add_f32 v213, v213, v39
v_add_f32 v212, v212, v40
v_add_f32 v213, v213, v41
v_add_f32 v212, v212, v42
v_add_f32 v213, v213, v43
v_add_f32 v212, v212, v44
v_add_f32 v213, v213, v45
v_add_f32 v212, v212, v46
v_add_f32 v213, v213, v47
v_add_f32 v212, v212, v48
v_add_f32 v213, v213, v49
v_add_f32 v212, v212, v50
v_add_f32 v213, v213, v51
v_add_f32 v212, v212, v52
v_add_f32 v213, v213, v53
v_add_f32 v212, v212, v54
v_add_f32 v213, v213, v55
v_add_f32 v212, v212, v56
v_add_f32 v213, v213, v57
v_add_f32 v212, v212, v58
v_add_f32 v213, v213, v59
v_add_f32 v212, v212, v60
v_add_f32 v213, v213, v61
v_add_f32 v212, v212, v62
v_add_f32 v213, v213, v63
v_add_f32 v212, v212, v64
v_add_f32 v213, v213, v65
v_add_f32 v212, v212, v66
v_add_f32 v213, v213, v67
v_cvt_pk_bf16_f32 v209, v210, v210
v_lshlrev_b32 v210, 16, v209
v_cvt_pk_bf16_f32 v209, v211, v211
v_lshlrev_b32 v211, 16, v209
v_cvt_pk_bf16_f32 v209, v212, v212
v_lshlrev_b32 v212, 16, v209
v_cvt_pk_bf16_f32 v209, v213, v213
v_lshlrev_b32 v213, 16, v209
v_mul_f32 v214, v210, v210
v_mul_f32 v214, 0x3d372713, v214
v_add_f32 v214, 1.0, v214
v_mul_f32 v214, v214, v210
v_mul_f32 v214, 0x40135761, v214
v_exp_f32 v214, v214
s_nop 0
v_add_f32 v214, 1.0, v214
v_rcp_f32 v214, v214
s_nop 0
v_sub_f32 v214, 1.0, v214
v_mul_f32 v210, v210, v214
v_cvt_pk_bf16_f32 v209, v210, v210
v_lshlrev_b32 v210, 16, v209
v_mul_f32 v210, v210, v212
v_mul_f32 v214, v211, v211
v_mul_f32 v214, 0x3d372713, v214
v_add_f32 v214, 1.0, v214
v_mul_f32 v214, v214, v211
v_mul_f32 v214, 0x40135761, v214
v_exp_f32 v214, v214
s_nop 0
v_add_f32 v214, 1.0, v214
v_rcp_f32 v214, v214
s_nop 0
v_sub_f32 v214, 1.0, v214
v_mul_f32 v211, v211, v214
v_cvt_pk_bf16_f32 v209, v211, v211
v_lshlrev_b32 v211, 16, v209
v_mul_f32 v211, v211, v213
v_cvt_pk_bf16_f32 v210, v210, v211
v_mul_u32_u24 v204, 9216, v200
v_lshl_add_u32 v204, v201, 2, v204
s_lshl_b32 s28, s2, 7
s_add_u32 s28, s28, 1179648
buffer_store_dword v210, v204, s[24:27], s28 offen
k5_kernel_end:
s_endpgm
.globl k6_kernel
.p2align 8
.type k6_kernel,@function
k6_kernel:
s_cmp_ge_u32 s2, 81
s_cbranch_scc1 k6_kernel_end
s_load_dwordx2 s[8:9], s[0:1], 64
s_mov_b32 s10, 5308416
s_mov_b32 s11, 0x00020000
s_load_dwordx2 s[24:25], s[0:1], 104
s_mov_b32 s26, 2097152
s_mov_b32 s27, 0x00020000
s_load_dwordx2 s[20:21], s[0:1], 96
s_mov_b32 s22, 256
s_mov_b32 s23, 0x00020000
s_load_dwordx2 s[16:17], s[0:1], 88
s_mov_b32 s18, 9216
s_mov_b32 s19, 0x00020000
s_waitcnt lgkmcnt(0)
s_mul_hi_u32 s4, s2, 477218589
s_mul_i32 s5, s4, 9
s_sub_u32 s5, s2, s5
s_lshl_b32 s6, s4, 9
v_and_b32 v220, 7, v0
v_lshrrev_b32 v221, 3, v0
v_mul_u32_u24 v222, 18432, v221
v_lshl_add_u32 v222, v220, 4, v222
s_mul_i32 s29, s6, 1152
s_lshl_b32 s28, s5, 7
s_add_u32 s29, s29, s28
v_add_u32 v224, 0, v222
buffer_load_dwordx4 v[100:103], v224, s[8:11], s29 offen
v_add_u32 v224, 1152, v222
buffer_load_dwordx4 v[104:107], v224, s[8:11], s29 offen
v_add_u32 v224, 2304, v222
buffer_load_dwordx4 v[108:111], v224, s[8:11], s29 offen
v_add_u32 v224, 3456, v222
buffer_load_dwordx4 v[112:115], v224, s[8:11], s29 offen
v_add_u32 v224, 4608, v222
buffer_load_dwordx4 v[116:119], v224, s[8:11], s29 offen
v_add_u32 v224, 5760, v222
buffer_load_dwordx4 v[120:123], v224, s[8:11], s29 offen
v_add_u32 v224, 6912, v222
buffer_load_dwordx4 v[124:127], v224, s[8:11], s29 offen
v_add_u32 v224, 8064, v222
buffer_load_dwordx4 v[128:131], v224, s[8:11], s29 offen
v_add_u32 v224, 9216, v222
buffer_load_dwordx4 v[132:135], v224, s[8:11], s29 offen
v_add_u32 v224, 10368, v222
buffer_load_dwordx4 v[136:139], v224, s[8:11], s29 offen
v_add_u32 v224, 11520, v222
buffer_load_dwordx4 v[140:143], v224, s[8:11], s29 offen
v_add_u32 v224, 12672, v222
buffer_load_dwordx4 v[144:147], v224, s[8:11], s29 offen
v_add_u32 v224, 13824, v222
buffer_load_dwordx4 v[148:151], v224, s[8:11], s29 offen
v_add_u32 v224, 14976, v222
buffer_load_dwordx4 v[152:155], v224, s[8:11], s29 offen
v_add_u32 v224, 16128, v222
buffer_load_dwordx4 v[156:159], v224, s[8:11], s29 offen
v_add_u32 v224, 17280, v222
buffer_load_dwordx4 v[160:163], v224, s[8:11], s29 offen
v_lshrrev_b32 v200, 5, v0
v_and_b32 v201, 31, v0
v_mul_u32_u24 v204, 9216, v200
v_lshl_add_u32 v204, v201, 4, v204
s_lshl_b32 s28, s4, 10
s_add_u32 s28, s28, 1179648
buffer_load_dwordx4 v[4:7], v204, s[24:27], s28 offen
buffer_load_dwordx4 v[8:11], v204, s[24:27], s28 offen offset:512
v_lshlrev_b32 v207, 7, v201
v_lshl_add_u32 v207, v200, 2, v207
s_waitcnt vmcnt(0)
ds_write_b32 v207, v4 offset:0
ds_write_b32 v207, v8 offset:4096
ds_write_b32 v207, v5 offset:32
ds_write_b32 v207, v9 offset:4128
ds_write_b32 v207, v6 offset:64
ds_write_b32 v207, v10 offset:4160
ds_write_b32 v207, v7 offset:96
ds_write_b32 v207, v11 offset:4192
s_waitcnt lgkmcnt(0)
s_barrier
s_mov_b32 s30, 0x05040100
s_mov_b32 s31, 0x07060302
v_mul_u32_u24 v223, 256, v221
v_mov_b32 v4, 0
v_mov_b32 v5, 0
v_mov_b32 v6, 0
v_mov_b32 v7, 0
v_mov_b32 v8, 0
v_mov_b32 v9, 0
v_mov_b32 v10, 0
v_mov_b32 v11, 0
v_mov_b32 v12, 0
v_mov_b32 v13, 0
v_mov_b32 v14, 0
v_mov_b32 v15, 0
v_mov_b32 v16, 0
v_mov_b32 v17, 0
v_mov_b32 v18, 0
v_mov_b32 v19, 0
v_mov_b32 v20, 0
v_mov_b32 v21, 0
v_mov_b32 v22, 0
v_mov_b32 v23, 0
v_mov_b32 v24, 0
v_mov_b32 v25, 0
v_mov_b32 v26, 0
v_mov_b32 v27, 0
v_mov_b32 v28, 0
v_mov_b32 v29, 0
v_mov_b32 v30, 0
v_mov_b32 v31, 0
v_mov_b32 v32, 0
v_mov_b32 v33, 0
v_mov_b32 v34, 0
v_mov_b32 v35, 0
v_mov_b32 v36, 0
v_mov_b32 v37, 0
v_mov_b32 v38, 0
v_mov_b32 v39, 0
v_mov_b32 v40, 0
v_mov_b32 v41, 0
v_mov_b32 v42, 0
v_mov_b32 v43, 0
v_mov_b32 v44, 0
v_mov_b32 v45, 0
v_mov_b32 v46, 0
v_mov_b32 v47, 0
v_mov_b32 v48, 0
v_mov_b32 v49, 0
v_mov_b32 v50, 0
v_mov_b32 v51, 0
v_mov_b32 v52, 0
v_mov_b32 v53, 0
v_mov_b32 v54, 0
v_mov_b32 v55, 0
v_mov_b32 v56, 0
v_mov_b32 v57, 0
v_mov_b32 v58, 0
v_mov_b32 v59, 0
v_mov_b32 v60, 0
v_mov_b32 v61, 0
v_mov_b32 v62, 0
v_mov_b32 v63, 0
v_mov_b32 v64, 0
v_mov_b32 v65, 0
v_mov_b32 v66, 0
v_mov_b32 v67, 0
ds_read_b128 v[80:83], v223 offset:0
ds_read_b128 v[84:87], v223 offset:16
s_waitcnt vmcnt(14) lgkmcnt(0)
v_perm_b32 v90, v104, v100, s30
v_perm_b32 v91, v104, v100, s31
v_perm_b32 v92, v105, v101, s30
v_perm_b32 v93, v105, v101, s31
v_perm_b32 v94, v106, v102, s30
v_perm_b32 v95, v106, v102, s31
v_perm_b32 v96, v107, v103, s30
v_perm_b32 v97, v107, v103, s31
v_dot2_f32_bf16 v4, v90, v80, v4
v_dot2_f32_bf16 v5, v91, v80, v5
v_dot2_f32_bf16 v6, v92, v80, v6
v_dot2_f32_bf16 v7, v93, v80, v7
v_dot2_f32_bf16 v8, v94, v80, v8
v_dot2_f32_bf16 v9, v95, v80, v9
v_dot2_f32_bf16 v10, v96, v80, v10
v_dot2_f32_bf16 v11, v97, v80, v11
v_dot2_f32_bf16 v12, v90, v81, v12
v_dot2_f32_bf16 v13, v91, v81, v13
v_dot2_f32_bf16 v14, v92, v81, v14
v_dot2_f32_bf16 v15, v93, v81, v15
v_dot2_f32_bf16 v16, v94, v81, v16
v_dot2_f32_bf16 v17, v95, v81, v17
v_dot2_f32_bf16 v18, v96, v81, v18
v_dot2_f32_bf16 v19, v97, v81, v19
v_dot2_f32_bf16 v20, v90, v82, v20
v_dot2_f32_bf16 v21, v91, v82, v21
v_dot2_f32_bf16 v22, v92, v82, v22
v_dot2_f32_bf16 v23, v93, v82, v23
v_dot2_f32_bf16 v24, v94, v82, v24
v_dot2_f32_bf16 v25, v95, v82, v25
v_dot2_f32_bf16 v26, v96, v82, v26
v_dot2_f32_bf16 v27, v97, v82, v27
v_dot2_f32_bf16 v28, v90, v83, v28
v_dot2_f32_bf16 v29, v91, v83, v29
v_dot2_f32_bf16 v30, v92, v83, v30
v_dot2_f32_bf16 v31, v93, v83, v31
v_dot2_f32_bf16 v32, v94, v83, v32
v_dot2_f32_bf16 v33, v95, v83, v33
v_dot2_f32_bf16 v34, v96, v83, v34
v_dot2_f32_bf16 v35, v97, v83, v35
v_dot2_f32_bf16 v36, v90, v84, v36
v_dot2_f32_bf16 v37, v91, v84, v37
v_dot2_f32_bf16 v38, v92, v84, v38
v_dot2_f32_bf16 v39, v93, v84, v39
v_dot2_f32_bf16 v40, v94, v84, v40
v_dot2_f32_bf16 v41, v95, v84, v41
v_dot2_f32_bf16 v42, v96, v84, v42
v_dot2_f32_bf16 v43, v97, v84, v43
v_dot2_f32_bf16 v44, v90, v85, v44
v_dot2_f32_bf16 v45, v91, v85, v45
v_dot2_f32_bf16 v46, v92, v85, v46
v_dot2_f32_bf16 v47, v93, v85, v47
v_dot2_f32_bf16 v48, v94, v85, v48
v_dot2_f32_bf16 v49, v95, v85, v49
v_dot2_f32_bf16 v50, v96, v85, v50
v_dot2_f32_bf16 v51, v97, v85, v51
v_dot2_f32_bf16 v52, v90, v86, v52
v_dot2_f32_bf16 v53, v91, v86, v53
v_dot2_f32_bf16 v54, v92, v86, v54
v_dot2_f32_bf16 v55, v93, v86, v55
v_dot2_f32_bf16 v56, v94, v86, v56
v_dot2_f32_bf16 v57, v95, v86, v57
v_dot2_f32_bf16 v58, v96, v86, v58
v_dot2_f32_bf16 v59, v97, v86, v59
v_dot2_f32_bf16 v60, v90, v87, v60
v_dot2_f32_bf16 v61, v91, v87, v61
v_dot2_f32_bf16 v62, v92, v87, v62
v_dot2_f32_bf16 v63, v93, v87, v63
v_dot2_f32_bf16 v64, v94, v87, v64
v_dot2_f32_bf16 v65, v95, v87, v65
v_dot2_f32_bf16 v66, v96, v87, v66
v_dot2_f32_bf16 v67, v97, v87, v67
ds_read_b128 v[80:83], v223 offset:32
ds_read_b128 v[84:87], v223 offset:48
s_waitcnt vmcnt(12) lgkmcnt(0)
v_perm_b32 v90, v112, v108, s30
v_perm_b32 v91, v112, v108, s31
v_perm_b32 v92, v113, v109, s30
v_perm_b32 v93, v113, v109, s31
v_perm_b32 v94, v114, v110, s30
v_perm_b32 v95, v114, v110, s31
v_perm_b32 v96, v115, v111, s30
v_perm_b32 v97, v115, v111, s31
v_dot2_f32_bf16 v4, v90, v80, v4
v_dot2_f32_bf16 v5, v91, v80, v5
v_dot2_f32_bf16 v6, v92, v80, v6
v_dot2_f32_bf16 v7, v93, v80, v7
v_dot2_f32_bf16 v8, v94, v80, v8
v_dot2_f32_bf16 v9, v95, v80, v9
v_dot2_f32_bf16 v10, v96, v80, v10
v_dot2_f32_bf16 v11, v97, v80, v11
v_dot2_f32_bf16 v12, v90, v81, v12
v_dot2_f32_bf16 v13, v91, v81, v13
v_dot2_f32_bf16 v14, v92, v81, v14
v_dot2_f32_bf16 v15, v93, v81, v15
v_dot2_f32_bf16 v16, v94, v81, v16
v_dot2_f32_bf16 v17, v95, v81, v17
v_dot2_f32_bf16 v18, v96, v81, v18
v_dot2_f32_bf16 v19, v97, v81, v19
v_dot2_f32_bf16 v20, v90, v82, v20
v_dot2_f32_bf16 v21, v91, v82, v21
v_dot2_f32_bf16 v22, v92, v82, v22
v_dot2_f32_bf16 v23, v93, v82, v23
v_dot2_f32_bf16 v24, v94, v82, v24
v_dot2_f32_bf16 v25, v95, v82, v25
v_dot2_f32_bf16 v26, v96, v82, v26
v_dot2_f32_bf16 v27, v97, v82, v27
v_dot2_f32_bf16 v28, v90, v83, v28
v_dot2_f32_bf16 v29, v91, v83, v29
v_dot2_f32_bf16 v30, v92, v83, v30
v_dot2_f32_bf16 v31, v93, v83, v31
v_dot2_f32_bf16 v32, v94, v83, v32
v_dot2_f32_bf16 v33, v95, v83, v33
v_dot2_f32_bf16 v34, v96, v83, v34
v_dot2_f32_bf16 v35, v97, v83, v35
v_dot2_f32_bf16 v36, v90, v84, v36
v_dot2_f32_bf16 v37, v91, v84, v37
v_dot2_f32_bf16 v38, v92, v84, v38
v_dot2_f32_bf16 v39, v93, v84, v39
v_dot2_f32_bf16 v40, v94, v84, v40
v_dot2_f32_bf16 v41, v95, v84, v41
v_dot2_f32_bf16 v42, v96, v84, v42
v_dot2_f32_bf16 v43, v97, v84, v43
v_dot2_f32_bf16 v44, v90, v85, v44
v_dot2_f32_bf16 v45, v91, v85, v45
v_dot2_f32_bf16 v46, v92, v85, v46
v_dot2_f32_bf16 v47, v93, v85, v47
v_dot2_f32_bf16 v48, v94, v85, v48
v_dot2_f32_bf16 v49, v95, v85, v49
v_dot2_f32_bf16 v50, v96, v85, v50
v_dot2_f32_bf16 v51, v97, v85, v51
v_dot2_f32_bf16 v52, v90, v86, v52
v_dot2_f32_bf16 v53, v91, v86, v53
v_dot2_f32_bf16 v54, v92, v86, v54
v_dot2_f32_bf16 v55, v93, v86, v55
v_dot2_f32_bf16 v56, v94, v86, v56
v_dot2_f32_bf16 v57, v95, v86, v57
v_dot2_f32_bf16 v58, v96, v86, v58
v_dot2_f32_bf16 v59, v97, v86, v59
v_dot2_f32_bf16 v60, v90, v87, v60
v_dot2_f32_bf16 v61, v91, v87, v61
v_dot2_f32_bf16 v62, v92, v87, v62
v_dot2_f32_bf16 v63, v93, v87, v63
v_dot2_f32_bf16 v64, v94, v87, v64
v_dot2_f32_bf16 v65, v95, v87, v65
v_dot2_f32_bf16 v66, v96, v87, v66
v_dot2_f32_bf16 v67, v97, v87, v67
ds_read_b128 v[80:83], v223 offset:64
ds_read_b128 v[84:87], v223 offset:80
s_waitcnt vmcnt(10) lgkmcnt(0)
v_perm_b32 v90, v120, v116, s30
v_perm_b32 v91, v120, v116, s31
v_perm_b32 v92, v121, v117, s30
v_perm_b32 v93, v121, v117, s31
v_perm_b32 v94, v122, v118, s30
v_perm_b32 v95, v122, v118, s31
v_perm_b32 v96, v123, v119, s30
v_perm_b32 v97, v123, v119, s31
v_dot2_f32_bf16 v4, v90, v80, v4
v_dot2_f32_bf16 v5, v91, v80, v5
v_dot2_f32_bf16 v6, v92, v80, v6
v_dot2_f32_bf16 v7, v93, v80, v7
v_dot2_f32_bf16 v8, v94, v80, v8
v_dot2_f32_bf16 v9, v95, v80, v9
v_dot2_f32_bf16 v10, v96, v80, v10
v_dot2_f32_bf16 v11, v97, v80, v11
v_dot2_f32_bf16 v12, v90, v81, v12
v_dot2_f32_bf16 v13, v91, v81, v13
v_dot2_f32_bf16 v14, v92, v81, v14
v_dot2_f32_bf16 v15, v93, v81, v15
v_dot2_f32_bf16 v16, v94, v81, v16
v_dot2_f32_bf16 v17, v95, v81, v17
v_dot2_f32_bf16 v18, v96, v81, v18
v_dot2_f32_bf16 v19, v97, v81, v19
v_dot2_f32_bf16 v20, v90, v82, v20
v_dot2_f32_bf16 v21, v91, v82, v21
v_dot2_f32_bf16 v22, v92, v82, v22
v_dot2_f32_bf16 v23, v93, v82, v23
v_dot2_f32_bf16 v24, v94, v82, v24
v_dot2_f32_bf16 v25, v95, v82, v25
v_dot2_f32_bf16 v26, v96, v82, v26
v_dot2_f32_bf16 v27, v97, v82, v27
v_dot2_f32_bf16 v28, v90, v83, v28
v_dot2_f32_bf16 v29, v91, v83, v29
v_dot2_f32_bf16 v30, v92, v83, v30
v_dot2_f32_bf16 v31, v93, v83, v31
v_dot2_f32_bf16 v32, v94, v83, v32
v_dot2_f32_bf16 v33, v95, v83, v33
v_dot2_f32_bf16 v34, v96, v83, v34
v_dot2_f32_bf16 v35, v97, v83, v35
v_dot2_f32_bf16 v36, v90, v84, v36
v_dot2_f32_bf16 v37, v91, v84, v37
v_dot2_f32_bf16 v38, v92, v84, v38
v_dot2_f32_bf16 v39, v93, v84, v39
v_dot2_f32_bf16 v40, v94, v84, v40
v_dot2_f32_bf16 v41, v95, v84, v41
v_dot2_f32_bf16 v42, v96, v84, v42
v_dot2_f32_bf16 v43, v97, v84, v43
v_dot2_f32_bf16 v44, v90, v85, v44
v_dot2_f32_bf16 v45, v91, v85, v45
v_dot2_f32_bf16 v46, v92, v85, v46
v_dot2_f32_bf16 v47, v93, v85, v47
v_dot2_f32_bf16 v48, v94, v85, v48
v_dot2_f32_bf16 v49, v95, v85, v49
v_dot2_f32_bf16 v50, v96, v85, v50
v_dot2_f32_bf16 v51, v97, v85, v51
v_dot2_f32_bf16 v52, v90, v86, v52
v_dot2_f32_bf16 v53, v91, v86, v53
v_dot2_f32_bf16 v54, v92, v86, v54
v_dot2_f32_bf16 v55, v93, v86, v55
v_dot2_f32_bf16 v56, v94, v86, v56
v_dot2_f32_bf16 v57, v95, v86, v57
v_dot2_f32_bf16 v58, v96, v86, v58
v_dot2_f32_bf16 v59, v97, v86, v59
v_dot2_f32_bf16 v60, v90, v87, v60
v_dot2_f32_bf16 v61, v91, v87, v61
v_dot2_f32_bf16 v62, v92, v87, v62
v_dot2_f32_bf16 v63, v93, v87, v63
v_dot2_f32_bf16 v64, v94, v87, v64
v_dot2_f32_bf16 v65, v95, v87, v65
v_dot2_f32_bf16 v66, v96, v87, v66
v_dot2_f32_bf16 v67, v97, v87, v67
ds_read_b128 v[80:83], v223 offset:96
ds_read_b128 v[84:87], v223 offset:112
s_waitcnt vmcnt(8) lgkmcnt(0)
v_perm_b32 v90, v128, v124, s30
v_perm_b32 v91, v128, v124, s31
v_perm_b32 v92, v129, v125, s30
v_perm_b32 v93, v129, v125, s31
v_perm_b32 v94, v130, v126, s30
v_perm_b32 v95, v130, v126, s31
v_perm_b32 v96, v131, v127, s30
v_perm_b32 v97, v131, v127, s31
v_dot2_f32_bf16 v4, v90, v80, v4
v_dot2_f32_bf16 v5, v91, v80, v5
v_dot2_f32_bf16 v6, v92, v80, v6
v_dot2_f32_bf16 v7, v93, v80, v7
v_dot2_f32_bf16 v8, v94, v80, v8
v_dot2_f32_bf16 v9, v95, v80, v9
v_dot2_f32_bf16 v10, v96, v80, v10
v_dot2_f32_bf16 v11, v97, v80, v11
v_dot2_f32_bf16 v12, v90, v81, v12
v_dot2_f32_bf16 v13, v91, v81, v13
v_dot2_f32_bf16 v14, v92, v81, v14
v_dot2_f32_bf16 v15, v93, v81, v15
v_dot2_f32_bf16 v16, v94, v81, v16
v_dot2_f32_bf16 v17, v95, v81, v17
v_dot2_f32_bf16 v18, v96, v81, v18
v_dot2_f32_bf16 v19, v97, v81, v19
v_dot2_f32_bf16 v20, v90, v82, v20
v_dot2_f32_bf16 v21, v91, v82, v21
v_dot2_f32_bf16 v22, v92, v82, v22
v_dot2_f32_bf16 v23, v93, v82, v23
v_dot2_f32_bf16 v24, v94, v82, v24
v_dot2_f32_bf16 v25, v95, v82, v25
v_dot2_f32_bf16 v26, v96, v82, v26
v_dot2_f32_bf16 v27, v97, v82, v27
v_dot2_f32_bf16 v28, v90, v83, v28
v_dot2_f32_bf16 v29, v91, v83, v29
v_dot2_f32_bf16 v30, v92, v83, v30
v_dot2_f32_bf16 v31, v93, v83, v31
v_dot2_f32_bf16 v32, v94, v83, v32
v_dot2_f32_bf16 v33, v95, v83, v33
v_dot2_f32_bf16 v34, v96, v83, v34
v_dot2_f32_bf16 v35, v97, v83, v35
v_dot2_f32_bf16 v36, v90, v84, v36
v_dot2_f32_bf16 v37, v91, v84, v37
v_dot2_f32_bf16 v38, v92, v84, v38
v_dot2_f32_bf16 v39, v93, v84, v39
v_dot2_f32_bf16 v40, v94, v84, v40
v_dot2_f32_bf16 v41, v95, v84, v41
v_dot2_f32_bf16 v42, v96, v84, v42
v_dot2_f32_bf16 v43, v97, v84, v43
v_dot2_f32_bf16 v44, v90, v85, v44
v_dot2_f32_bf16 v45, v91, v85, v45
v_dot2_f32_bf16 v46, v92, v85, v46
v_dot2_f32_bf16 v47, v93, v85, v47
v_dot2_f32_bf16 v48, v94, v85, v48
v_dot2_f32_bf16 v49, v95, v85, v49
v_dot2_f32_bf16 v50, v96, v85, v50
v_dot2_f32_bf16 v51, v97, v85, v51
v_dot2_f32_bf16 v52, v90, v86, v52
v_dot2_f32_bf16 v53, v91, v86, v53
v_dot2_f32_bf16 v54, v92, v86, v54
v_dot2_f32_bf16 v55, v93, v86, v55
v_dot2_f32_bf16 v56, v94, v86, v56
v_dot2_f32_bf16 v57, v95, v86, v57
v_dot2_f32_bf16 v58, v96, v86, v58
v_dot2_f32_bf16 v59, v97, v86, v59
v_dot2_f32_bf16 v60, v90, v87, v60
v_dot2_f32_bf16 v61, v91, v87, v61
v_dot2_f32_bf16 v62, v92, v87, v62
v_dot2_f32_bf16 v63, v93, v87, v63
v_dot2_f32_bf16 v64, v94, v87, v64
v_dot2_f32_bf16 v65, v95, v87, v65
v_dot2_f32_bf16 v66, v96, v87, v66
v_dot2_f32_bf16 v67, v97, v87, v67
ds_read_b128 v[80:83], v223 offset:128
ds_read_b128 v[84:87], v223 offset:144
s_waitcnt vmcnt(6) lgkmcnt(0)
v_perm_b32 v90, v136, v132, s30
v_perm_b32 v91, v136, v132, s31
v_perm_b32 v92, v137, v133, s30
v_perm_b32 v93, v137, v133, s31
v_perm_b32 v94, v138, v134, s30
v_perm_b32 v95, v138, v134, s31
v_perm_b32 v96, v139, v135, s30
v_perm_b32 v97, v139, v135, s31
v_dot2_f32_bf16 v4, v90, v80, v4
v_dot2_f32_bf16 v5, v91, v80, v5
v_dot2_f32_bf16 v6, v92, v80, v6
v_dot2_f32_bf16 v7, v93, v80, v7
v_dot2_f32_bf16 v8, v94, v80, v8
v_dot2_f32_bf16 v9, v95, v80, v9
v_dot2_f32_bf16 v10, v96, v80, v10
v_dot2_f32_bf16 v11, v97, v80, v11
v_dot2_f32_bf16 v12, v90, v81, v12
v_dot2_f32_bf16 v13, v91, v81, v13
v_dot2_f32_bf16 v14, v92, v81, v14
v_dot2_f32_bf16 v15, v93, v81, v15
v_dot2_f32_bf16 v16, v94, v81, v16
v_dot2_f32_bf16 v17, v95, v81, v17
v_dot2_f32_bf16 v18, v96, v81, v18
v_dot2_f32_bf16 v19, v97, v81, v19
v_dot2_f32_bf16 v20, v90, v82, v20
v_dot2_f32_bf16 v21, v91, v82, v21
v_dot2_f32_bf16 v22, v92, v82, v22
v_dot2_f32_bf16 v23, v93, v82, v23
v_dot2_f32_bf16 v24, v94, v82, v24
v_dot2_f32_bf16 v25, v95, v82, v25
v_dot2_f32_bf16 v26, v96, v82, v26
v_dot2_f32_bf16 v27, v97, v82, v27
v_dot2_f32_bf16 v28, v90, v83, v28
v_dot2_f32_bf16 v29, v91, v83, v29
v_dot2_f32_bf16 v30, v92, v83, v30
v_dot2_f32_bf16 v31, v93, v83, v31
v_dot2_f32_bf16 v32, v94, v83, v32
v_dot2_f32_bf16 v33, v95, v83, v33
v_dot2_f32_bf16 v34, v96, v83, v34
v_dot2_f32_bf16 v35, v97, v83, v35
v_dot2_f32_bf16 v36, v90, v84, v36
v_dot2_f32_bf16 v37, v91, v84, v37
v_dot2_f32_bf16 v38, v92, v84, v38
v_dot2_f32_bf16 v39, v93, v84, v39
v_dot2_f32_bf16 v40, v94, v84, v40
v_dot2_f32_bf16 v41, v95, v84, v41
v_dot2_f32_bf16 v42, v96, v84, v42
v_dot2_f32_bf16 v43, v97, v84, v43
v_dot2_f32_bf16 v44, v90, v85, v44
v_dot2_f32_bf16 v45, v91, v85, v45
v_dot2_f32_bf16 v46, v92, v85, v46
v_dot2_f32_bf16 v47, v93, v85, v47
v_dot2_f32_bf16 v48, v94, v85, v48
v_dot2_f32_bf16 v49, v95, v85, v49
v_dot2_f32_bf16 v50, v96, v85, v50
v_dot2_f32_bf16 v51, v97, v85, v51
v_dot2_f32_bf16 v52, v90, v86, v52
v_dot2_f32_bf16 v53, v91, v86, v53
v_dot2_f32_bf16 v54, v92, v86, v54
v_dot2_f32_bf16 v55, v93, v86, v55
v_dot2_f32_bf16 v56, v94, v86, v56
v_dot2_f32_bf16 v57, v95, v86, v57
v_dot2_f32_bf16 v58, v96, v86, v58
v_dot2_f32_bf16 v59, v97, v86, v59
v_dot2_f32_bf16 v60, v90, v87, v60
v_dot2_f32_bf16 v61, v91, v87, v61
v_dot2_f32_bf16 v62, v92, v87, v62
v_dot2_f32_bf16 v63, v93, v87, v63
v_dot2_f32_bf16 v64, v94, v87, v64
v_dot2_f32_bf16 v65, v95, v87, v65
v_dot2_f32_bf16 v66, v96, v87, v66
v_dot2_f32_bf16 v67, v97, v87, v67
ds_read_b128 v[80:83], v223 offset:160
ds_read_b128 v[84:87], v223 offset:176
s_waitcnt vmcnt(4) lgkmcnt(0)
v_perm_b32 v90, v144, v140, s30
v_perm_b32 v91, v144, v140, s31
v_perm_b32 v92, v145, v141, s30
v_perm_b32 v93, v145, v141, s31
v_perm_b32 v94, v146, v142, s30
v_perm_b32 v95, v146, v142, s31
v_perm_b32 v96, v147, v143, s30
v_perm_b32 v97, v147, v143, s31
v_dot2_f32_bf16 v4, v90, v80, v4
v_dot2_f32_bf16 v5, v91, v80, v5
v_dot2_f32_bf16 v6, v92, v80, v6
v_dot2_f32_bf16 v7, v93, v80, v7
v_dot2_f32_bf16 v8, v94, v80, v8
v_dot2_f32_bf16 v9, v95, v80, v9
v_dot2_f32_bf16 v10, v96, v80, v10
v_dot2_f32_bf16 v11, v97, v80, v11
v_dot2_f32_bf16 v12, v90, v81, v12
v_dot2_f32_bf16 v13, v91, v81, v13
v_dot2_f32_bf16 v14, v92, v81, v14
v_dot2_f32_bf16 v15, v93, v81, v15
v_dot2_f32_bf16 v16, v94, v81, v16
v_dot2_f32_bf16 v17, v95, v81, v17
v_dot2_f32_bf16 v18, v96, v81, v18
v_dot2_f32_bf16 v19, v97, v81, v19
v_dot2_f32_bf16 v20, v90, v82, v20
v_dot2_f32_bf16 v21, v91, v82, v21
v_dot2_f32_bf16 v22, v92, v82, v22
v_dot2_f32_bf16 v23, v93, v82, v23
v_dot2_f32_bf16 v24, v94, v82, v24
v_dot2_f32_bf16 v25, v95, v82, v25
v_dot2_f32_bf16 v26, v96, v82, v26
v_dot2_f32_bf16 v27, v97, v82, v27
v_dot2_f32_bf16 v28, v90, v83, v28
v_dot2_f32_bf16 v29, v91, v83, v29
v_dot2_f32_bf16 v30, v92, v83, v30
v_dot2_f32_bf16 v31, v93, v83, v31
v_dot2_f32_bf16 v32, v94, v83, v32
v_dot2_f32_bf16 v33, v95, v83, v33
v_dot2_f32_bf16 v34, v96, v83, v34
v_dot2_f32_bf16 v35, v97, v83, v35
v_dot2_f32_bf16 v36, v90, v84, v36
v_dot2_f32_bf16 v37, v91, v84, v37
v_dot2_f32_bf16 v38, v92, v84, v38
v_dot2_f32_bf16 v39, v93, v84, v39
v_dot2_f32_bf16 v40, v94, v84, v40
v_dot2_f32_bf16 v41, v95, v84, v41
v_dot2_f32_bf16 v42, v96, v84, v42
v_dot2_f32_bf16 v43, v97, v84, v43
v_dot2_f32_bf16 v44, v90, v85, v44
v_dot2_f32_bf16 v45, v91, v85, v45
v_dot2_f32_bf16 v46, v92, v85, v46
v_dot2_f32_bf16 v47, v93, v85, v47
v_dot2_f32_bf16 v48, v94, v85, v48
v_dot2_f32_bf16 v49, v95, v85, v49
v_dot2_f32_bf16 v50, v96, v85, v50
v_dot2_f32_bf16 v51, v97, v85, v51
v_dot2_f32_bf16 v52, v90, v86, v52
v_dot2_f32_bf16 v53, v91, v86, v53
v_dot2_f32_bf16 v54, v92, v86, v54
v_dot2_f32_bf16 v55, v93, v86, v55
v_dot2_f32_bf16 v56, v94, v86, v56
v_dot2_f32_bf16 v57, v95, v86, v57
v_dot2_f32_bf16 v58, v96, v86, v58
v_dot2_f32_bf16 v59, v97, v86, v59
v_dot2_f32_bf16 v60, v90, v87, v60
v_dot2_f32_bf16 v61, v91, v87, v61
v_dot2_f32_bf16 v62, v92, v87, v62
v_dot2_f32_bf16 v63, v93, v87, v63
v_dot2_f32_bf16 v64, v94, v87, v64
v_dot2_f32_bf16 v65, v95, v87, v65
v_dot2_f32_bf16 v66, v96, v87, v66
v_dot2_f32_bf16 v67, v97, v87, v67
ds_read_b128 v[80:83], v223 offset:192
ds_read_b128 v[84:87], v223 offset:208
s_waitcnt vmcnt(2) lgkmcnt(0)
v_perm_b32 v90, v152, v148, s30
v_perm_b32 v91, v152, v148, s31
v_perm_b32 v92, v153, v149, s30
v_perm_b32 v93, v153, v149, s31
v_perm_b32 v94, v154, v150, s30
v_perm_b32 v95, v154, v150, s31
v_perm_b32 v96, v155, v151, s30
v_perm_b32 v97, v155, v151, s31
v_dot2_f32_bf16 v4, v90, v80, v4
v_dot2_f32_bf16 v5, v91, v80, v5
v_dot2_f32_bf16 v6, v92, v80, v6
v_dot2_f32_bf16 v7, v93, v80, v7
v_dot2_f32_bf16 v8, v94, v80, v8
v_dot2_f32_bf16 v9, v95, v80, v9
v_dot2_f32_bf16 v10, v96, v80, v10
v_dot2_f32_bf16 v11, v97, v80, v11
v_dot2_f32_bf16 v12, v90, v81, v12
v_dot2_f32_bf16 v13, v91, v81, v13
v_dot2_f32_bf16 v14, v92, v81, v14
v_dot2_f32_bf16 v15, v93, v81, v15
v_dot2_f32_bf16 v16, v94, v81, v16
v_dot2_f32_bf16 v17, v95, v81, v17
v_dot2_f32_bf16 v18, v96, v81, v18
v_dot2_f32_bf16 v19, v97, v81, v19
v_dot2_f32_bf16 v20, v90, v82, v20
v_dot2_f32_bf16 v21, v91, v82, v21
v_dot2_f32_bf16 v22, v92, v82, v22
v_dot2_f32_bf16 v23, v93, v82, v23
v_dot2_f32_bf16 v24, v94, v82, v24
v_dot2_f32_bf16 v25, v95, v82, v25
v_dot2_f32_bf16 v26, v96, v82, v26
v_dot2_f32_bf16 v27, v97, v82, v27
v_dot2_f32_bf16 v28, v90, v83, v28
v_dot2_f32_bf16 v29, v91, v83, v29
v_dot2_f32_bf16 v30, v92, v83, v30
v_dot2_f32_bf16 v31, v93, v83, v31
v_dot2_f32_bf16 v32, v94, v83, v32
v_dot2_f32_bf16 v33, v95, v83, v33
v_dot2_f32_bf16 v34, v96, v83, v34
v_dot2_f32_bf16 v35, v97, v83, v35
v_dot2_f32_bf16 v36, v90, v84, v36
v_dot2_f32_bf16 v37, v91, v84, v37
v_dot2_f32_bf16 v38, v92, v84, v38
v_dot2_f32_bf16 v39, v93, v84, v39
v_dot2_f32_bf16 v40, v94, v84, v40
v_dot2_f32_bf16 v41, v95, v84, v41
v_dot2_f32_bf16 v42, v96, v84, v42
v_dot2_f32_bf16 v43, v97, v84, v43
v_dot2_f32_bf16 v44, v90, v85, v44
v_dot2_f32_bf16 v45, v91, v85, v45
v_dot2_f32_bf16 v46, v92, v85, v46
v_dot2_f32_bf16 v47, v93, v85, v47
v_dot2_f32_bf16 v48, v94, v85, v48
v_dot2_f32_bf16 v49, v95, v85, v49
v_dot2_f32_bf16 v50, v96, v85, v50
v_dot2_f32_bf16 v51, v97, v85, v51
v_dot2_f32_bf16 v52, v90, v86, v52
v_dot2_f32_bf16 v53, v91, v86, v53
v_dot2_f32_bf16 v54, v92, v86, v54
v_dot2_f32_bf16 v55, v93, v86, v55
v_dot2_f32_bf16 v56, v94, v86, v56
v_dot2_f32_bf16 v57, v95, v86, v57
v_dot2_f32_bf16 v58, v96, v86, v58
v_dot2_f32_bf16 v59, v97, v86, v59
v_dot2_f32_bf16 v60, v90, v87, v60
v_dot2_f32_bf16 v61, v91, v87, v61
v_dot2_f32_bf16 v62, v92, v87, v62
v_dot2_f32_bf16 v63, v93, v87, v63
v_dot2_f32_bf16 v64, v94, v87, v64
v_dot2_f32_bf16 v65, v95, v87, v65
v_dot2_f32_bf16 v66, v96, v87, v66
v_dot2_f32_bf16 v67, v97, v87, v67
ds_read_b128 v[80:83], v223 offset:224
ds_read_b128 v[84:87], v223 offset:240
s_waitcnt vmcnt(0) lgkmcnt(0)
v_perm_b32 v90, v160, v156, s30
v_perm_b32 v91, v160, v156, s31
v_perm_b32 v92, v161, v157, s30
v_perm_b32 v93, v161, v157, s31
v_perm_b32 v94, v162, v158, s30
v_perm_b32 v95, v162, v158, s31
v_perm_b32 v96, v163, v159, s30
v_perm_b32 v97, v163, v159, s31
v_dot2_f32_bf16 v4, v90, v80, v4
v_dot2_f32_bf16 v5, v91, v80, v5
v_dot2_f32_bf16 v6, v92, v80, v6
v_dot2_f32_bf16 v7, v93, v80, v7
v_dot2_f32_bf16 v8, v94, v80, v8
v_dot2_f32_bf16 v9, v95, v80, v9
v_dot2_f32_bf16 v10, v96, v80, v10
v_dot2_f32_bf16 v11, v97, v80, v11
v_dot2_f32_bf16 v12, v90, v81, v12
v_dot2_f32_bf16 v13, v91, v81, v13
v_dot2_f32_bf16 v14, v92, v81, v14
v_dot2_f32_bf16 v15, v93, v81, v15
v_dot2_f32_bf16 v16, v94, v81, v16
v_dot2_f32_bf16 v17, v95, v81, v17
v_dot2_f32_bf16 v18, v96, v81, v18
v_dot2_f32_bf16 v19, v97, v81, v19
v_dot2_f32_bf16 v20, v90, v82, v20
v_dot2_f32_bf16 v21, v91, v82, v21
v_dot2_f32_bf16 v22, v92, v82, v22
v_dot2_f32_bf16 v23, v93, v82, v23
v_dot2_f32_bf16 v24, v94, v82, v24
v_dot2_f32_bf16 v25, v95, v82, v25
v_dot2_f32_bf16 v26, v96, v82, v26
v_dot2_f32_bf16 v27, v97, v82, v27
v_dot2_f32_bf16 v28, v90, v83, v28
v_dot2_f32_bf16 v29, v91, v83, v29
v_dot2_f32_bf16 v30, v92, v83, v30
v_dot2_f32_bf16 v31, v93, v83, v31
v_dot2_f32_bf16 v32, v94, v83, v32
v_dot2_f32_bf16 v33, v95, v83, v33
v_dot2_f32_bf16 v34, v96, v83, v34
v_dot2_f32_bf16 v35, v97, v83, v35
v_dot2_f32_bf16 v36, v90, v84, v36
v_dot2_f32_bf16 v37, v91, v84, v37
v_dot2_f32_bf16 v38, v92, v84, v38
v_dot2_f32_bf16 v39, v93, v84, v39
v_dot2_f32_bf16 v40, v94, v84, v40
v_dot2_f32_bf16 v41, v95, v84, v41
v_dot2_f32_bf16 v42, v96, v84, v42
v_dot2_f32_bf16 v43, v97, v84, v43
v_dot2_f32_bf16 v44, v90, v85, v44
v_dot2_f32_bf16 v45, v91, v85, v45
v_dot2_f32_bf16 v46, v92, v85, v46
v_dot2_f32_bf16 v47, v93, v85, v47
v_dot2_f32_bf16 v48, v94, v85, v48
v_dot2_f32_bf16 v49, v95, v85, v49
v_dot2_f32_bf16 v50, v96, v85, v50
v_dot2_f32_bf16 v51, v97, v85, v51
v_dot2_f32_bf16 v52, v90, v86, v52
v_dot2_f32_bf16 v53, v91, v86, v53
v_dot2_f32_bf16 v54, v92, v86, v54
v_dot2_f32_bf16 v55, v93, v86, v55
v_dot2_f32_bf16 v56, v94, v86, v56
v_dot2_f32_bf16 v57, v95, v86, v57
v_dot2_f32_bf16 v58, v96, v86, v58
v_dot2_f32_bf16 v59, v97, v86, v59
v_dot2_f32_bf16 v60, v90, v87, v60
v_dot2_f32_bf16 v61, v91, v87, v61
v_dot2_f32_bf16 v62, v92, v87, v62
v_dot2_f32_bf16 v63, v93, v87, v63
v_dot2_f32_bf16 v64, v94, v87, v64
v_dot2_f32_bf16 v65, v95, v87, v65
v_dot2_f32_bf16 v66, v96, v87, v66
v_dot2_f32_bf16 v67, v97, v87, v67
s_nop 4
v_lshlrev_b32 v225, 11, v221
v_lshl_add_u32 v225, v220, 5, v225
s_barrier
ds_write_b128 v225, v[4:7] offset:16384
ds_write_b128 v225, v[8:11] offset:16400
ds_write_b128 v225, v[12:15] offset:16640
ds_write_b128 v225, v[16:19] offset:16656
ds_write_b128 v225, v[20:23] offset:16896
ds_write_b128 v225, v[24:27] offset:16912
ds_write_b128 v225, v[28:31] offset:17152
ds_write_b128 v225, v[32:35] offset:17168
ds_write_b128 v225, v[36:39] offset:17408
ds_write_b128 v225, v[40:43] offset:17424
ds_write_b128 v225, v[44:47] offset:17664
ds_write_b128 v225, v[48:51] offset:17680
ds_write_b128 v225, v[52:55] offset:17920
ds_write_b128 v225, v[56:59] offset:17936
ds_write_b128 v225, v[60:63] offset:18176
ds_write_b128 v225, v[64:67] offset:18192
s_waitcnt lgkmcnt(0)
s_barrier
v_lshlrev_b32 v226, 3, v0
v_add_u32 v226, 16384, v226
ds_read_b64 v[4:5], v226 offset:0
ds_read_b64 v[6:7], v226 offset:2048
ds_read_b64 v[8:9], v226 offset:4096
ds_read_b64 v[10:11], v226 offset:6144
ds_read_b64 v[12:13], v226 offset:8192
ds_read_b64 v[14:15], v226 offset:10240
ds_read_b64 v[16:17], v226 offset:12288
ds_read_b64 v[18:19], v226 offset:14336
ds_read_b64 v[20:21], v226 offset:16384
ds_read_b64 v[22:23], v226 offset:18432
ds_read_b64 v[24:25], v226 offset:20480
ds_read_b64 v[26:27], v226 offset:22528
ds_read_b64 v[28:29], v226 offset:24576
ds_read_b64 v[30:31], v226 offset:26624
ds_read_b64 v[32:33], v226 offset:28672
ds_read_b64 v[34:35], v226 offset:30720
ds_read_b64 v[36:37], v226 offset:32768
ds_read_b64 v[38:39], v226 offset:34816
ds_read_b64 v[40:41], v226 offset:36864
ds_read_b64 v[42:43], v226 offset:38912
ds_read_b64 v[44:45], v226 offset:40960
ds_read_b64 v[46:47], v226 offset:43008
ds_read_b64 v[48:49], v226 offset:45056
ds_read_b64 v[50:51], v226 offset:47104
ds_read_b64 v[52:53], v226 offset:49152
ds_read_b64 v[54:55], v226 offset:51200
ds_read_b64 v[56:57], v226 offset:53248
ds_read_b64 v[58:59], v226 offset:55296
ds_read_b64 v[60:61], v226 offset:57344
ds_read_b64 v[62:63], v226 offset:59392
ds_read_b64 v[64:65], v226 offset:61440
ds_read_b64 v[66:67], v226 offset:63488
s_waitcnt lgkmcnt(0)
v_mov_b32 v210, 0
v_mov_b32 v211, 0
v_add_f32 v210, v210, v4
v_add_f32 v211, v211, v5
v_add_f32 v210, v210, v6
v_add_f32 v211, v211, v7
v_add_f32 v210, v210, v8
v_add_f32 v211, v211, v9
v_add_f32 v210, v210, v10
v_add_f32 v211, v211, v11
v_add_f32 v210, v210, v12
v_add_f32 v211, v211, v13
v_add_f32 v210, v210, v14
v_add_f32 v211, v211, v15
v_add_f32 v210, v210, v16
v_add_f32 v211, v211, v17
v_add_f32 v210, v210, v18
v_add_f32 v211, v211, v19
v_add_f32 v210, v210, v20
v_add_f32 v211, v211, v21
v_add_f32 v210, v210, v22
v_add_f32 v211, v211, v23
v_add_f32 v210, v210, v24
v_add_f32 v211, v211, v25
v_add_f32 v210, v210, v26
v_add_f32 v211, v211, v27
v_add_f32 v210, v210, v28
v_add_f32 v211, v211, v29
v_add_f32 v210, v210, v30
v_add_f32 v211, v211, v31
v_add_f32 v210, v210, v32
v_add_f32 v211, v211, v33
v_add_f32 v210, v210, v34
v_add_f32 v211, v211, v35
v_add_f32 v210, v210, v36
v_add_f32 v211, v211, v37
v_add_f32 v210, v210, v38
v_add_f32 v211, v211, v39
v_add_f32 v210, v210, v40
v_add_f32 v211, v211, v41
v_add_f32 v210, v210, v42
v_add_f32 v211, v211, v43
v_add_f32 v210, v210, v44
v_add_f32 v211, v211, v45
v_add_f32 v210, v210, v46
v_add_f32 v211, v211, v47
v_add_f32 v210, v210, v48
v_add_f32 v211, v211, v49
v_add_f32 v210, v210, v50
v_add_f32 v211, v211, v51
v_add_f32 v210, v210, v52
v_add_f32 v211, v211, v53
v_add_f32 v210, v210, v54
v_add_f32 v211, v211, v55
v_add_f32 v210, v210, v56
v_add_f32 v211, v211, v57
v_add_f32 v210, v210, v58
v_add_f32 v211, v211, v59
v_add_f32 v210, v210, v60
v_add_f32 v211, v211, v61
v_add_f32 v210, v210, v62
v_add_f32 v211, v211, v63
v_add_f32 v210, v210, v64
v_add_f32 v211, v211, v65
v_add_f32 v210, v210, v66
v_add_f32 v211, v211, v67
v_mul_u32_u24 v204, 2304, v200
v_lshl_add_u32 v204, v201, 3, v204
s_mul_i32 s28, s4, 18432
s_lshl_b32 s29, s5, 8
s_add_u32 s28, s28, s29
s_add_u32 s28, s28, 1310720
buffer_store_dwordx2 v[210:211], v204, s[24:27], s28 offen sc1
s_waitcnt vmcnt(0)
s_barrier
s_lshl_b32 s6, s5, 2
v_mov_b32 v26, 1
v_mov_b32 v27, 0
v_cmp_eq_u32 vcc, 0, v0
s_and_saveexec_b64 s[28:29], vcc
s_cbranch_execz k6_na
buffer_atomic_add v26, v27, s[20:23], s6 offen sc0
s_waitcnt vmcnt(0)
ds_write_b32 v27, v26
s_waitcnt lgkmcnt(0)
k6_na:
s_or_b64 exec, exec, s[28:29]
s_barrier
ds_read_b32 v26, v27
s_waitcnt lgkmcnt(0)
v_readfirstlane_b32 s7, v26
s_cmp_lg_u32 s7, 8
s_cbranch_scc1 k6_kernel_end
s_lshl_b32 s29, s5, 8
s_add_u32 s28, s29, 1310720
v_add_u32 v205, 0, v204
buffer_load_dwordx2 v[30:31], v205, s[24:27], s28 offen sc1
v_add_u32 v205, 18432, v204
buffer_load_dwordx2 v[32:33], v205, s[24:27], s28 offen sc1
v_add_u32 v205, 36864, v204
buffer_load_dwordx2 v[34:35], v205, s[24:27], s28 offen sc1
v_add_u32 v205, 55296, v204
buffer_load_dwordx2 v[36:37], v205, s[24:27], s28 offen sc1
v_add_u32 v205, 73728, v204
buffer_load_dwordx2 v[38:39], v205, s[24:27], s28 offen sc1
v_add_u32 v205, 92160, v204
buffer_load_dwordx2 v[40:41], v205, s[24:27], s28 offen sc1
v_add_u32 v205, 110592, v204
buffer_load_dwordx2 v[42:43], v205, s[24:27], s28 offen sc1
v_add_u32 v205, 129024, v204
buffer_load_dwordx2 v[44:45], v205, s[24:27], s28 offen sc1
v_add_u32 v205, 147456, v204
buffer_load_dwordx2 v[46:47], v205, s[24:27], s28 offen sc1
s_add_u32 s28, s29, 1114112
buffer_load_dwordx2 v[50:51], v204, s[24:27], s28 offen
v_mul_u32_u24 v206, 0x3600, v200
v_lshl_add_u32 v206, v201, 3, v206
s_add_u32 s28, s29, 11520
buffer_load_dwordx2 v[52:53], v206, s[24:27], s28 offen
s_waitcnt vmcnt(0)
v_add_f32 v30, v30, v32
v_add_f32 v31, v31, v33
v_add_f32 v30, v30, v34
v_add_f32 v31, v31, v35
v_add_f32 v30, v30, v36
v_add_f32 v31, v31, v37
v_add_f32 v30, v30, v38
v_add_f32 v31, v31, v39
v_add_f32 v30, v30, v40
v_add_f32 v31, v31, v41
v_add_f32 v30, v30, v42
v_add_f32 v31, v31, v43
v_add_f32 v30, v30, v44
v_add_f32 v31, v31, v45
v_add_f32 v30, v30, v46
v_add_f32 v31, v31, v47
v_cvt_pk_bf16_f32 v209, v30, v30
v_lshlrev_b32 v30, 16, v209
v_cvt_pk_bf16_f32 v209, v31, v31
v_lshlrev_b32 v31, 16, v209
v_fma_f32 v30, v30, v52, v50
v_fma_f32 v31, v31, v53, v51
v_cvt_pk_bf16_f32 v30, v30, v31
v_lshrrev_b32 v204, 1, v204
s_lshr_b32 s29, s29, 1
buffer_store_dword v30, v204, s[16:19], s29 offen
k6_kernel_end:
s_endpgm
.section .rodata,"a"
.p2align 6
.amdhsa_kernel k1_kernel
.amdhsa_next_free_vgpr 256
.amdhsa_next_free_sgpr 102
.amdhsa_accum_offset 256
.amdhsa_group_segment_fixed_size 0
.amdhsa_kernarg_size 112
.amdhsa_user_sgpr_count 2
.amdhsa_user_sgpr_kernarg_segment_ptr 1
.amdhsa_system_sgpr_workgroup_id_x 1
.end_amdhsa_kernel
.p2align 6
.amdhsa_kernel k2_kernel
.amdhsa_next_free_vgpr 256
.amdhsa_next_free_sgpr 102
.amdhsa_accum_offset 256
.amdhsa_group_segment_fixed_size 0
.amdhsa_kernarg_size 112
.amdhsa_user_sgpr_count 2
.amdhsa_user_sgpr_kernarg_segment_ptr 1
.amdhsa_system_sgpr_workgroup_id_x 1
.end_amdhsa_kernel
.p2align 6
.amdhsa_kernel k3_kernel
.amdhsa_next_free_vgpr 256
.amdhsa_next_free_sgpr 102
.amdhsa_accum_offset 256
.amdhsa_group_segment_fixed_size 0
.amdhsa_kernarg_size 112
.amdhsa_user_sgpr_count 2
.amdhsa_user_sgpr_kernarg_segment_ptr 1
.amdhsa_system_sgpr_workgroup_id_x 1
.end_amdhsa_kernel
.p2align 6
.amdhsa_kernel k4_kernel
.amdhsa_next_free_vgpr 256
.amdhsa_next_free_sgpr 102
.amdhsa_accum_offset 256
.amdhsa_group_segment_fixed_size 0
.amdhsa_kernarg_size 112
.amdhsa_user_sgpr_count 2
.amdhsa_user_sgpr_kernarg_segment_ptr 1
.amdhsa_system_sgpr_workgroup_id_x 1
.end_amdhsa_kernel
.p2align 6
.amdhsa_kernel k5_kernel
.amdhsa_next_free_vgpr 256
.amdhsa_next_free_sgpr 102
.amdhsa_accum_offset 256
.amdhsa_group_segment_fixed_size 0
.amdhsa_kernarg_size 112
.amdhsa_user_sgpr_count 2
.amdhsa_user_sgpr_kernarg_segment_ptr 1
.amdhsa_system_sgpr_workgroup_id_x 1
.end_amdhsa_kernel
.p2align 6
.amdhsa_kernel k6_kernel
.amdhsa_next_free_vgpr 256
.amdhsa_next_free_sgpr 102
.amdhsa_accum_offset 256
.amdhsa_group_segment_fixed_size 0
.amdhsa_kernarg_size 112
.amdhsa_user_sgpr_count 2
.amdhsa_user_sgpr_kernarg_segment_ptr 1
.amdhsa_system_sgpr_workgroup_id_x 1
.end_amdhsa_kernel
```
